```python
import torch

def _softmax(x, axis=-1):
    return torch.softmax(x, dim=axis)
def _gelu(x):
    return torch.nn.functional.gelu(x, approximate="tanh")
def _silu(x):
    return torch.nn.functional.silu(x)
def _sigmoid(x):
    return torch.sigmoid(x)
def _layernorm(x, axis=-1, eps=1e-5):
    m = x.mean(dim=axis, keepdim=True)
    v = x.var(dim=axis, keepdim=True, unbiased=False)
    return (x - m) / torch.sqrt(v + eps)
def _scatter_add(tgt, idx, src, axis=0):
    return tgt.clone().index_add_(axis, idx, src)
def _segment_sum(src, seg, n):
    out = torch.zeros((n,) + src.shape[1:], dtype=src.dtype)
    return out.index_add_(0, seg, src)
def _pad(x, pw):
    flat = tuple(v for pair in reversed(pw) for v in pair)
    return torch.nn.functional.pad(x, flat)

kernel_name = 'standalone__mha_block_cached__near_ridge'

def setup_inputs():

    _w = (lambda a: (lambda t: t.to(torch.bfloat16) if t.is_floating_point() else t)(torch.as_tensor(a)))
    B, Sq, D = 16, 128, 512
    H, Sk, Dh = 32, 1024, 128
    return {
        "x": _w((lambda *s: torch.randn(*s, dtype=torch.bfloat16) * 0.8)(B, Sq, D)),
        "k_cache": _w((lambda *s: torch.randn(*s, dtype=torch.bfloat16) * 0.8)(B, H, Sk, Dh)),
        "v_cache": _w((lambda *s: torch.randn(*s, dtype=torch.bfloat16) * 0.05)(B, H, Sk, Dh)),
        "wq": _w((lambda *s: torch.randn(*s, dtype=torch.bfloat16) * 0.8)(D, H * Dh) * (D ** -0.5)),
        "wo": _w((lambda *s: torch.randn(*s, dtype=torch.bfloat16) * 0.05)(H * Dh, D) * ((H * Dh) ** -0.5)),
    }

def reference(x, k_cache, v_cache, wq, wo):
    B, Sq, D = x.shape
    H, Dh = 32, 128
    q = (lambda x, *d: x.permute(*d))((x @ wq).reshape(B, Sq, H, Dh), 0, 2, 1, 3)
    scores = torch.einsum("bhqd,bhkd->bhqk", q, k_cache) * (Dh ** -0.5)
    p = _softmax(scores, axis=-1)
    o = torch.einsum("bhqk,bhkd->bhqd", p, v_cache)
    return (lambda x, *d: x.permute(*d))(o, 0, 2, 1, 3).reshape(B, Sq, H * Dh) @ wo
```

```asm
; @launch grid=(256,1,1) block=(256,1,1) lds=163840
.amdgcn_target "amdgcn-amd-amdhsa--gfx950"
.text
.globl standalone__mha_block_cached__near_ridge_kernel
.p2align 8
.type standalone__mha_block_cached__near_ridge_kernel,@function
standalone__mha_block_cached__near_ridge_kernel:
s_cmp_ge_u32 s2, 256
s_cbranch_scc1 L_end
s_load_dwordx16 s[64:79], s[0:1], 0
v_lshrrev_b32 v1, 6, v0
v_and_b32 v2, 63, v0
v_readfirstlane_b32 s36, v1
v_lshlrev_b32 v40, 4, v2
s_getpc_b64 s[88:89]
L_pc:
s_mov_b32 s90, L_codeend-L_pc
s_mov_b32 s91, 0x20000
s_lshr_b32 s51, s2, 3
s_lshl_b32 s51, s51, 2
s_add_u32 s51, s51, s36
s_and_b32 s51, s51, 63
s_lshl_b32 s51, s51, 10
buffer_load_dwordx4 v[128:131], v40, s[88:91], s51 offen
s_lshl_b32 s37, s36, 12
s_lshl_b32 s40, s36, 11
v_lshrrev_b32 v176, 4, v2
v_and_b32 v179, 3, v2
v_lshrrev_b32 v180, 2, v2
v_lshl_add_u32 v180, v1, 5, v180
v_sub_u32 v181, 0, v176
v_and_b32 v181, 3, v181
v_xor_b32 v181, v181, v179
v_lshlrev_b32 v181, 4, v181
v_lshl_add_u32 v169, v180, 10, v181
v_add_u32 v170, 15360, v169
v_lshrrev_b32 v180, 5, v2
v_and_b32 v181, 1, v1
v_lshl_add_u32 v181, v181, 2, v180
v_lshlrev_b32 v181, 1, v181
v_and_b32 v182, 31, v2
v_xor_b32 v181, v181, v182
v_lshlrev_b32 v181, 4, v181
v_lshl_add_u32 v180, v1, 3, v180
v_lshl_add_u32 v171, v180, 13, v181
v_xor_b32_e64 v181, 64, v171
v_add_u32 v172, 15360, v181
v_add_u32 v173, 30720, v171
v_add_u32 v174, 46080, v181
s_and_b32 s86, s2, 1
s_lshl_b32 s86, s86, 3
s_bfe_u32 s52, s2, 0x30003
s_add_u32 s86, s86, s52
s_lshr_b32 s53, s2, 6
s_lshl_b32 s46, s53, 1
s_add_u32 s46, s46, s52
s_lshl_b32 s46, s46, 1
s_sub_u32 s80, s46, 14
s_cselect_b32 s46, s46, s80
s_sub_u32 s80, s46, 14
s_cselect_b32 s46, s46, s80
s_add_u32 s46, s46, 2
s_mov_b32 s80, 0
s_bfe_u32 s52, s2, 0x20001
s_lshl_b32 s52, s52, 3
s_lshl_b32 s59, s53, 1
s_add_u32 s59, s59, s52
s_add_u32 s52, s52, s53
s_lshl_b32 s81, s86, 17
s_lshl_b32 s82, s59, 8
s_waitcnt lgkmcnt(0)
s_mov_b32 s12, s64
s_mov_b32 s13, s65
s_mov_b32 s14, 0x200000
s_mov_b32 s15, 0x20000
s_mov_b32 s16, s70
s_mov_b32 s17, s71
s_mov_b32 s18, 0x400000
s_mov_b32 s19, 0x20000
s_lshl_b32 s48, s80, 6
s_add_u32 m0, s40, 32768
s_add_u32 s48, s48, s81
buffer_load_dwordx4 v169, s[12:15], s48 offen offset:0 lds
s_lshl_b32 s49, s80, 18
buffer_load_dwordx4 v170, s[12:15], s48 offen offset:1024 lds
s_add_u32 m0, s37, 98304
s_add_u32 s49, s49, s82
buffer_load_dwordx4 v171, s[16:19], s49 offen offset:0 lds
s_add_u32 s80, s80, 1
buffer_load_dwordx4 v172, s[16:19], s49 offen offset:1024 lds
s_cmp_eq_u32 s80, 16
s_cselect_b32 s80, 2, s80
buffer_load_dwordx4 v173, s[16:19], s49 offen offset:2048 lds
buffer_load_dwordx4 v174, s[16:19], s49 offen offset:3072 lds
s_lshl_b32 s53, s86, 5
s_add_u32 s53, s53, s59
s_lshl_b32 s53, s53, 18
s_add_u32 s66, s66, s53
s_addc_u32 s67, s67, 0
s_add_u32 s68, s68, s53
s_addc_u32 s69, s69, 0
s_mov_b32 s38, 0
s_mov_b32 s39, 0
s_lshl_b32 s84, s86, 2
s_lshr_b32 s53, s52, 3
s_add_u32 s84, s84, s53
s_lshl_b32 s84, s84, 2
s_add_u32 s84, s84, s36
s_lshl_b32 s84, s84, 7
s_and_b32 s53, s52, 3
s_lshl_b32 s53, s53, 2
s_add_u32 s84, s84, s53
s_add_u32 s84, s84, 16777216
s_lshl_b32 s51, s86, 5
s_add_u32 s51, s51, s59
s_lshl_b32 s51, s51, 15
s_add_u32 s50, s51, s40
s_lshl_b32 s48, s80, 6
s_add_u32 m0, s40, 40960
s_add_u32 s48, s48, s81
buffer_load_dwordx4 v169, s[12:15], s48 offen offset:0 lds
s_lshl_b32 s49, s80, 18
buffer_load_dwordx4 v170, s[12:15], s48 offen offset:1024 lds
s_add_u32 m0, s37, 114688
s_add_u32 s49, s49, s82
buffer_load_dwordx4 v171, s[16:19], s49 offen offset:0 lds
s_mov_b32 s80, s46
buffer_load_dwordx4 v172, s[16:19], s49 offen offset:1024 lds
buffer_load_dwordx4 v173, s[16:19], s49 offen offset:2048 lds
buffer_load_dwordx4 v174, s[16:19], s49 offen offset:3072 lds
s_mov_b32 s44, 0x3e0293ee
s_mov_b32 s42, 0x41000000
s_mov_b32 s4, s66
s_mov_b32 s5, s67
s_mov_b32 s6, 0x80000
s_mov_b32 s7, 0x20000
s_mov_b32 s8, s68
s_mov_b32 s9, s69
s_mov_b32 s10, 0x80000
s_mov_b32 s11, 0x20000
s_mov_b32 s20, s72
s_mov_b32 s21, s73
s_mov_b32 s22, 0x400000
s_mov_b32 s23, 0x20000
s_mov_b32 s24, s78
s_mov_b32 s25, s79
s_mov_b32 s26, 0x2000000
s_mov_b32 s27, 0x20000
s_mov_b32 s28, s74
s_mov_b32 s29, s75
s_mov_b32 s30, 0x200000
s_mov_b32 s31, 0x20000
v_and_b32_e64 v177, 15, v2
v_lshl_add_u32 v180, v1, 4, v176
v_lshlrev_b32 v181, 1, v176
v_xor_b32 v181, v181, v177
v_lshlrev_b32_e64 v181, 4, v181
v_lshl_add_u32 v32, v180, 8, v181
v_xor_b32 v33, 128, v32
v_xor_b32 v181, v177, v176
v_lshlrev_b32 v181, 4, v181
v_lshl_add_u32 v28, v180, 8, v181
v_xor_b32_e64 v29, 64, v28
v_xor_b32 v30, 128, v28
v_xor_b32 v31, 192, v28
s_lshl_b32 s48, s80, 6
s_add_u32 m0, s40, 49152
s_add_u32 s48, s48, s81
buffer_load_dwordx4 v169, s[12:15], s48 offen offset:0 lds
s_lshl_b32 s49, s80, 18
buffer_load_dwordx4 v170, s[12:15], s48 offen offset:1024 lds
s_add_u32 m0, s37, 131072
s_add_u32 s49, s49, s82
buffer_load_dwordx4 v171, s[16:19], s49 offen offset:0 lds
s_add_u32 s80, s80, 1
buffer_load_dwordx4 v172, s[16:19], s49 offen offset:1024 lds
s_cmp_eq_u32 s80, 16
s_cselect_b32 s80, 2, s80
buffer_load_dwordx4 v173, s[16:19], s49 offen offset:2048 lds
buffer_load_dwordx4 v174, s[16:19], s49 offen offset:3072 lds
v_lshl_add_u32 v16, v177, 8, v181
v_xor_b32 v17, 64, v16
v_xor_b32 v18, 128, v16
v_xor_b32 v19, 192, v16
v_bfe_u32 v178, v2, 2, 2
v_sub_u32 v180, 0, v178
v_and_b32 v180, 3, v180
v_xor_b32 v180, v180, v176
v_lshlrev_b32 v180, 4, v180
v_lshl_add_u32 v181, v1, 5, v177
v_lshl_add_u32 v180, v181, 6, v180
v_add_u32 v168, 32768, v180
v_and_b32_e64 v180, 1, v176
v_lshl_add_u32 v180, v180, 2, v178
v_lshlrev_b32_e64 v180, 5, v180
v_lshl_add_u32 v180, v179, 3, v180
v_lshl_add_u32 v182, v176, 2, v178
v_lshl_add_u32 v181, v182, 8, v180
v_add_u32 v20, 65536, v181
v_xor_b32 v21, 32, v20
v_xor_b32 v22, 64, v20
v_xor_b32 v23, 96, v20
v_xor_b32 v24, 128, v20
v_xor_b32 v25, 160, v20
v_xor_b32 v26, 192, v20
v_xor_b32 v27, 224, v20
v_lshl_add_u32 v181, v176, 3, v178
v_lshl_add_u32 v181, v181, 9, v180
v_add_u32 v160, 98304, v181
v_xor_b32 v161, 32, v160
v_xor_b32 v162, 64, v160
v_xor_b32 v163, 96, v160
v_xor_b32 v164, 128, v160
v_xor_b32 v165, 160, v160
v_xor_b32 v166, 192, v160
v_xor_b32 v167, 224, v160
v_and_b32 v180, 0xff, v32
v_lshrrev_b32_e64 v181, 8, v32
v_lshl_add_u32 v3, v181, 10, v180
v_xor_b32 v180, 128, v3
v_add_u32 v4, 3072, v180
v_add_u32 v5, 6144, v3
v_add_u32 v6, 9216, v180
v_cmp_eq_u32 vcc, 0, v179
v_mov_b32 v180, 0x3f803f80
v_mov_b32 v14, 0
v_cndmask_b32 v44, 0, v180, vcc
v_cndmask_b32 v45, 0, v180, vcc
v_cndmask_b32 v46, 0, v180, vcc
v_cndmask_b32 v47, 0, v180, vcc
v_mov_b32 v48, 0
v_mov_b32 v49, 0
v_mov_b32 v50, 0
v_mov_b32 v51, 0
v_mov_b32 v52, 0
v_mov_b32 v53, 0
v_mov_b32 v54, 0
v_mov_b32 v55, 0
v_mov_b32 v56, 0
v_mov_b32 v57, 0
v_mov_b32 v58, 0
v_mov_b32 v59, 0
v_mov_b32 v60, 0
v_mov_b32 v61, 0
v_mov_b32 v62, 0
v_mov_b32_e64 v63, 0
s_mov_b32 s58, s86
s_bfe_u32 s61, s2, 0x20001
s_lshr_b32 s59, s2, 6
s_lshl_b32 s51, s58, 2
s_add_u32 s51, s51, s61
s_lshl_b32 s83, s51, 18
s_add_u32 s83, s83, s40
s_lshl_b32 s85, s51, 2
s_add_u32 s85, s85, s36
s_lshl_b32 s85, s85, 7
s_add_u32 s85, s85, 16777216
s_lshl_b32 s41, s61, 20
s_lshl_b32 s52, s59, 8
s_add_u32 s41, s41, s52
s_lshl_b32 s47, s51, 15
s_add_u32 s47, s47, s52
s_lshl_b32 s52, s36, 6
s_add_u32 s47, s47, s52
s_lshl_b32 s51, s58, 2
s_add_u32 s51, s51, s59
s_lshl_b32 s51, s51, 2
s_add_u32 s52, s51, s36
s_add_u32 s53, s51, s61
s_lshl_b32 s62, s52, 2
s_add_u32 s62, s62, s61
s_lshl_b32 s62, s62, 13
s_add_u32 s62, s62, 25165824
s_lshl_b32 s63, s53, 15
s_add_u32 s63, s63, s40
s_add_u32 s63, s63, 25165824
s_lshl_b32 s3, s52, 7
s_lshl_b32 s52, s61, 2
s_add_u32 s3, s3, s52
s_add_u32 s3, s3, 16842752
s_lshl_b32 s45, s53, 7
s_add_u32 s45, s45, 16842752
s_add_u32 s51, s59, 0
s_and_b32 s51, s51, 3
s_lshl_b32 s52, s51, 18
s_add_u32 s64, s41, s52
s_lshl_b32 s52, s51, 16
s_add_u32 s68, s83, s52
s_add_u32 s51, s59, 1
s_and_b32 s51, s51, 3
s_lshl_b32 s52, s51, 18
s_add_u32 s65, s41, s52
s_lshl_b32 s52, s51, 16
s_add_u32 s69, s83, s52
s_add_u32 s51, s59, 2
s_and_b32 s51, s51, 3
s_lshl_b32 s52, s51, 18
s_add_u32 s66, s41, s52
s_lshl_b32 s52, s51, 16
s_add_u32 s70, s83, s52
s_add_u32 s51, s59, 3
s_and_b32 s51, s51, 3
s_lshl_b32 s52, s51, 18
s_add_u32 s67, s41, s52
s_lshl_b32 s52, s51, 16
s_add_u32 s71, s83, s52
v_add_u32 v240, 65536, v20
v_add_u32 v241, 65536, v21
v_add_u32 v242, 65536, v22
v_add_u32 v243, 65536, v23
v_add_u32 v244, 65536, v24
v_add_u32 v245, 65536, v25
v_add_u32 v246, 65536, v26
v_add_u32 v247, 65536, v27
v_and_b32 v13, 3, v2
v_lshlrev_b32_e64 v13, 2, v13
buffer_load_dword v12, v13, s[24:27], s85 offen sc1
buffer_load_dword v15, v14, s[24:27], s84 offen sc1
buffer_load_dword v252, v13, s[24:27], s45 offen sc1
buffer_load_dword v253, v14, s[24:27], s3 offen sc1
s_waitcnt vmcnt(16)
s_barrier
ds_read_b128 a[96:99], v168 offset:0
ds_read_b128 a[100:103], v168 offset:1024
ds_read_b64_tr_b16 a[128:129], v160 offset:0
ds_read_b64_tr_b16 a[130:131], v160 offset:2048
ds_read_b64_tr_b16 a[132:133], v161 offset:0
ds_read_b64_tr_b16 a[134:135], v161 offset:2048
ds_read_b64_tr_b16 a[136:137], v162 offset:0
ds_read_b64_tr_b16 a[138:139], v162 offset:2048
ds_read_b64_tr_b16 a[140:141], v163 offset:0
ds_read_b64_tr_b16 a[142:143], v163 offset:2048
ds_read_b64_tr_b16 a[144:145], v164 offset:0
ds_read_b64_tr_b16 a[146:147], v164 offset:2048
ds_read_b64_tr_b16 a[148:149], v165 offset:0
ds_read_b64_tr_b16 a[150:151], v165 offset:2048
s_waitcnt lgkmcnt(4)
v_mfma_f32_16x16x32_bf16 v[64:67], a[128:131], a[96:99], 0
ds_read_b64_tr_b16 a[152:153], v166 offset:0
s_lshl_b32 s48, s80, 6
s_add_u32 m0, s40, 57344
s_add_u32 s48, s48, s81
v_mfma_f32_16x16x32_bf16 v[68:71], a[128:131], a[100:103], 0
ds_read_b64_tr_b16 a[154:155], v166 offset:2048
buffer_load_dwordx4 v169, s[12:15], s48 offen offset:0 lds
v_mfma_f32_16x16x32_bf16 v[72:75], a[132:135], a[96:99], 0
ds_read_b64_tr_b16 a[156:157], v167 offset:0
s_lshl_b32 s49, s80, 18
v_mfma_f32_16x16x32_bf16 v[76:79], a[132:135], a[100:103], 0
ds_read_b64_tr_b16 a[158:159], v167 offset:2048
buffer_load_dwordx4 v170, s[12:15], s48 offen offset:1024 lds
v_mfma_f32_16x16x32_bf16 v[80:83], a[136:139], a[96:99], 0
v_add_u32 v168, 8192, v168
ds_read_b64_tr_b16 a[128:129], v160 offset:256
s_add_u32 m0, s37, 147456
s_add_u32 s49, s49, s82
v_mfma_f32_16x16x32_bf16 v[84:87], a[136:139], a[100:103], 0
ds_read_b64_tr_b16 a[130:131], v160 offset:2304
buffer_load_dwordx4 v171, s[16:19], s49 offen offset:0 lds
v_mfma_f32_16x16x32_bf16 v[88:91], a[140:143], a[96:99], 0
ds_read_b64_tr_b16 a[132:133], v161 offset:256
s_add_u32 s80, s80, 1
v_mfma_f32_16x16x32_bf16 v[92:95], a[140:143], a[100:103], 0
ds_read_b64_tr_b16 a[134:135], v161 offset:2304
buffer_load_dwordx4 v172, s[16:19], s49 offen offset:1024 lds
s_waitcnt lgkmcnt(4)
v_mfma_f32_16x16x32_bf16 v[96:99], a[144:147], a[96:99], 0
ds_read_b64_tr_b16 a[136:137], v162 offset:256
s_cmp_eq_u32 s80, 16
s_cselect_b32 s80, 2, s80
v_mfma_f32_16x16x32_bf16 v[100:103], a[144:147], a[100:103], 0
ds_read_b64_tr_b16 a[138:139], v162 offset:2304
buffer_load_dwordx4 v173, s[16:19], s49 offen offset:2048 lds
v_mfma_f32_16x16x32_bf16 v[104:107], a[148:151], a[96:99], 0
ds_read_b64_tr_b16 a[140:141], v163 offset:256
v_mfma_f32_16x16x32_bf16 v[108:111], a[148:151], a[100:103], 0
ds_read_b64_tr_b16 a[142:143], v163 offset:2304
buffer_load_dwordx4 v174, s[16:19], s49 offen offset:3072 lds
v_mfma_f32_16x16x32_bf16 v[112:115], a[152:155], a[96:99], 0
ds_read_b64_tr_b16 a[144:145], v164 offset:256
v_mfma_f32_16x16x32_bf16 v[116:119], a[152:155], a[100:103], 0
ds_read_b64_tr_b16 a[146:147], v164 offset:2304
v_mfma_f32_16x16x32_bf16 v[120:123], a[156:159], a[96:99], 0
ds_read_b64_tr_b16 a[148:149], v165 offset:256
v_mfma_f32_16x16x32_bf16 v[124:127], a[156:159], a[100:103], 0
ds_read_b64_tr_b16 a[150:151], v165 offset:2304
s_waitcnt lgkmcnt(4)
v_mfma_f32_16x16x32_bf16 a[32:35], a[128:131], a[96:99], 0
ds_read_b64_tr_b16 a[152:153], v166 offset:256
v_mfma_f32_16x16x32_bf16 a[36:39], a[128:131], a[100:103], 0
ds_read_b64_tr_b16 a[154:155], v166 offset:2304
v_mfma_f32_16x16x32_bf16 a[40:43], a[132:135], a[96:99], 0
ds_read_b64_tr_b16 a[156:157], v167 offset:256
v_mfma_f32_16x16x32_bf16 a[44:47], a[132:135], a[100:103], 0
ds_read_b64_tr_b16 a[158:159], v167 offset:2304
v_mfma_f32_16x16x32_bf16 a[48:51], a[136:139], a[96:99], 0
s_waitcnt vmcnt(16)
s_barrier
ds_read_b64_tr_b16 a[128:129], v160 offset:16384
v_mfma_f32_16x16x32_bf16 a[52:55], a[136:139], a[100:103], 0
ds_read_b64_tr_b16 a[130:131], v160 offset:18432
v_mfma_f32_16x16x32_bf16 a[56:59], a[140:143], a[96:99], 0
ds_read_b128 a[104:107], v168 offset:0
ds_read_b64_tr_b16 a[132:133], v161 offset:16384
v_mfma_f32_16x16x32_bf16 a[60:63], a[140:143], a[100:103], 0
ds_read_b64_tr_b16 a[134:135], v161 offset:18432
s_waitcnt lgkmcnt(5)
v_mfma_f32_16x16x32_bf16 a[64:67], a[144:147], a[96:99], 0
ds_read_b128 a[108:111], v168 offset:1024
ds_read_b64_tr_b16 a[136:137], v162 offset:16384
v_mfma_f32_16x16x32_bf16 a[68:71], a[144:147], a[100:103], 0
ds_read_b64_tr_b16 a[138:139], v162 offset:18432
v_mfma_f32_16x16x32_bf16 a[72:75], a[148:151], a[96:99], 0
ds_read_b64_tr_b16 a[140:141], v163 offset:16384
v_mfma_f32_16x16x32_bf16 a[76:79], a[148:151], a[100:103], 0
ds_read_b64_tr_b16 a[142:143], v163 offset:18432
v_mfma_f32_16x16x32_bf16 a[80:83], a[152:155], a[96:99], 0
ds_read_b64_tr_b16 a[144:145], v164 offset:16384
v_mfma_f32_16x16x32_bf16 a[84:87], a[152:155], a[100:103], 0
ds_read_b64_tr_b16 a[146:147], v164 offset:18432
v_mfma_f32_16x16x32_bf16 a[88:91], a[156:159], a[96:99], 0
ds_read_b64_tr_b16 a[148:149], v165 offset:16384
v_mfma_f32_16x16x32_bf16 a[92:95], a[156:159], a[100:103], 0
ds_read_b64_tr_b16 a[150:151], v165 offset:18432
s_waitcnt lgkmcnt(4)
v_mfma_f32_16x16x32_bf16 v[64:67], a[128:131], a[104:107], v[64:67]
ds_read_b64_tr_b16 a[152:153], v166 offset:16384
v_mfma_f32_16x16x32_bf16 v[68:71], a[128:131], a[108:111], v[68:71]
ds_read_b64_tr_b16 a[154:155], v166 offset:18432
v_mfma_f32_16x16x32_bf16 v[72:75], a[132:135], a[104:107], v[72:75]
ds_read_b64_tr_b16 a[156:157], v167 offset:16384
v_mfma_f32_16x16x32_bf16 v[76:79], a[132:135], a[108:111], v[76:79]
ds_read_b64_tr_b16 a[158:159], v167 offset:18432
v_mfma_f32_16x16x32_bf16 v[80:83], a[136:139], a[104:107], v[80:83]
v_add_u32 v168, 8192, v168
ds_read_b64_tr_b16 a[128:129], v160 offset:16640
v_mfma_f32_16x16x32_bf16 v[84:87], a[136:139], a[108:111], v[84:87]
ds_read_b64_tr_b16 a[130:131], v160 offset:18688
v_mfma_f32_16x16x32_bf16 v[88:91], a[140:143], a[104:107], v[88:91]
ds_read_b64_tr_b16 a[132:133], v161 offset:16640
v_mfma_f32_16x16x32_bf16 v[92:95], a[140:143], a[108:111], v[92:95]
ds_read_b64_tr_b16 a[134:135], v161 offset:18688
s_waitcnt lgkmcnt(4)
v_mfma_f32_16x16x32_bf16 v[96:99], a[144:147], a[104:107], v[96:99]
ds_read_b64_tr_b16 a[136:137], v162 offset:16640
v_mfma_f32_16x16x32_bf16 v[100:103], a[144:147], a[108:111], v[100:103]
ds_read_b64_tr_b16 a[138:139], v162 offset:18688
v_mfma_f32_16x16x32_bf16 v[104:107], a[148:151], a[104:107], v[104:107]
ds_read_b64_tr_b16 a[140:141], v163 offset:16640
v_mfma_f32_16x16x32_bf16 v[108:111], a[148:151], a[108:111], v[108:111]
ds_read_b64_tr_b16 a[142:143], v163 offset:18688
v_mfma_f32_16x16x32_bf16 v[112:115], a[152:155], a[104:107], v[112:115]
ds_read_b64_tr_b16 a[144:145], v164 offset:16640
v_mfma_f32_16x16x32_bf16 v[116:119], a[152:155], a[108:111], v[116:119]
ds_read_b64_tr_b16 a[146:147], v164 offset:18688
v_mfma_f32_16x16x32_bf16 v[120:123], a[156:159], a[104:107], v[120:123]
ds_read_b64_tr_b16 a[148:149], v165 offset:16640
v_mfma_f32_16x16x32_bf16 v[124:127], a[156:159], a[108:111], v[124:127]
ds_read_b64_tr_b16 a[150:151], v165 offset:18688
s_waitcnt lgkmcnt(4)
v_mfma_f32_16x16x32_bf16 a[32:35], a[128:131], a[104:107], a[32:35]
ds_read_b64_tr_b16 a[152:153], v166 offset:16640
v_mfma_f32_16x16x32_bf16 a[36:39], a[128:131], a[108:111], a[36:39]
ds_read_b64_tr_b16 a[154:155], v166 offset:18688
v_mfma_f32_16x16x32_bf16 a[40:43], a[132:135], a[104:107], a[40:43]
ds_read_b64_tr_b16 a[156:157], v167 offset:16640
v_mfma_f32_16x16x32_bf16 a[44:47], a[132:135], a[108:111], a[44:47]
ds_read_b64_tr_b16 a[158:159], v167 offset:18688
v_mfma_f32_16x16x32_bf16 a[48:51], a[136:139], a[104:107], a[48:51]
s_waitcnt vmcnt(10)
s_barrier
ds_read_b64_tr_b16 a[128:129], v160 offset:32768
s_lshl_b32 s48, s80, 6
s_add_u32 m0, s40, 32768
s_add_u32 s48, s48, s81
v_mfma_f32_16x16x32_bf16 a[52:55], a[136:139], a[108:111], a[52:55]
ds_read_b64_tr_b16 a[130:131], v160 offset:34816
buffer_load_dwordx4 v169, s[12:15], s48 offen offset:0 lds
v_mfma_f32_16x16x32_bf16 a[56:59], a[140:143], a[104:107], a[56:59]
ds_read_b128 a[96:99], v168 offset:0
ds_read_b64_tr_b16 a[132:133], v161 offset:32768
s_lshl_b32 s49, s80, 18
v_mfma_f32_16x16x32_bf16 a[60:63], a[140:143], a[108:111], a[60:63]
ds_read_b64_tr_b16 a[134:135], v161 offset:34816
buffer_load_dwordx4 v170, s[12:15], s48 offen offset:1024 lds
s_waitcnt lgkmcnt(5)
v_mfma_f32_16x16x32_bf16 a[64:67], a[144:147], a[104:107], a[64:67]
ds_read_b128 a[100:103], v168 offset:1024
ds_read_b64_tr_b16 a[136:137], v162 offset:32768
s_add_u32 m0, s37, 98304
s_add_u32 s49, s49, s82
v_mfma_f32_16x16x32_bf16 a[68:71], a[144:147], a[108:111], a[68:71]
ds_read_b64_tr_b16 a[138:139], v162 offset:34816
buffer_load_dwordx4 v171, s[16:19], s49 offen offset:0 lds
v_mfma_f32_16x16x32_bf16 a[72:75], a[148:151], a[104:107], a[72:75]
ds_read_b64_tr_b16 a[140:141], v163 offset:32768
s_add_u32 s80, s80, 1
v_mfma_f32_16x16x32_bf16 a[76:79], a[148:151], a[108:111], a[76:79]
ds_read_b64_tr_b16 a[142:143], v163 offset:34816
buffer_load_dwordx4 v172, s[16:19], s49 offen offset:1024 lds
v_mfma_f32_16x16x32_bf16 a[80:83], a[152:155], a[104:107], a[80:83]
ds_read_b64_tr_b16 a[144:145], v164 offset:32768
s_cmp_eq_u32 s80, 16
s_cselect_b32 s80, 2, s80
v_mfma_f32_16x16x32_bf16 a[84:87], a[152:155], a[108:111], a[84:87]
ds_read_b64_tr_b16 a[146:147], v164 offset:34816
buffer_load_dwordx4 v173, s[16:19], s49 offen offset:2048 lds
v_mfma_f32_16x16x32_bf16 a[88:91], a[156:159], a[104:107], a[88:91]
ds_read_b64_tr_b16 a[148:149], v165 offset:32768
v_mfma_f32_16x16x32_bf16 a[92:95], a[156:159], a[108:111], a[92:95]
ds_read_b64_tr_b16 a[150:151], v165 offset:34816
buffer_load_dwordx4 v174, s[16:19], s49 offen offset:3072 lds
s_waitcnt lgkmcnt(4)
v_mfma_f32_16x16x32_bf16 v[64:67], a[128:131], a[96:99], v[64:67]
ds_read_b64_tr_b16 a[152:153], v166 offset:32768
v_mfma_f32_16x16x32_bf16 v[68:71], a[128:131], a[100:103], v[68:71]
ds_read_b64_tr_b16 a[154:155], v166 offset:34816
v_mfma_f32_16x16x32_bf16 v[72:75], a[132:135], a[96:99], v[72:75]
ds_read_b64_tr_b16 a[156:157], v167 offset:32768
v_mfma_f32_16x16x32_bf16 v[76:79], a[132:135], a[100:103], v[76:79]
ds_read_b64_tr_b16 a[158:159], v167 offset:34816
v_mfma_f32_16x16x32_bf16 v[80:83], a[136:139], a[96:99], v[80:83]
v_add_u32 v168, 8192, v168
ds_read_b64_tr_b16 a[128:129], v160 offset:33024
v_mfma_f32_16x16x32_bf16 v[84:87], a[136:139], a[100:103], v[84:87]
ds_read_b64_tr_b16 a[130:131], v160 offset:35072
v_mfma_f32_16x16x32_bf16 v[88:91], a[140:143], a[96:99], v[88:91]
ds_read_b64_tr_b16 a[132:133], v161 offset:33024
v_mfma_f32_16x16x32_bf16 v[92:95], a[140:143], a[100:103], v[92:95]
ds_read_b64_tr_b16 a[134:135], v161 offset:35072
s_waitcnt lgkmcnt(4)
v_mfma_f32_16x16x32_bf16 v[96:99], a[144:147], a[96:99], v[96:99]
ds_read_b64_tr_b16 a[136:137], v162 offset:33024
v_mfma_f32_16x16x32_bf16 v[100:103], a[144:147], a[100:103], v[100:103]
ds_read_b64_tr_b16 a[138:139], v162 offset:35072
v_mfma_f32_16x16x32_bf16 v[104:107], a[148:151], a[96:99], v[104:107]
ds_read_b64_tr_b16 a[140:141], v163 offset:33024
v_mfma_f32_16x16x32_bf16 v[108:111], a[148:151], a[100:103], v[108:111]
ds_read_b64_tr_b16 a[142:143], v163 offset:35072
v_mfma_f32_16x16x32_bf16 v[112:115], a[152:155], a[96:99], v[112:115]
ds_read_b64_tr_b16 a[144:145], v164 offset:33024
v_mfma_f32_16x16x32_bf16 v[116:119], a[152:155], a[100:103], v[116:119]
ds_read_b64_tr_b16 a[146:147], v164 offset:35072
v_mfma_f32_16x16x32_bf16 v[120:123], a[156:159], a[96:99], v[120:123]
ds_read_b64_tr_b16 a[148:149], v165 offset:33024
v_mfma_f32_16x16x32_bf16 v[124:127], a[156:159], a[100:103], v[124:127]
ds_read_b64_tr_b16 a[150:151], v165 offset:35072
s_waitcnt lgkmcnt(4)
v_mfma_f32_16x16x32_bf16 a[32:35], a[128:131], a[96:99], a[32:35]
ds_read_b64_tr_b16 a[152:153], v166 offset:33024
v_mfma_f32_16x16x32_bf16 a[36:39], a[128:131], a[100:103], a[36:39]
ds_read_b64_tr_b16 a[154:155], v166 offset:35072
v_mfma_f32_16x16x32_bf16 a[40:43], a[132:135], a[96:99], a[40:43]
ds_read_b64_tr_b16 a[156:157], v167 offset:33024
v_mfma_f32_16x16x32_bf16 a[44:47], a[132:135], a[100:103], a[44:47]
ds_read_b64_tr_b16 a[158:159], v167 offset:35072
v_mfma_f32_16x16x32_bf16 a[48:51], a[136:139], a[96:99], a[48:51]
s_waitcnt vmcnt(6)
s_barrier
ds_read_b64_tr_b16 a[128:129], v160 offset:49152
s_lshl_b32 s48, s80, 6
s_add_u32 m0, s40, 40960
s_add_u32 s48, s48, s81
v_mfma_f32_16x16x32_bf16 a[52:55], a[136:139], a[100:103], a[52:55]
ds_read_b64_tr_b16 a[130:131], v160 offset:51200
buffer_load_dwordx4 v169, s[12:15], s48 offen offset:0 lds
v_mfma_f32_16x16x32_bf16 a[56:59], a[140:143], a[96:99], a[56:59]
ds_read_b128 a[104:107], v168 offset:0
ds_read_b64_tr_b16 a[132:133], v161 offset:49152
s_lshl_b32 s49, s80, 18
v_mfma_f32_16x16x32_bf16 a[60:63], a[140:143], a[100:103], a[60:63]
ds_read_b64_tr_b16 a[134:135], v161 offset:51200
buffer_load_dwordx4 v170, s[12:15], s48 offen offset:1024 lds
s_waitcnt lgkmcnt(5)
v_mfma_f32_16x16x32_bf16 a[64:67], a[144:147], a[96:99], a[64:67]
ds_read_b128 a[108:111], v168 offset:1024
ds_read_b64_tr_b16 a[136:137], v162 offset:49152
s_add_u32 m0, s37, 114688
s_add_u32 s49, s49, s82
v_mfma_f32_16x16x32_bf16 a[68:71], a[144:147], a[100:103], a[68:71]
ds_read_b64_tr_b16 a[138:139], v162 offset:51200
buffer_load_dwordx4 v171, s[16:19], s49 offen offset:0 lds
v_mfma_f32_16x16x32_bf16 a[72:75], a[148:151], a[96:99], a[72:75]
ds_read_b64_tr_b16 a[140:141], v163 offset:49152
s_add_u32 s80, s80, 1
v_mfma_f32_16x16x32_bf16 a[76:79], a[148:151], a[100:103], a[76:79]
ds_read_b64_tr_b16 a[142:143], v163 offset:51200
buffer_load_dwordx4 v172, s[16:19], s49 offen offset:1024 lds
v_mfma_f32_16x16x32_bf16 a[80:83], a[152:155], a[96:99], a[80:83]
ds_read_b64_tr_b16 a[144:145], v164 offset:49152
s_cmp_eq_u32 s80, 16
s_cselect_b32 s80, 2, s80
v_mfma_f32_16x16x32_bf16 a[84:87], a[152:155], a[100:103], a[84:87]
ds_read_b64_tr_b16 a[146:147], v164 offset:51200
buffer_load_dwordx4 v173, s[16:19], s49 offen offset:2048 lds
v_mfma_f32_16x16x32_bf16 a[88:91], a[156:159], a[96:99], a[88:91]
ds_read_b64_tr_b16 a[148:149], v165 offset:49152
v_mfma_f32_16x16x32_bf16 a[92:95], a[156:159], a[100:103], a[92:95]
ds_read_b64_tr_b16 a[150:151], v165 offset:51200
buffer_load_dwordx4 v174, s[16:19], s49 offen offset:3072 lds
s_waitcnt lgkmcnt(4)
v_mfma_f32_16x16x32_bf16 v[64:67], a[128:131], a[104:107], v[64:67]
ds_read_b64_tr_b16 a[152:153], v166 offset:49152
v_mfma_f32_16x16x32_bf16 v[68:71], a[128:131], a[108:111], v[68:71]
ds_read_b64_tr_b16 a[154:155], v166 offset:51200
v_mfma_f32_16x16x32_bf16 v[72:75], a[132:135], a[104:107], v[72:75]
ds_read_b64_tr_b16 a[156:157], v167 offset:49152
v_mfma_f32_16x16x32_bf16 v[76:79], a[132:135], a[108:111], v[76:79]
ds_read_b64_tr_b16 a[158:159], v167 offset:51200
v_mfma_f32_16x16x32_bf16 v[80:83], a[136:139], a[104:107], v[80:83]
v_add_u32 v168, -24576, v168
ds_read_b64_tr_b16 a[128:129], v160 offset:49408
v_mfma_f32_16x16x32_bf16 v[84:87], a[136:139], a[108:111], v[84:87]
ds_read_b64_tr_b16 a[130:131], v160 offset:51456
v_mfma_f32_16x16x32_bf16 v[88:91], a[140:143], a[104:107], v[88:91]
ds_read_b64_tr_b16 a[132:133], v161 offset:49408
v_mfma_f32_16x16x32_bf16 v[92:95], a[140:143], a[108:111], v[92:95]
ds_read_b64_tr_b16 a[134:135], v161 offset:51456
s_waitcnt lgkmcnt(4)
v_mfma_f32_16x16x32_bf16 v[96:99], a[144:147], a[104:107], v[96:99]
ds_read_b64_tr_b16 a[136:137], v162 offset:49408
v_mfma_f32_16x16x32_bf16 v[100:103], a[144:147], a[108:111], v[100:103]
ds_read_b64_tr_b16 a[138:139], v162 offset:51456
v_mfma_f32_16x16x32_bf16 v[104:107], a[148:151], a[104:107], v[104:107]
ds_read_b64_tr_b16 a[140:141], v163 offset:49408
v_mfma_f32_16x16x32_bf16 v[108:111], a[148:151], a[108:111], v[108:111]
ds_read_b64_tr_b16 a[142:143], v163 offset:51456
v_mfma_f32_16x16x32_bf16 v[112:115], a[152:155], a[104:107], v[112:115]
ds_read_b64_tr_b16 a[144:145], v164 offset:49408
v_mfma_f32_16x16x32_bf16 v[116:119], a[152:155], a[108:111], v[116:119]
ds_read_b64_tr_b16 a[146:147], v164 offset:51456
v_mfma_f32_16x16x32_bf16 v[120:123], a[156:159], a[104:107], v[120:123]
ds_read_b64_tr_b16 a[148:149], v165 offset:49408
v_mfma_f32_16x16x32_bf16 v[124:127], a[156:159], a[108:111], v[124:127]
ds_read_b64_tr_b16 a[150:151], v165 offset:51456
s_waitcnt lgkmcnt(4)
v_mfma_f32_16x16x32_bf16 a[32:35], a[128:131], a[104:107], a[32:35]
ds_read_b64_tr_b16 a[152:153], v166 offset:49408
v_mfma_f32_16x16x32_bf16 a[36:39], a[128:131], a[108:111], a[36:39]
ds_read_b64_tr_b16 a[154:155], v166 offset:51456
v_mfma_f32_16x16x32_bf16 a[40:43], a[132:135], a[104:107], a[40:43]
ds_read_b64_tr_b16 a[156:157], v167 offset:49408
v_mfma_f32_16x16x32_bf16 a[44:47], a[132:135], a[108:111], a[44:47]
ds_read_b64_tr_b16 a[158:159], v167 offset:51456
v_mfma_f32_16x16x32_bf16 a[48:51], a[136:139], a[104:107], a[48:51]
s_waitcnt vmcnt(6)
s_barrier
ds_read_b64_tr_b16 a[128:129], v160 offset:0
s_lshl_b32 s48, s80, 6
s_add_u32 m0, s40, 49152
s_add_u32 s48, s48, s81
v_mfma_f32_16x16x32_bf16 a[52:55], a[136:139], a[108:111], a[52:55]
ds_read_b64_tr_b16 a[130:131], v160 offset:2048
buffer_load_dwordx4 v169, s[12:15], s48 offen offset:0 lds
v_mfma_f32_16x16x32_bf16 a[56:59], a[140:143], a[104:107], a[56:59]
ds_read_b128 a[96:99], v168 offset:0
ds_read_b64_tr_b16 a[132:133], v161 offset:0
s_lshl_b32 s49, s80, 18
v_mfma_f32_16x16x32_bf16 a[60:63], a[140:143], a[108:111], a[60:63]
ds_read_b64_tr_b16 a[134:135], v161 offset:2048
buffer_load_dwordx4 v170, s[12:15], s48 offen offset:1024 lds
s_waitcnt lgkmcnt(5)
v_mfma_f32_16x16x32_bf16 a[64:67], a[144:147], a[104:107], a[64:67]
ds_read_b128 a[100:103], v168 offset:1024
ds_read_b64_tr_b16 a[136:137], v162 offset:0
s_add_u32 m0, s37, 131072
s_add_u32 s49, s49, s82
v_mfma_f32_16x16x32_bf16 a[68:71], a[144:147], a[108:111], a[68:71]
ds_read_b64_tr_b16 a[138:139], v162 offset:2048
buffer_load_dwordx4 v171, s[16:19], s49 offen offset:0 lds
v_mfma_f32_16x16x32_bf16 a[72:75], a[148:151], a[104:107], a[72:75]
ds_read_b64_tr_b16 a[140:141], v163 offset:0
s_add_u32 s80, s80, 1
v_mfma_f32_16x16x32_bf16 a[76:79], a[148:151], a[108:111], a[76:79]
ds_read_b64_tr_b16 a[142:143], v163 offset:2048
buffer_load_dwordx4 v172, s[16:19], s49 offen offset:1024 lds
v_mfma_f32_16x16x32_bf16 a[80:83], a[152:155], a[104:107], a[80:83]
ds_read_b64_tr_b16 a[144:145], v164 offset:0
s_cmp_eq_u32 s80, 16
s_cselect_b32 s80, 2, s80
v_mfma_f32_16x16x32_bf16 a[84:87], a[152:155], a[108:111], a[84:87]
ds_read_b64_tr_b16 a[146:147], v164 offset:2048
buffer_load_dwordx4 v173, s[16:19], s49 offen offset:2048 lds
v_mfma_f32_16x16x32_bf16 a[88:91], a[156:159], a[104:107], a[88:91]
ds_read_b64_tr_b16 a[148:149], v165 offset:0
v_mfma_f32_16x16x32_bf16 a[92:95], a[156:159], a[108:111], a[92:95]
ds_read_b64_tr_b16 a[150:151], v165 offset:2048
buffer_load_dwordx4 v174, s[16:19], s49 offen offset:3072 lds
s_waitcnt lgkmcnt(4)
v_mfma_f32_16x16x32_bf16 v[64:67], a[128:131], a[96:99], v[64:67]
ds_read_b64_tr_b16 a[152:153], v166 offset:0
v_mfma_f32_16x16x32_bf16 v[68:71], a[128:131], a[100:103], v[68:71]
ds_read_b64_tr_b16 a[154:155], v166 offset:2048
v_mfma_f32_16x16x32_bf16 v[72:75], a[132:135], a[96:99], v[72:75]
ds_read_b64_tr_b16 a[156:157], v167 offset:0
v_mfma_f32_16x16x32_bf16 v[76:79], a[132:135], a[100:103], v[76:79]
ds_read_b64_tr_b16 a[158:159], v167 offset:2048
v_mfma_f32_16x16x32_bf16 v[80:83], a[136:139], a[96:99], v[80:83]
v_add_u32 v168, 8192, v168
ds_read_b64_tr_b16 a[128:129], v160 offset:256
v_mfma_f32_16x16x32_bf16 v[84:87], a[136:139], a[100:103], v[84:87]
ds_read_b64_tr_b16 a[130:131], v160 offset:2304
v_mfma_f32_16x16x32_bf16 v[88:91], a[140:143], a[96:99], v[88:91]
ds_read_b64_tr_b16 a[132:133], v161 offset:256
v_mfma_f32_16x16x32_bf16 v[92:95], a[140:143], a[100:103], v[92:95]
ds_read_b64_tr_b16 a[134:135], v161 offset:2304
s_waitcnt lgkmcnt(4)
v_mfma_f32_16x16x32_bf16 v[96:99], a[144:147], a[96:99], v[96:99]
ds_read_b64_tr_b16 a[136:137], v162 offset:256
v_mfma_f32_16x16x32_bf16 v[100:103], a[144:147], a[100:103], v[100:103]
ds_read_b64_tr_b16 a[138:139], v162 offset:2304
v_mfma_f32_16x16x32_bf16 v[104:107], a[148:151], a[96:99], v[104:107]
ds_read_b64_tr_b16 a[140:141], v163 offset:256
v_mfma_f32_16x16x32_bf16 v[108:111], a[148:151], a[100:103], v[108:111]
ds_read_b64_tr_b16 a[142:143], v163 offset:2304
v_mfma_f32_16x16x32_bf16 v[112:115], a[152:155], a[96:99], v[112:115]
ds_read_b64_tr_b16 a[144:145], v164 offset:256
v_mfma_f32_16x16x32_bf16 v[116:119], a[152:155], a[100:103], v[116:119]
ds_read_b64_tr_b16 a[146:147], v164 offset:2304
v_mfma_f32_16x16x32_bf16 v[120:123], a[156:159], a[96:99], v[120:123]
ds_read_b64_tr_b16 a[148:149], v165 offset:256
v_mfma_f32_16x16x32_bf16 v[124:127], a[156:159], a[100:103], v[124:127]
ds_read_b64_tr_b16 a[150:151], v165 offset:2304
s_waitcnt lgkmcnt(4)
v_mfma_f32_16x16x32_bf16 a[32:35], a[128:131], a[96:99], a[32:35]
ds_read_b64_tr_b16 a[152:153], v166 offset:256
v_mfma_f32_16x16x32_bf16 a[36:39], a[128:131], a[100:103], a[36:39]
ds_read_b64_tr_b16 a[154:155], v166 offset:2304
v_mfma_f32_16x16x32_bf16 a[40:43], a[132:135], a[96:99], a[40:43]
ds_read_b64_tr_b16 a[156:157], v167 offset:256
v_mfma_f32_16x16x32_bf16 a[44:47], a[132:135], a[100:103], a[44:47]
ds_read_b64_tr_b16 a[158:159], v167 offset:2304
v_mfma_f32_16x16x32_bf16 a[48:51], a[136:139], a[96:99], a[48:51]
s_waitcnt vmcnt(6)
s_barrier
ds_read_b64_tr_b16 a[128:129], v160 offset:16384
s_lshl_b32 s48, s80, 6
s_add_u32 m0, s40, 57344
s_add_u32 s48, s48, s81
v_mfma_f32_16x16x32_bf16 a[52:55], a[136:139], a[100:103], a[52:55]
ds_read_b64_tr_b16 a[130:131], v160 offset:18432
buffer_load_dwordx4 v169, s[12:15], s48 offen offset:0 lds
v_mfma_f32_16x16x32_bf16 a[56:59], a[140:143], a[96:99], a[56:59]
ds_read_b128 a[104:107], v168 offset:0
ds_read_b64_tr_b16 a[132:133], v161 offset:16384
s_lshl_b32 s49, s80, 18
v_mfma_f32_16x16x32_bf16 a[60:63], a[140:143], a[100:103], a[60:63]
ds_read_b64_tr_b16 a[134:135], v161 offset:18432
buffer_load_dwordx4 v170, s[12:15], s48 offen offset:1024 lds
s_waitcnt lgkmcnt(5)
v_mfma_f32_16x16x32_bf16 a[64:67], a[144:147], a[96:99], a[64:67]
ds_read_b128 a[108:111], v168 offset:1024
ds_read_b64_tr_b16 a[136:137], v162 offset:16384
s_add_u32 m0, s37, 147456
s_add_u32 s49, s49, s82
v_mfma_f32_16x16x32_bf16 a[68:71], a[144:147], a[100:103], a[68:71]
ds_read_b64_tr_b16 a[138:139], v162 offset:18432
buffer_load_dwordx4 v171, s[16:19], s49 offen offset:0 lds
v_mfma_f32_16x16x32_bf16 a[72:75], a[148:151], a[96:99], a[72:75]
ds_read_b64_tr_b16 a[140:141], v163 offset:16384
s_add_u32 s80, s80, 1
v_mfma_f32_16x16x32_bf16 a[76:79], a[148:151], a[100:103], a[76:79]
ds_read_b64_tr_b16 a[142:143], v163 offset:18432
buffer_load_dwordx4 v172, s[16:19], s49 offen offset:1024 lds
v_mfma_f32_16x16x32_bf16 a[80:83], a[152:155], a[96:99], a[80:83]
ds_read_b64_tr_b16 a[144:145], v164 offset:16384
s_cmp_eq_u32 s80, 16
s_cselect_b32 s80, 2, s80
v_mfma_f32_16x16x32_bf16 a[84:87], a[152:155], a[100:103], a[84:87]
ds_read_b64_tr_b16 a[146:147], v164 offset:18432
buffer_load_dwordx4 v173, s[16:19], s49 offen offset:2048 lds
v_mfma_f32_16x16x32_bf16 a[88:91], a[156:159], a[96:99], a[88:91]
ds_read_b64_tr_b16 a[148:149], v165 offset:16384
v_mfma_f32_16x16x32_bf16 a[92:95], a[156:159], a[100:103], a[92:95]
ds_read_b64_tr_b16 a[150:151], v165 offset:18432
buffer_load_dwordx4 v174, s[16:19], s49 offen offset:3072 lds
s_waitcnt lgkmcnt(4)
v_mfma_f32_16x16x32_bf16 v[64:67], a[128:131], a[104:107], v[64:67]
ds_read_b64_tr_b16 a[152:153], v166 offset:16384
v_mfma_f32_16x16x32_bf16 v[68:71], a[128:131], a[108:111], v[68:71]
ds_read_b64_tr_b16 a[154:155], v166 offset:18432
v_mfma_f32_16x16x32_bf16 v[72:75], a[132:135], a[104:107], v[72:75]
ds_read_b64_tr_b16 a[156:157], v167 offset:16384
v_mfma_f32_16x16x32_bf16 v[76:79], a[132:135], a[108:111], v[76:79]
ds_read_b64_tr_b16 a[158:159], v167 offset:18432
v_mfma_f32_16x16x32_bf16 v[80:83], a[136:139], a[104:107], v[80:83]
v_add_u32 v168, 8192, v168
ds_read_b64_tr_b16 a[128:129], v160 offset:16640
v_mfma_f32_16x16x32_bf16 v[84:87], a[136:139], a[108:111], v[84:87]
ds_read_b64_tr_b16 a[130:131], v160 offset:18688
v_mfma_f32_16x16x32_bf16 v[88:91], a[140:143], a[104:107], v[88:91]
ds_read_b64_tr_b16 a[132:133], v161 offset:16640
v_mfma_f32_16x16x32_bf16 v[92:95], a[140:143], a[108:111], v[92:95]
ds_read_b64_tr_b16 a[134:135], v161 offset:18688
s_waitcnt lgkmcnt(4)
v_mfma_f32_16x16x32_bf16 v[96:99], a[144:147], a[104:107], v[96:99]
ds_read_b64_tr_b16 a[136:137], v162 offset:16640
v_mfma_f32_16x16x32_bf16 v[100:103], a[144:147], a[108:111], v[100:103]
ds_read_b64_tr_b16 a[138:139], v162 offset:18688
v_mfma_f32_16x16x32_bf16 v[104:107], a[148:151], a[104:107], v[104:107]
ds_read_b64_tr_b16 a[140:141], v163 offset:16640
v_mfma_f32_16x16x32_bf16 v[108:111], a[148:151], a[108:111], v[108:111]
ds_read_b64_tr_b16 a[142:143], v163 offset:18688
v_mfma_f32_16x16x32_bf16 v[112:115], a[152:155], a[104:107], v[112:115]
ds_read_b64_tr_b16 a[144:145], v164 offset:16640
v_mfma_f32_16x16x32_bf16 v[116:119], a[152:155], a[108:111], v[116:119]
ds_read_b64_tr_b16 a[146:147], v164 offset:18688
v_mfma_f32_16x16x32_bf16 v[120:123], a[156:159], a[104:107], v[120:123]
ds_read_b64_tr_b16 a[148:149], v165 offset:16640
v_mfma_f32_16x16x32_bf16 v[124:127], a[156:159], a[108:111], v[124:127]
ds_read_b64_tr_b16 a[150:151], v165 offset:18688
s_waitcnt lgkmcnt(4)
v_mfma_f32_16x16x32_bf16 a[32:35], a[128:131], a[104:107], a[32:35]
ds_read_b64_tr_b16 a[152:153], v166 offset:16640
v_mfma_f32_16x16x32_bf16 a[36:39], a[128:131], a[108:111], a[36:39]
ds_read_b64_tr_b16 a[154:155], v166 offset:18688
v_mfma_f32_16x16x32_bf16 a[40:43], a[132:135], a[104:107], a[40:43]
ds_read_b64_tr_b16 a[156:157], v167 offset:16640
v_mfma_f32_16x16x32_bf16 a[44:47], a[132:135], a[108:111], a[44:47]
ds_read_b64_tr_b16 a[158:159], v167 offset:18688
v_mfma_f32_16x16x32_bf16 a[48:51], a[136:139], a[104:107], a[48:51]
s_waitcnt vmcnt(6)
s_barrier
ds_read_b64_tr_b16 a[128:129], v160 offset:32768
s_lshl_b32 s48, s80, 6
s_add_u32 m0, s40, 32768
s_add_u32 s48, s48, s81
v_mfma_f32_16x16x32_bf16 a[52:55], a[136:139], a[108:111], a[52:55]
ds_read_b64_tr_b16 a[130:131], v160 offset:34816
buffer_load_dwordx4 v169, s[12:15], s48 offen offset:0 lds
v_mfma_f32_16x16x32_bf16 a[56:59], a[140:143], a[104:107], a[56:59]
ds_read_b128 a[96:99], v168 offset:0
ds_read_b64_tr_b16 a[132:133], v161 offset:32768
s_lshl_b32 s49, s80, 18
v_mfma_f32_16x16x32_bf16 a[60:63], a[140:143], a[108:111], a[60:63]
ds_read_b64_tr_b16 a[134:135], v161 offset:34816
buffer_load_dwordx4 v170, s[12:15], s48 offen offset:1024 lds
s_waitcnt lgkmcnt(5)
v_mfma_f32_16x16x32_bf16 a[64:67], a[144:147], a[104:107], a[64:67]
ds_read_b128 a[100:103], v168 offset:1024
ds_read_b64_tr_b16 a[136:137], v162 offset:32768
s_add_u32 m0, s37, 98304
s_add_u32 s49, s49, s82
v_mfma_f32_16x16x32_bf16 a[68:71], a[144:147], a[108:111], a[68:71]
ds_read_b64_tr_b16 a[138:139], v162 offset:34816
buffer_load_dwordx4 v171, s[16:19], s49 offen offset:0 lds
v_mfma_f32_16x16x32_bf16 a[72:75], a[148:151], a[104:107], a[72:75]
ds_read_b64_tr_b16 a[140:141], v163 offset:32768
s_add_u32 s80, s80, 1
v_mfma_f32_16x16x32_bf16 a[76:79], a[148:151], a[108:111], a[76:79]
ds_read_b64_tr_b16 a[142:143], v163 offset:34816
buffer_load_dwordx4 v172, s[16:19], s49 offen offset:1024 lds
v_mfma_f32_16x16x32_bf16 a[80:83], a[152:155], a[104:107], a[80:83]
ds_read_b64_tr_b16 a[144:145], v164 offset:32768
s_cmp_eq_u32 s80, 16
s_cselect_b32 s80, 2, s80
v_mfma_f32_16x16x32_bf16 a[84:87], a[152:155], a[108:111], a[84:87]
ds_read_b64_tr_b16 a[146:147], v164 offset:34816
buffer_load_dwordx4 v173, s[16:19], s49 offen offset:2048 lds
v_mfma_f32_16x16x32_bf16 a[88:91], a[156:159], a[104:107], a[88:91]
ds_read_b64_tr_b16 a[148:149], v165 offset:32768
v_mfma_f32_16x16x32_bf16 a[92:95], a[156:159], a[108:111], a[92:95]
ds_read_b64_tr_b16 a[150:151], v165 offset:34816
buffer_load_dwordx4 v174, s[16:19], s49 offen offset:3072 lds
s_waitcnt lgkmcnt(4)
v_mfma_f32_16x16x32_bf16 v[64:67], a[128:131], a[96:99], v[64:67]
ds_read_b64_tr_b16 a[152:153], v166 offset:32768
s_add_u32 m0, s37, 0
s_nop 0
v_mfma_f32_16x16x32_bf16 v[68:71], a[128:131], a[100:103], v[68:71]
ds_read_b64_tr_b16 a[154:155], v166 offset:34816
buffer_load_dwordx4 v28, s[4:7], s38 offen offset:0 nt lds
v_mfma_f32_16x16x32_bf16 v[72:75], a[132:135], a[96:99], v[72:75]
ds_read_b64_tr_b16 a[156:157], v167 offset:32768
v_mfma_f32_16x16x32_bf16 v[76:79], a[132:135], a[100:103], v[76:79]
ds_read_b64_tr_b16 a[158:159], v167 offset:34816
buffer_load_dwordx4 v29, s[4:7], s38 offen offset:1024 nt lds
v_mfma_f32_16x16x32_bf16 v[80:83], a[136:139], a[96:99], v[80:83]
v_add_u32 v168, 8192, v168
ds_read_b64_tr_b16 a[128:129], v160 offset:33024
v_mfma_f32_16x16x32_bf16 v[84:87], a[136:139], a[100:103], v[84:87]
ds_read_b64_tr_b16 a[130:131], v160 offset:35072
buffer_load_dwordx4 v30, s[4:7], s38 offen offset:2048 nt lds
v_mfma_f32_16x16x32_bf16 v[88:91], a[140:143], a[96:99], v[88:91]
ds_read_b64_tr_b16 a[132:133], v161 offset:33024
v_mfma_f32_16x16x32_bf16 v[92:95], a[140:143], a[100:103], v[92:95]
ds_read_b64_tr_b16 a[134:135], v161 offset:35072
buffer_load_dwordx4 v31, s[4:7], s38 offen offset:3072 nt lds
s_add_u32 s38, s38, 16384
s_waitcnt lgkmcnt(4)
v_mfma_f32_16x16x32_bf16 v[96:99], a[144:147], a[96:99], v[96:99]
ds_read_b64_tr_b16 a[136:137], v162 offset:33024
v_mfma_f32_16x16x32_bf16 v[100:103], a[144:147], a[100:103], v[100:103]
ds_read_b64_tr_b16 a[138:139], v162 offset:35072
v_mfma_f32_16x16x32_bf16 v[104:107], a[148:151], a[96:99], v[104:107]
ds_read_b64_tr_b16 a[140:141], v163 offset:33024
v_mfma_f32_16x16x32_bf16 v[108:111], a[148:151], a[100:103], v[108:111]
ds_read_b64_tr_b16 a[142:143], v163 offset:35072
v_mfma_f32_16x16x32_bf16 v[112:115], a[152:155], a[96:99], v[112:115]
ds_read_b64_tr_b16 a[144:145], v164 offset:33024
v_mfma_f32_16x16x32_bf16 v[116:119], a[152:155], a[100:103], v[116:119]
ds_read_b64_tr_b16 a[146:147], v164 offset:35072
v_mfma_f32_16x16x32_bf16 v[120:123], a[156:159], a[96:99], v[120:123]
ds_read_b64_tr_b16 a[148:149], v165 offset:33024
v_mfma_f32_16x16x32_bf16 v[124:127], a[156:159], a[100:103], v[124:127]
ds_read_b64_tr_b16 a[150:151], v165 offset:35072
s_waitcnt lgkmcnt(4)
v_mfma_f32_16x16x32_bf16 a[32:35], a[128:131], a[96:99], a[32:35]
ds_read_b64_tr_b16 a[152:153], v166 offset:33024
v_mfma_f32_16x16x32_bf16 a[36:39], a[128:131], a[100:103], a[36:39]
ds_read_b64_tr_b16 a[154:155], v166 offset:35072
v_mfma_f32_16x16x32_bf16 a[40:43], a[132:135], a[96:99], a[40:43]
ds_read_b64_tr_b16 a[156:157], v167 offset:33024
v_mfma_f32_16x16x32_bf16 a[44:47], a[132:135], a[100:103], a[44:47]
ds_read_b64_tr_b16 a[158:159], v167 offset:35072
v_mfma_f32_16x16x32_bf16 a[48:51], a[136:139], a[96:99], a[48:51]
s_waitcnt vmcnt(10)
s_barrier
ds_read_b64_tr_b16 a[128:129], v160 offset:49152
s_lshl_b32 s48, s80, 6
s_add_u32 m0, s40, 40960
s_add_u32 s48, s48, s81
v_mfma_f32_16x16x32_bf16 a[52:55], a[136:139], a[100:103], a[52:55]
ds_read_b64_tr_b16 a[130:131], v160 offset:51200
buffer_load_dwordx4 v169, s[12:15], s48 offen offset:0 lds
v_mfma_f32_16x16x32_bf16 a[56:59], a[140:143], a[96:99], a[56:59]
ds_read_b128 a[104:107], v168 offset:0
ds_read_b64_tr_b16 a[132:133], v161 offset:49152
s_lshl_b32 s49, s80, 18
v_mfma_f32_16x16x32_bf16 a[60:63], a[140:143], a[100:103], a[60:63]
ds_read_b64_tr_b16 a[134:135], v161 offset:51200
buffer_load_dwordx4 v170, s[12:15], s48 offen offset:1024 lds
s_waitcnt lgkmcnt(5)
v_mfma_f32_16x16x32_bf16 a[64:67], a[144:147], a[96:99], a[64:67]
ds_read_b128 a[108:111], v168 offset:1024
ds_read_b64_tr_b16 a[136:137], v162 offset:49152
s_add_u32 m0, s37, 114688
s_add_u32 s49, s49, s82
v_mfma_f32_16x16x32_bf16 a[68:71], a[144:147], a[100:103], a[68:71]
ds_read_b64_tr_b16 a[138:139], v162 offset:51200
buffer_load_dwordx4 v171, s[16:19], s49 offen offset:0 lds
v_mfma_f32_16x16x32_bf16 a[72:75], a[148:151], a[96:99], a[72:75]
ds_read_b64_tr_b16 a[140:141], v163 offset:49152
s_add_u32 s80, s80, 1
v_mfma_f32_16x16x32_bf16 a[76:79], a[148:151], a[100:103], a[76:79]
ds_read_b64_tr_b16 a[142:143], v163 offset:51200
buffer_load_dwordx4 v172, s[16:19], s49 offen offset:1024 lds
v_mfma_f32_16x16x32_bf16 a[80:83], a[152:155], a[96:99], a[80:83]
ds_read_b64_tr_b16 a[144:145], v164 offset:49152
s_cmp_eq_u32 s80, 16
s_cselect_b32 s80, 2, s80
v_mfma_f32_16x16x32_bf16 a[84:87], a[152:155], a[100:103], a[84:87]
ds_read_b64_tr_b16 a[146:147], v164 offset:51200
buffer_load_dwordx4 v173, s[16:19], s49 offen offset:2048 lds
v_mfma_f32_16x16x32_bf16 a[88:91], a[156:159], a[96:99], a[88:91]
ds_read_b64_tr_b16 a[148:149], v165 offset:49152
v_mfma_f32_16x16x32_bf16 a[92:95], a[156:159], a[100:103], a[92:95]
ds_read_b64_tr_b16 a[150:151], v165 offset:51200
buffer_load_dwordx4 v174, s[16:19], s49 offen offset:3072 lds
s_waitcnt lgkmcnt(4)
v_mfma_f32_16x16x32_bf16 v[64:67], a[128:131], a[104:107], v[64:67]
ds_read_b64_tr_b16 a[152:153], v166 offset:49152
v_mfma_f32_16x16x32_bf16 v[68:71], a[128:131], a[108:111], v[68:71]
ds_read_b64_tr_b16 a[154:155], v166 offset:51200
v_mfma_f32_16x16x32_bf16 v[72:75], a[132:135], a[104:107], v[72:75]
ds_read_b64_tr_b16 a[156:157], v167 offset:49152
v_mfma_f32_16x16x32_bf16 v[76:79], a[132:135], a[108:111], v[76:79]
ds_read_b64_tr_b16 a[158:159], v167 offset:51200
v_mfma_f32_16x16x32_bf16 v[80:83], a[136:139], a[104:107], v[80:83]
v_add_u32 v168, -24576, v168
ds_read_b64_tr_b16 a[128:129], v160 offset:49408
v_mfma_f32_16x16x32_bf16 v[84:87], a[136:139], a[108:111], v[84:87]
ds_read_b64_tr_b16 a[130:131], v160 offset:51456
v_mfma_f32_16x16x32_bf16 v[88:91], a[140:143], a[104:107], v[88:91]
ds_read_b64_tr_b16 a[132:133], v161 offset:49408
v_mfma_f32_16x16x32_bf16 v[92:95], a[140:143], a[108:111], v[92:95]
ds_read_b64_tr_b16 a[134:135], v161 offset:51456
s_waitcnt lgkmcnt(4)
v_mfma_f32_16x16x32_bf16 v[96:99], a[144:147], a[104:107], v[96:99]
ds_read_b64_tr_b16 a[136:137], v162 offset:49408
v_mfma_f32_16x16x32_bf16 v[100:103], a[144:147], a[108:111], v[100:103]
ds_read_b64_tr_b16 a[138:139], v162 offset:51456
v_mfma_f32_16x16x32_bf16 v[104:107], a[148:151], a[104:107], v[104:107]
ds_read_b64_tr_b16 a[140:141], v163 offset:49408
v_mfma_f32_16x16x32_bf16 v[108:111], a[148:151], a[108:111], v[108:111]
ds_read_b64_tr_b16 a[142:143], v163 offset:51456
v_mfma_f32_16x16x32_bf16 v[112:115], a[152:155], a[104:107], v[112:115]
ds_read_b64_tr_b16 a[144:145], v164 offset:49408
v_mfma_f32_16x16x32_bf16 v[116:119], a[152:155], a[108:111], v[116:119]
ds_read_b64_tr_b16 a[146:147], v164 offset:51456
v_mfma_f32_16x16x32_bf16 v[120:123], a[156:159], a[104:107], v[120:123]
ds_read_b64_tr_b16 a[148:149], v165 offset:49408
v_mfma_f32_16x16x32_bf16 v[124:127], a[156:159], a[108:111], v[124:127]
ds_read_b64_tr_b16 a[150:151], v165 offset:51456
s_waitcnt lgkmcnt(4)
v_mfma_f32_16x16x32_bf16 a[32:35], a[128:131], a[104:107], a[32:35]
ds_read_b64_tr_b16 a[152:153], v166 offset:49408
v_mfma_f32_16x16x32_bf16 a[36:39], a[128:131], a[108:111], a[36:39]
ds_read_b64_tr_b16 a[154:155], v166 offset:51456
v_mfma_f32_16x16x32_bf16 a[40:43], a[132:135], a[104:107], a[40:43]
ds_read_b64_tr_b16 a[156:157], v167 offset:49408
v_mfma_f32_16x16x32_bf16 a[44:47], a[132:135], a[108:111], a[44:47]
ds_read_b64_tr_b16 a[158:159], v167 offset:51456
v_mfma_f32_16x16x32_bf16 a[48:51], a[136:139], a[104:107], a[48:51]
s_waitcnt vmcnt(10)
s_barrier
ds_read_b64_tr_b16 a[128:129], v160 offset:0
s_lshl_b32 s48, s80, 6
s_add_u32 m0, s40, 49152
s_add_u32 s48, s48, s81
v_mfma_f32_16x16x32_bf16 a[52:55], a[136:139], a[108:111], a[52:55]
ds_read_b64_tr_b16 a[130:131], v160 offset:2048
buffer_load_dwordx4 v169, s[12:15], s48 offen offset:0 lds
v_mfma_f32_16x16x32_bf16 a[56:59], a[140:143], a[104:107], a[56:59]
ds_read_b128 a[96:99], v168 offset:0
ds_read_b64_tr_b16 a[132:133], v161 offset:0
s_lshl_b32 s49, s80, 18
v_mfma_f32_16x16x32_bf16 a[60:63], a[140:143], a[108:111], a[60:63]
ds_read_b64_tr_b16 a[134:135], v161 offset:2048
buffer_load_dwordx4 v170, s[12:15], s48 offen offset:1024 lds
s_waitcnt lgkmcnt(5)
v_mfma_f32_16x16x32_bf16 a[64:67], a[144:147], a[104:107], a[64:67]
ds_read_b128 a[100:103], v168 offset:1024
ds_read_b64_tr_b16 a[136:137], v162 offset:0
s_add_u32 m0, s37, 131072
s_add_u32 s49, s49, s82
v_mfma_f32_16x16x32_bf16 a[68:71], a[144:147], a[108:111], a[68:71]
ds_read_b64_tr_b16 a[138:139], v162 offset:2048
buffer_load_dwordx4 v171, s[16:19], s49 offen offset:0 lds
v_mfma_f32_16x16x32_bf16 a[72:75], a[148:151], a[104:107], a[72:75]
ds_read_b64_tr_b16 a[140:141], v163 offset:0
s_add_u32 s80, s80, 1
v_mfma_f32_16x16x32_bf16 a[76:79], a[148:151], a[108:111], a[76:79]
ds_read_b64_tr_b16 a[142:143], v163 offset:2048
buffer_load_dwordx4 v172, s[16:19], s49 offen offset:1024 lds
v_mfma_f32_16x16x32_bf16 a[80:83], a[152:155], a[104:107], a[80:83]
ds_read_b64_tr_b16 a[144:145], v164 offset:0
s_cmp_eq_u32 s80, 16
s_cselect_b32 s80, 2, s80
v_mfma_f32_16x16x32_bf16 a[84:87], a[152:155], a[108:111], a[84:87]
ds_read_b64_tr_b16 a[146:147], v164 offset:2048
buffer_load_dwordx4 v173, s[16:19], s49 offen offset:2048 lds
v_mfma_f32_16x16x32_bf16 a[88:91], a[156:159], a[104:107], a[88:91]
ds_read_b64_tr_b16 a[148:149], v165 offset:0
v_mfma_f32_16x16x32_bf16 a[92:95], a[156:159], a[108:111], a[92:95]
ds_read_b64_tr_b16 a[150:151], v165 offset:2048
buffer_load_dwordx4 v174, s[16:19], s49 offen offset:3072 lds
s_waitcnt lgkmcnt(4)
v_mfma_f32_16x16x32_bf16 v[64:67], a[128:131], a[96:99], v[64:67]
ds_read_b64_tr_b16 a[152:153], v166 offset:0
s_add_u32 m0, s37, 16384
s_nop 0
v_mfma_f32_16x16x32_bf16 v[68:71], a[128:131], a[100:103], v[68:71]
ds_read_b64_tr_b16 a[154:155], v166 offset:2048
buffer_load_dwordx4 v28, s[4:7], s38 offen offset:0 nt lds
v_mfma_f32_16x16x32_bf16 v[72:75], a[132:135], a[96:99], v[72:75]
ds_read_b64_tr_b16 a[156:157], v167 offset:0
v_mfma_f32_16x16x32_bf16 v[76:79], a[132:135], a[100:103], v[76:79]
ds_read_b64_tr_b16 a[158:159], v167 offset:2048
buffer_load_dwordx4 v29, s[4:7], s38 offen offset:1024 nt lds
v_mfma_f32_16x16x32_bf16 v[80:83], a[136:139], a[96:99], v[80:83]
v_add_u32 v168, 8192, v168
ds_read_b64_tr_b16 a[128:129], v160 offset:256
v_mfma_f32_16x16x32_bf16 v[84:87], a[136:139], a[100:103], v[84:87]
ds_read_b64_tr_b16 a[130:131], v160 offset:2304
buffer_load_dwordx4 v30, s[4:7], s38 offen offset:2048 nt lds
v_mfma_f32_16x16x32_bf16 v[88:91], a[140:143], a[96:99], v[88:91]
ds_read_b64_tr_b16 a[132:133], v161 offset:256
v_mfma_f32_16x16x32_bf16 v[92:95], a[140:143], a[100:103], v[92:95]
ds_read_b64_tr_b16 a[134:135], v161 offset:2304
buffer_load_dwordx4 v31, s[4:7], s38 offen offset:3072 nt lds
s_add_u32 s38, s38, 16384
s_waitcnt lgkmcnt(4)
v_mfma_f32_16x16x32_bf16 v[96:99], a[144:147], a[96:99], v[96:99]
ds_read_b64_tr_b16 a[136:137], v162 offset:256
v_mfma_f32_16x16x32_bf16 v[100:103], a[144:147], a[100:103], v[100:103]
ds_read_b64_tr_b16 a[138:139], v162 offset:2304
v_mfma_f32_16x16x32_bf16 v[104:107], a[148:151], a[96:99], v[104:107]
ds_read_b64_tr_b16 a[140:141], v163 offset:256
v_mfma_f32_16x16x32_bf16 v[108:111], a[148:151], a[100:103], v[108:111]
ds_read_b64_tr_b16 a[142:143], v163 offset:2304
v_mfma_f32_16x16x32_bf16 v[112:115], a[152:155], a[96:99], v[112:115]
ds_read_b64_tr_b16 a[144:145], v164 offset:256
v_mfma_f32_16x16x32_bf16 v[116:119], a[152:155], a[100:103], v[116:119]
ds_read_b64_tr_b16 a[146:147], v164 offset:2304
v_mfma_f32_16x16x32_bf16 v[120:123], a[156:159], a[96:99], v[120:123]
ds_read_b64_tr_b16 a[148:149], v165 offset:256
v_mfma_f32_16x16x32_bf16 v[124:127], a[156:159], a[100:103], v[124:127]
ds_read_b64_tr_b16 a[150:151], v165 offset:2304
s_waitcnt lgkmcnt(4)
v_mfma_f32_16x16x32_bf16 a[32:35], a[128:131], a[96:99], a[32:35]
ds_read_b64_tr_b16 a[152:153], v166 offset:256
v_mfma_f32_16x16x32_bf16 a[36:39], a[128:131], a[100:103], a[36:39]
ds_read_b64_tr_b16 a[154:155], v166 offset:2304
v_mfma_f32_16x16x32_bf16 a[40:43], a[132:135], a[96:99], a[40:43]
ds_read_b64_tr_b16 a[156:157], v167 offset:256
v_mfma_f32_16x16x32_bf16 a[44:47], a[132:135], a[100:103], a[44:47]
ds_read_b64_tr_b16 a[158:159], v167 offset:2304
v_mfma_f32_16x16x32_bf16 a[48:51], a[136:139], a[96:99], a[48:51]
s_waitcnt vmcnt(10)
s_barrier
ds_read_b64_tr_b16 a[128:129], v160 offset:16384
s_lshl_b32 s48, s80, 6
s_add_u32 m0, s40, 57344
s_add_u32 s48, s48, s81
v_mfma_f32_16x16x32_bf16 a[52:55], a[136:139], a[100:103], a[52:55]
ds_read_b64_tr_b16 a[130:131], v160 offset:18432
buffer_load_dwordx4 v169, s[12:15], s48 offen offset:0 lds
v_mfma_f32_16x16x32_bf16 a[56:59], a[140:143], a[96:99], a[56:59]
ds_read_b128 a[104:107], v168 offset:0
ds_read_b64_tr_b16 a[132:133], v161 offset:16384
s_lshl_b32 s49, s80, 18
v_mfma_f32_16x16x32_bf16 a[60:63], a[140:143], a[100:103], a[60:63]
ds_read_b64_tr_b16 a[134:135], v161 offset:18432
buffer_load_dwordx4 v170, s[12:15], s48 offen offset:1024 lds
s_waitcnt lgkmcnt(5)
v_mfma_f32_16x16x32_bf16 a[64:67], a[144:147], a[96:99], a[64:67]
ds_read_b128 a[108:111], v168 offset:1024
ds_read_b64_tr_b16 a[136:137], v162 offset:16384
s_add_u32 m0, s37, 147456
s_add_u32 s49, s49, s82
v_mfma_f32_16x16x32_bf16 a[68:71], a[144:147], a[100:103], a[68:71]
ds_read_b64_tr_b16 a[138:139], v162 offset:18432
buffer_load_dwordx4 v171, s[16:19], s49 offen offset:0 lds
v_mfma_f32_16x16x32_bf16 a[72:75], a[148:151], a[96:99], a[72:75]
ds_read_b64_tr_b16 a[140:141], v163 offset:16384
s_add_u32 s80, s80, 1
v_mfma_f32_16x16x32_bf16 a[76:79], a[148:151], a[100:103], a[76:79]
ds_read_b64_tr_b16 a[142:143], v163 offset:18432
buffer_load_dwordx4 v172, s[16:19], s49 offen offset:1024 lds
v_mfma_f32_16x16x32_bf16 a[80:83], a[152:155], a[96:99], a[80:83]
ds_read_b64_tr_b16 a[144:145], v164 offset:16384
s_cmp_eq_u32 s80, 16
s_cselect_b32 s80, 2, s80
v_mfma_f32_16x16x32_bf16 a[84:87], a[152:155], a[100:103], a[84:87]
ds_read_b64_tr_b16 a[146:147], v164 offset:18432
buffer_load_dwordx4 v173, s[16:19], s49 offen offset:2048 lds
v_mfma_f32_16x16x32_bf16 a[88:91], a[156:159], a[96:99], a[88:91]
ds_read_b64_tr_b16 a[148:149], v165 offset:16384
v_mfma_f32_16x16x32_bf16 a[92:95], a[156:159], a[100:103], a[92:95]
ds_read_b64_tr_b16 a[150:151], v165 offset:18432
buffer_load_dwordx4 v174, s[16:19], s49 offen offset:3072 lds
s_waitcnt lgkmcnt(4)
v_mfma_f32_16x16x32_bf16 v[64:67], a[128:131], a[104:107], v[64:67]
ds_read_b64_tr_b16 a[152:153], v166 offset:16384
v_mfma_f32_16x16x32_bf16 v[68:71], a[128:131], a[108:111], v[68:71]
ds_read_b64_tr_b16 a[154:155], v166 offset:18432
v_mfma_f32_16x16x32_bf16 v[72:75], a[132:135], a[104:107], v[72:75]
ds_read_b64_tr_b16 a[156:157], v167 offset:16384
v_mfma_f32_16x16x32_bf16 v[76:79], a[132:135], a[108:111], v[76:79]
ds_read_b64_tr_b16 a[158:159], v167 offset:18432
v_mfma_f32_16x16x32_bf16 v[80:83], a[136:139], a[104:107], v[80:83]
v_add_u32 v168, 8192, v168
ds_read_b64_tr_b16 a[128:129], v160 offset:16640
v_mfma_f32_16x16x32_bf16 v[84:87], a[136:139], a[108:111], v[84:87]
ds_read_b64_tr_b16 a[130:131], v160 offset:18688
v_mfma_f32_16x16x32_bf16 v[88:91], a[140:143], a[104:107], v[88:91]
ds_read_b64_tr_b16 a[132:133], v161 offset:16640
v_mfma_f32_16x16x32_bf16 v[92:95], a[140:143], a[108:111], v[92:95]
ds_read_b64_tr_b16 a[134:135], v161 offset:18688
s_waitcnt lgkmcnt(4)
v_mfma_f32_16x16x32_bf16 v[96:99], a[144:147], a[104:107], v[96:99]
ds_read_b64_tr_b16 a[136:137], v162 offset:16640
v_mfma_f32_16x16x32_bf16 v[100:103], a[144:147], a[108:111], v[100:103]
ds_read_b64_tr_b16 a[138:139], v162 offset:18688
v_mfma_f32_16x16x32_bf16 v[104:107], a[148:151], a[104:107], v[104:107]
ds_read_b64_tr_b16 a[140:141], v163 offset:16640
v_mfma_f32_16x16x32_bf16 v[108:111], a[148:151], a[108:111], v[108:111]
ds_read_b64_tr_b16 a[142:143], v163 offset:18688
v_mfma_f32_16x16x32_bf16 v[112:115], a[152:155], a[104:107], v[112:115]
ds_read_b64_tr_b16 a[144:145], v164 offset:16640
v_mfma_f32_16x16x32_bf16 v[116:119], a[152:155], a[108:111], v[116:119]
ds_read_b64_tr_b16 a[146:147], v164 offset:18688
v_mfma_f32_16x16x32_bf16 v[120:123], a[156:159], a[104:107], v[120:123]
ds_read_b64_tr_b16 a[148:149], v165 offset:16640
v_mfma_f32_16x16x32_bf16 v[124:127], a[156:159], a[108:111], v[124:127]
ds_read_b64_tr_b16 a[150:151], v165 offset:18688
s_waitcnt lgkmcnt(4)
v_mfma_f32_16x16x32_bf16 a[32:35], a[128:131], a[104:107], a[32:35]
ds_read_b64_tr_b16 a[152:153], v166 offset:16640
v_mfma_f32_16x16x32_bf16 a[36:39], a[128:131], a[108:111], a[36:39]
ds_read_b64_tr_b16 a[154:155], v166 offset:18688
v_mfma_f32_16x16x32_bf16 a[40:43], a[132:135], a[104:107], a[40:43]
ds_read_b64_tr_b16 a[156:157], v167 offset:16640
v_mfma_f32_16x16x32_bf16 a[44:47], a[132:135], a[108:111], a[44:47]
ds_read_b64_tr_b16 a[158:159], v167 offset:18688
v_mfma_f32_16x16x32_bf16 a[48:51], a[136:139], a[104:107], a[48:51]
s_waitcnt vmcnt(10)
s_barrier
ds_read_b64_tr_b16 a[128:129], v160 offset:32768
s_lshl_b32 s48, s80, 6
s_add_u32 m0, s40, 32768
s_add_u32 s48, s48, s81
v_mfma_f32_16x16x32_bf16 a[52:55], a[136:139], a[108:111], a[52:55]
ds_read_b64_tr_b16 a[130:131], v160 offset:34816
buffer_load_dwordx4 v169, s[12:15], s48 offen offset:0 lds
v_mfma_f32_16x16x32_bf16 a[56:59], a[140:143], a[104:107], a[56:59]
ds_read_b128 a[96:99], v168 offset:0
ds_read_b64_tr_b16 a[132:133], v161 offset:32768
s_lshl_b32 s49, s80, 18
v_mfma_f32_16x16x32_bf16 a[60:63], a[140:143], a[108:111], a[60:63]
ds_read_b64_tr_b16 a[134:135], v161 offset:34816
buffer_load_dwordx4 v170, s[12:15], s48 offen offset:1024 lds
s_waitcnt lgkmcnt(5)
v_mfma_f32_16x16x32_bf16 a[64:67], a[144:147], a[104:107], a[64:67]
ds_read_b128 a[100:103], v168 offset:1024
ds_read_b64_tr_b16 a[136:137], v162 offset:32768
s_add_u32 m0, s37, 98304
s_add_u32 s49, s49, s82
v_mfma_f32_16x16x32_bf16 a[68:71], a[144:147], a[108:111], a[68:71]
ds_read_b64_tr_b16 a[138:139], v162 offset:34816
buffer_load_dwordx4 v171, s[16:19], s49 offen offset:0 lds
v_mfma_f32_16x16x32_bf16 a[72:75], a[148:151], a[104:107], a[72:75]
ds_read_b64_tr_b16 a[140:141], v163 offset:32768
s_add_u32 s80, s80, 1
v_mfma_f32_16x16x32_bf16 a[76:79], a[148:151], a[108:111], a[76:79]
ds_read_b64_tr_b16 a[142:143], v163 offset:34816
buffer_load_dwordx4 v172, s[16:19], s49 offen offset:1024 lds
v_mfma_f32_16x16x32_bf16 a[80:83], a[152:155], a[104:107], a[80:83]
ds_read_b64_tr_b16 a[144:145], v164 offset:32768
s_cmp_eq_u32 s80, 16
s_cselect_b32 s80, 2, s80
v_mfma_f32_16x16x32_bf16 a[84:87], a[152:155], a[108:111], a[84:87]
ds_read_b64_tr_b16 a[146:147], v164 offset:34816
buffer_load_dwordx4 v173, s[16:19], s49 offen offset:2048 lds
v_mfma_f32_16x16x32_bf16 a[88:91], a[156:159], a[104:107], a[88:91]
ds_read_b64_tr_b16 a[148:149], v165 offset:32768
v_mfma_f32_16x16x32_bf16 a[92:95], a[156:159], a[108:111], a[92:95]
ds_read_b64_tr_b16 a[150:151], v165 offset:34816
buffer_load_dwordx4 v174, s[16:19], s49 offen offset:3072 lds
s_waitcnt lgkmcnt(4)
v_mfma_f32_16x16x32_bf16 v[64:67], a[128:131], a[96:99], v[64:67]
ds_read_b64_tr_b16 a[152:153], v166 offset:32768
s_add_u32 m0, s37, 65536
s_nop 0
v_mfma_f32_16x16x32_bf16 v[68:71], a[128:131], a[100:103], v[68:71]
ds_read_b64_tr_b16 a[154:155], v166 offset:34816
buffer_load_dwordx4 v32, s[8:11], s39 offen offset:0 nt lds
v_mfma_f32_16x16x32_bf16 v[72:75], a[132:135], a[96:99], v[72:75]
ds_read_b64_tr_b16 a[156:157], v167 offset:32768
v_mfma_f32_16x16x32_bf16 v[76:79], a[132:135], a[100:103], v[76:79]
ds_read_b64_tr_b16 a[158:159], v167 offset:34816
buffer_load_dwordx4 v33, s[8:11], s39 offen offset:1024 nt lds
v_mfma_f32_16x16x32_bf16 v[80:83], a[136:139], a[96:99], v[80:83]
v_add_u32 v168, 8192, v168
ds_read_b64_tr_b16 a[128:129], v160 offset:33024
v_mfma_f32_16x16x32_bf16 v[84:87], a[136:139], a[100:103], v[84:87]
ds_read_b64_tr_b16 a[130:131], v160 offset:35072
buffer_load_dwordx4 v32, s[8:11], s39 offen offset:2048 nt lds
v_mfma_f32_16x16x32_bf16 v[88:91], a[140:143], a[96:99], v[88:91]
ds_read_b64_tr_b16 a[132:133], v161 offset:33024
v_mfma_f32_16x16x32_bf16 v[92:95], a[140:143], a[100:103], v[92:95]
ds_read_b64_tr_b16 a[134:135], v161 offset:35072
buffer_load_dwordx4 v33, s[8:11], s39 offen offset:3072 nt lds
s_add_u32 s39, s39, 16384
s_waitcnt lgkmcnt(4)
v_mfma_f32_16x16x32_bf16 v[96:99], a[144:147], a[96:99], v[96:99]
ds_read_b64_tr_b16 a[136:137], v162 offset:33024
v_mfma_f32_16x16x32_bf16 v[100:103], a[144:147], a[100:103], v[100:103]
ds_read_b64_tr_b16 a[138:139], v162 offset:35072
v_mfma_f32_16x16x32_bf16 v[104:107], a[148:151], a[96:99], v[104:107]
ds_read_b64_tr_b16 a[140:141], v163 offset:33024
v_mfma_f32_16x16x32_bf16 v[108:111], a[148:151], a[100:103], v[108:111]
ds_read_b64_tr_b16 a[142:143], v163 offset:35072
v_mfma_f32_16x16x32_bf16 v[112:115], a[152:155], a[96:99], v[112:115]
ds_read_b64_tr_b16 a[144:145], v164 offset:33024
v_mfma_f32_16x16x32_bf16 v[116:119], a[152:155], a[100:103], v[116:119]
ds_read_b64_tr_b16 a[146:147], v164 offset:35072
v_mfma_f32_16x16x32_bf16 v[120:123], a[156:159], a[96:99], v[120:123]
ds_read_b64_tr_b16 a[148:149], v165 offset:33024
v_mfma_f32_16x16x32_bf16 v[124:127], a[156:159], a[100:103], v[124:127]
ds_read_b64_tr_b16 a[150:151], v165 offset:35072
s_waitcnt lgkmcnt(4)
v_mfma_f32_16x16x32_bf16 a[32:35], a[128:131], a[96:99], a[32:35]
ds_read_b64_tr_b16 a[152:153], v166 offset:33024
v_mfma_f32_16x16x32_bf16 a[36:39], a[128:131], a[100:103], a[36:39]
ds_read_b64_tr_b16 a[154:155], v166 offset:35072
v_mfma_f32_16x16x32_bf16 a[40:43], a[132:135], a[96:99], a[40:43]
ds_read_b64_tr_b16 a[156:157], v167 offset:33024
v_mfma_f32_16x16x32_bf16 a[44:47], a[132:135], a[100:103], a[44:47]
ds_read_b64_tr_b16 a[158:159], v167 offset:35072
v_mfma_f32_16x16x32_bf16 a[48:51], a[136:139], a[96:99], a[48:51]
s_waitcnt vmcnt(10)
s_barrier
ds_read_b64_tr_b16 a[128:129], v160 offset:49152
s_lshl_b32 s48, s80, 6
s_add_u32 m0, s40, 40960
s_add_u32 s48, s48, s81
v_mfma_f32_16x16x32_bf16 a[52:55], a[136:139], a[100:103], a[52:55]
ds_read_b64_tr_b16 a[130:131], v160 offset:51200
buffer_load_dwordx4 v169, s[12:15], s48 offen offset:0 lds
v_mfma_f32_16x16x32_bf16 a[56:59], a[140:143], a[96:99], a[56:59]
ds_read_b128 a[104:107], v168 offset:0
ds_read_b64_tr_b16 a[132:133], v161 offset:49152
s_lshl_b32 s49, s80, 18
v_mfma_f32_16x16x32_bf16 a[60:63], a[140:143], a[100:103], a[60:63]
ds_read_b64_tr_b16 a[134:135], v161 offset:51200
buffer_load_dwordx4 v170, s[12:15], s48 offen offset:1024 lds
s_waitcnt lgkmcnt(5)
v_mfma_f32_16x16x32_bf16 a[64:67], a[144:147], a[96:99], a[64:67]
ds_read_b128 a[108:111], v168 offset:1024
ds_read_b64_tr_b16 a[136:137], v162 offset:49152
s_add_u32 m0, s37, 114688
s_add_u32 s49, s49, s82
v_mfma_f32_16x16x32_bf16 a[68:71], a[144:147], a[100:103], a[68:71]
ds_read_b64_tr_b16 a[138:139], v162 offset:51200
buffer_load_dwordx4 v171, s[16:19], s49 offen offset:0 lds
v_mfma_f32_16x16x32_bf16 a[72:75], a[148:151], a[96:99], a[72:75]
ds_read_b64_tr_b16 a[140:141], v163 offset:49152
s_add_u32 s80, s80, 1
v_mfma_f32_16x16x32_bf16 a[76:79], a[148:151], a[100:103], a[76:79]
ds_read_b64_tr_b16 a[142:143], v163 offset:51200
buffer_load_dwordx4 v172, s[16:19], s49 offen offset:1024 lds
v_mfma_f32_16x16x32_bf16 a[80:83], a[152:155], a[96:99], a[80:83]
ds_read_b64_tr_b16 a[144:145], v164 offset:49152
s_cmp_eq_u32 s80, 16
s_cselect_b32 s80, 2, s80
v_mfma_f32_16x16x32_bf16 a[84:87], a[152:155], a[100:103], a[84:87]
ds_read_b64_tr_b16 a[146:147], v164 offset:51200
buffer_load_dwordx4 v173, s[16:19], s49 offen offset:2048 lds
v_mfma_f32_16x16x32_bf16 a[88:91], a[156:159], a[96:99], a[88:91]
ds_read_b64_tr_b16 a[148:149], v165 offset:49152
v_mfma_f32_16x16x32_bf16 a[92:95], a[156:159], a[100:103], a[92:95]
ds_read_b64_tr_b16 a[150:151], v165 offset:51200
buffer_load_dwordx4 v174, s[16:19], s49 offen offset:3072 lds
s_waitcnt lgkmcnt(4)
v_mfma_f32_16x16x32_bf16 v[64:67], a[128:131], a[104:107], v[64:67]
ds_read_b64_tr_b16 a[152:153], v166 offset:49152
v_mfma_f32_16x16x32_bf16 v[68:71], a[128:131], a[108:111], v[68:71]
ds_read_b64_tr_b16 a[154:155], v166 offset:51200
v_mfma_f32_16x16x32_bf16 v[72:75], a[132:135], a[104:107], v[72:75]
ds_read_b64_tr_b16 a[156:157], v167 offset:49152
v_mfma_f32_16x16x32_bf16 v[76:79], a[132:135], a[108:111], v[76:79]
ds_read_b64_tr_b16 a[158:159], v167 offset:51200
v_mfma_f32_16x16x32_bf16 v[80:83], a[136:139], a[104:107], v[80:83]
v_add_u32 v168, -24576, v168
ds_read_b64_tr_b16 a[128:129], v160 offset:49408
v_mfma_f32_16x16x32_bf16 v[84:87], a[136:139], a[108:111], v[84:87]
ds_read_b64_tr_b16 a[130:131], v160 offset:51456
v_mfma_f32_16x16x32_bf16 v[88:91], a[140:143], a[104:107], v[88:91]
ds_read_b64_tr_b16 a[132:133], v161 offset:49408
v_mfma_f32_16x16x32_bf16 v[92:95], a[140:143], a[108:111], v[92:95]
ds_read_b64_tr_b16 a[134:135], v161 offset:51456
s_waitcnt lgkmcnt(4)
v_mfma_f32_16x16x32_bf16 v[96:99], a[144:147], a[104:107], v[96:99]
ds_read_b64_tr_b16 a[136:137], v162 offset:49408
v_mfma_f32_16x16x32_bf16 v[100:103], a[144:147], a[108:111], v[100:103]
ds_read_b64_tr_b16 a[138:139], v162 offset:51456
v_mfma_f32_16x16x32_bf16 v[104:107], a[148:151], a[104:107], v[104:107]
ds_read_b64_tr_b16 a[140:141], v163 offset:49408
v_mfma_f32_16x16x32_bf16 v[108:111], a[148:151], a[108:111], v[108:111]
ds_read_b64_tr_b16 a[142:143], v163 offset:51456
v_mfma_f32_16x16x32_bf16 v[112:115], a[152:155], a[104:107], v[112:115]
ds_read_b64_tr_b16 a[144:145], v164 offset:49408
v_mfma_f32_16x16x32_bf16 v[116:119], a[152:155], a[108:111], v[116:119]
ds_read_b64_tr_b16 a[146:147], v164 offset:51456
v_mfma_f32_16x16x32_bf16 v[120:123], a[156:159], a[104:107], v[120:123]
ds_read_b64_tr_b16 a[148:149], v165 offset:49408
v_mfma_f32_16x16x32_bf16 v[124:127], a[156:159], a[108:111], v[124:127]
ds_read_b64_tr_b16 a[150:151], v165 offset:51456
s_waitcnt lgkmcnt(4)
v_mfma_f32_16x16x32_bf16 a[32:35], a[128:131], a[104:107], a[32:35]
ds_read_b64_tr_b16 a[152:153], v166 offset:49408
v_mfma_f32_16x16x32_bf16 a[36:39], a[128:131], a[108:111], a[36:39]
ds_read_b64_tr_b16 a[154:155], v166 offset:51456
v_mfma_f32_16x16x32_bf16 a[40:43], a[132:135], a[104:107], a[40:43]
ds_read_b64_tr_b16 a[156:157], v167 offset:49408
v_mfma_f32_16x16x32_bf16 a[44:47], a[132:135], a[108:111], a[44:47]
ds_read_b64_tr_b16 a[158:159], v167 offset:51456
v_mfma_f32_16x16x32_bf16 a[48:51], a[136:139], a[104:107], a[48:51]
s_waitcnt vmcnt(10)
s_barrier
ds_read_b64_tr_b16 a[128:129], v160 offset:0
s_lshl_b32 s48, s80, 6
s_add_u32 m0, s40, 49152
s_add_u32 s48, s48, s81
v_mfma_f32_16x16x32_bf16 a[52:55], a[136:139], a[108:111], a[52:55]
ds_read_b64_tr_b16 a[130:131], v160 offset:2048
buffer_load_dwordx4 v169, s[12:15], s48 offen offset:0 lds
v_mfma_f32_16x16x32_bf16 a[56:59], a[140:143], a[104:107], a[56:59]
ds_read_b128 a[96:99], v168 offset:0
ds_read_b64_tr_b16 a[132:133], v161 offset:0
s_lshl_b32 s49, s80, 18
v_mfma_f32_16x16x32_bf16 a[60:63], a[140:143], a[108:111], a[60:63]
ds_read_b64_tr_b16 a[134:135], v161 offset:2048
buffer_load_dwordx4 v170, s[12:15], s48 offen offset:1024 lds
s_waitcnt lgkmcnt(5)
v_mfma_f32_16x16x32_bf16 a[64:67], a[144:147], a[104:107], a[64:67]
ds_read_b128 a[100:103], v168 offset:1024
ds_read_b64_tr_b16 a[136:137], v162 offset:0
s_add_u32 m0, s37, 131072
s_add_u32 s49, s49, s82
v_mfma_f32_16x16x32_bf16 a[68:71], a[144:147], a[108:111], a[68:71]
ds_read_b64_tr_b16 a[138:139], v162 offset:2048
buffer_load_dwordx4 v171, s[16:19], s49 offen offset:0 lds
v_mfma_f32_16x16x32_bf16 a[72:75], a[148:151], a[104:107], a[72:75]
ds_read_b64_tr_b16 a[140:141], v163 offset:0
s_add_u32 s80, s80, 1
v_mfma_f32_16x16x32_bf16 a[76:79], a[148:151], a[108:111], a[76:79]
ds_read_b64_tr_b16 a[142:143], v163 offset:2048
buffer_load_dwordx4 v172, s[16:19], s49 offen offset:1024 lds
v_mfma_f32_16x16x32_bf16 a[80:83], a[152:155], a[104:107], a[80:83]
ds_read_b64_tr_b16 a[144:145], v164 offset:0
s_cmp_eq_u32 s80, 16
s_cselect_b32 s80, 2, s80
v_mfma_f32_16x16x32_bf16 a[84:87], a[152:155], a[108:111], a[84:87]
ds_read_b64_tr_b16 a[146:147], v164 offset:2048
buffer_load_dwordx4 v173, s[16:19], s49 offen offset:2048 lds
v_mfma_f32_16x16x32_bf16 a[88:91], a[156:159], a[104:107], a[88:91]
ds_read_b64_tr_b16 a[148:149], v165 offset:0
v_mfma_f32_16x16x32_bf16 a[92:95], a[156:159], a[108:111], a[92:95]
ds_read_b64_tr_b16 a[150:151], v165 offset:2048
buffer_load_dwordx4 v174, s[16:19], s49 offen offset:3072 lds
s_waitcnt lgkmcnt(4)
v_mfma_f32_16x16x32_bf16 v[64:67], a[128:131], a[96:99], v[64:67]
ds_read_b64_tr_b16 a[152:153], v166 offset:0
s_add_u32 m0, s37, 81920
s_nop 0
v_mfma_f32_16x16x32_bf16 v[68:71], a[128:131], a[100:103], v[68:71]
ds_read_b64_tr_b16 a[154:155], v166 offset:2048
buffer_load_dwordx4 v32, s[8:11], s39 offen offset:0 nt lds
v_mfma_f32_16x16x32_bf16 v[72:75], a[132:135], a[96:99], v[72:75]
ds_read_b64_tr_b16 a[156:157], v167 offset:0
v_mfma_f32_16x16x32_bf16 v[76:79], a[132:135], a[100:103], v[76:79]
ds_read_b64_tr_b16 a[158:159], v167 offset:2048
buffer_load_dwordx4 v33, s[8:11], s39 offen offset:1024 nt lds
v_mfma_f32_16x16x32_bf16 v[80:83], a[136:139], a[96:99], v[80:83]
v_add_u32 v168, 8192, v168
ds_read_b64_tr_b16 a[128:129], v160 offset:256
v_mfma_f32_16x16x32_bf16 v[84:87], a[136:139], a[100:103], v[84:87]
ds_read_b64_tr_b16 a[130:131], v160 offset:2304
buffer_load_dwordx4 v32, s[8:11], s39 offen offset:2048 nt lds
v_mfma_f32_16x16x32_bf16 v[88:91], a[140:143], a[96:99], v[88:91]
ds_read_b64_tr_b16 a[132:133], v161 offset:256
v_mfma_f32_16x16x32_bf16 v[92:95], a[140:143], a[100:103], v[92:95]
ds_read_b64_tr_b16 a[134:135], v161 offset:2304
buffer_load_dwordx4 v33, s[8:11], s39 offen offset:3072 nt lds
s_add_u32 s39, s39, 16384
s_waitcnt lgkmcnt(4)
v_mfma_f32_16x16x32_bf16 v[96:99], a[144:147], a[96:99], v[96:99]
ds_read_b64_tr_b16 a[136:137], v162 offset:256
v_mfma_f32_16x16x32_bf16 v[100:103], a[144:147], a[100:103], v[100:103]
ds_read_b64_tr_b16 a[138:139], v162 offset:2304
v_mfma_f32_16x16x32_bf16 v[104:107], a[148:151], a[96:99], v[104:107]
ds_read_b64_tr_b16 a[140:141], v163 offset:256
v_mfma_f32_16x16x32_bf16 v[108:111], a[148:151], a[100:103], v[108:111]
ds_read_b64_tr_b16 a[142:143], v163 offset:2304
v_mfma_f32_16x16x32_bf16 v[112:115], a[152:155], a[96:99], v[112:115]
ds_read_b64_tr_b16 a[144:145], v164 offset:256
v_mfma_f32_16x16x32_bf16 v[116:119], a[152:155], a[100:103], v[116:119]
ds_read_b64_tr_b16 a[146:147], v164 offset:2304
v_mfma_f32_16x16x32_bf16 v[120:123], a[156:159], a[96:99], v[120:123]
ds_read_b64_tr_b16 a[148:149], v165 offset:256
v_mfma_f32_16x16x32_bf16 v[124:127], a[156:159], a[100:103], v[124:127]
ds_read_b64_tr_b16 a[150:151], v165 offset:2304
s_waitcnt lgkmcnt(4)
v_mfma_f32_16x16x32_bf16 a[32:35], a[128:131], a[96:99], a[32:35]
ds_read_b64_tr_b16 a[152:153], v166 offset:256
v_mfma_f32_16x16x32_bf16 a[36:39], a[128:131], a[100:103], a[36:39]
ds_read_b64_tr_b16 a[154:155], v166 offset:2304
v_mfma_f32_16x16x32_bf16 a[40:43], a[132:135], a[96:99], a[40:43]
ds_read_b64_tr_b16 a[156:157], v167 offset:256
v_mfma_f32_16x16x32_bf16 a[44:47], a[132:135], a[100:103], a[44:47]
ds_read_b64_tr_b16 a[158:159], v167 offset:2304
v_mfma_f32_16x16x32_bf16 a[48:51], a[136:139], a[96:99], a[48:51]
s_waitcnt vmcnt(10)
s_barrier
ds_read_b64_tr_b16 a[128:129], v160 offset:16384
s_lshl_b32 s48, s80, 6
s_add_u32 m0, s40, 57344
s_add_u32 s48, s48, s81
v_mfma_f32_16x16x32_bf16 a[52:55], a[136:139], a[100:103], a[52:55]
ds_read_b64_tr_b16 a[130:131], v160 offset:18432
buffer_load_dwordx4 v169, s[12:15], s48 offen offset:0 lds
v_mfma_f32_16x16x32_bf16 a[56:59], a[140:143], a[96:99], a[56:59]
ds_read_b128 a[104:107], v168 offset:0
ds_read_b64_tr_b16 a[132:133], v161 offset:16384
s_lshl_b32 s49, s80, 18
v_mfma_f32_16x16x32_bf16 a[60:63], a[140:143], a[100:103], a[60:63]
ds_read_b64_tr_b16 a[134:135], v161 offset:18432
buffer_load_dwordx4 v170, s[12:15], s48 offen offset:1024 lds
s_waitcnt lgkmcnt(5)
v_mfma_f32_16x16x32_bf16 a[64:67], a[144:147], a[96:99], a[64:67]
ds_read_b128 a[108:111], v168 offset:1024
ds_read_b64_tr_b16 a[136:137], v162 offset:16384
s_add_u32 m0, s37, 147456
s_add_u32 s49, s49, s82
v_mfma_f32_16x16x32_bf16 a[68:71], a[144:147], a[100:103], a[68:71]
ds_read_b64_tr_b16 a[138:139], v162 offset:18432
buffer_load_dwordx4 v171, s[16:19], s49 offen offset:0 lds
v_mfma_f32_16x16x32_bf16 a[72:75], a[148:151], a[96:99], a[72:75]
ds_read_b64_tr_b16 a[140:141], v163 offset:16384
s_add_u32 s80, s80, 1
v_mfma_f32_16x16x32_bf16 a[76:79], a[148:151], a[100:103], a[76:79]
ds_read_b64_tr_b16 a[142:143], v163 offset:18432
buffer_load_dwordx4 v172, s[16:19], s49 offen offset:1024 lds
v_mfma_f32_16x16x32_bf16 a[80:83], a[152:155], a[96:99], a[80:83]
ds_read_b64_tr_b16 a[144:145], v164 offset:16384
s_cmp_eq_u32 s80, 16
s_cselect_b32 s80, 2, s80
v_mfma_f32_16x16x32_bf16 a[84:87], a[152:155], a[100:103], a[84:87]
ds_read_b64_tr_b16 a[146:147], v164 offset:18432
buffer_load_dwordx4 v173, s[16:19], s49 offen offset:2048 lds
v_mfma_f32_16x16x32_bf16 a[88:91], a[156:159], a[96:99], a[88:91]
ds_read_b64_tr_b16 a[148:149], v165 offset:16384
v_mfma_f32_16x16x32_bf16 a[92:95], a[156:159], a[100:103], a[92:95]
ds_read_b64_tr_b16 a[150:151], v165 offset:18432
buffer_load_dwordx4 v174, s[16:19], s49 offen offset:3072 lds
s_waitcnt lgkmcnt(4)
v_mfma_f32_16x16x32_bf16 v[64:67], a[128:131], a[104:107], v[64:67]
ds_read_b64_tr_b16 a[152:153], v166 offset:16384
v_mfma_f32_16x16x32_bf16 v[68:71], a[128:131], a[108:111], v[68:71]
ds_read_b64_tr_b16 a[154:155], v166 offset:18432
v_mfma_f32_16x16x32_bf16 v[72:75], a[132:135], a[104:107], v[72:75]
ds_read_b64_tr_b16 a[156:157], v167 offset:16384
v_mfma_f32_16x16x32_bf16 v[76:79], a[132:135], a[108:111], v[76:79]
ds_read_b64_tr_b16 a[158:159], v167 offset:18432
v_mfma_f32_16x16x32_bf16 v[80:83], a[136:139], a[104:107], v[80:83]
v_add_u32 v168, 8192, v168
ds_read_b64_tr_b16 a[128:129], v160 offset:16640
v_mfma_f32_16x16x32_bf16 v[84:87], a[136:139], a[108:111], v[84:87]
ds_read_b64_tr_b16 a[130:131], v160 offset:18688
v_mfma_f32_16x16x32_bf16 v[88:91], a[140:143], a[104:107], v[88:91]
ds_read_b64_tr_b16 a[132:133], v161 offset:16640
v_mfma_f32_16x16x32_bf16 v[92:95], a[140:143], a[108:111], v[92:95]
ds_read_b64_tr_b16 a[134:135], v161 offset:18688
s_waitcnt lgkmcnt(4)
v_mfma_f32_16x16x32_bf16 v[96:99], a[144:147], a[104:107], v[96:99]
ds_read_b64_tr_b16 a[136:137], v162 offset:16640
v_mfma_f32_16x16x32_bf16 v[100:103], a[144:147], a[108:111], v[100:103]
ds_read_b64_tr_b16 a[138:139], v162 offset:18688
v_mfma_f32_16x16x32_bf16 v[104:107], a[148:151], a[104:107], v[104:107]
ds_read_b64_tr_b16 a[140:141], v163 offset:16640
v_mfma_f32_16x16x32_bf16 v[108:111], a[148:151], a[108:111], v[108:111]
ds_read_b64_tr_b16 a[142:143], v163 offset:18688
v_mfma_f32_16x16x32_bf16 v[112:115], a[152:155], a[104:107], v[112:115]
ds_read_b64_tr_b16 a[144:145], v164 offset:16640
v_mfma_f32_16x16x32_bf16 v[116:119], a[152:155], a[108:111], v[116:119]
ds_read_b64_tr_b16 a[146:147], v164 offset:18688
v_mfma_f32_16x16x32_bf16 v[120:123], a[156:159], a[104:107], v[120:123]
ds_read_b64_tr_b16 a[148:149], v165 offset:16640
v_mfma_f32_16x16x32_bf16 v[124:127], a[156:159], a[108:111], v[124:127]
ds_read_b64_tr_b16 a[150:151], v165 offset:18688
s_waitcnt lgkmcnt(4)
v_mfma_f32_16x16x32_bf16 a[32:35], a[128:131], a[104:107], a[32:35]
ds_read_b64_tr_b16 a[152:153], v166 offset:16640
v_mfma_f32_16x16x32_bf16 a[36:39], a[128:131], a[108:111], a[36:39]
ds_read_b64_tr_b16 a[154:155], v166 offset:18688
v_mfma_f32_16x16x32_bf16 a[40:43], a[132:135], a[104:107], a[40:43]
ds_read_b64_tr_b16 a[156:157], v167 offset:16640
v_mfma_f32_16x16x32_bf16 a[44:47], a[132:135], a[108:111], a[44:47]
ds_read_b64_tr_b16 a[158:159], v167 offset:18688
v_mfma_f32_16x16x32_bf16 a[48:51], a[136:139], a[104:107], a[48:51]
s_waitcnt vmcnt(10)
s_barrier
ds_read_b64_tr_b16 a[128:129], v160 offset:32768
s_add_u32 m0, s37, 32768
s_nop 0
v_mfma_f32_16x16x32_bf16 a[52:55], a[136:139], a[108:111], a[52:55]
ds_read_b64_tr_b16 a[130:131], v160 offset:34816
buffer_load_dwordx4 v28, s[4:7], s38 offen offset:0 nt lds
v_mfma_f32_16x16x32_bf16 a[56:59], a[140:143], a[104:107], a[56:59]
ds_read_b128 a[96:99], v168 offset:0
ds_read_b64_tr_b16 a[132:133], v161 offset:32768
v_mfma_f32_16x16x32_bf16 a[60:63], a[140:143], a[108:111], a[60:63]
ds_read_b64_tr_b16 a[134:135], v161 offset:34816
buffer_load_dwordx4 v29, s[4:7], s38 offen offset:1024 nt lds
s_waitcnt lgkmcnt(5)
v_mfma_f32_16x16x32_bf16 a[64:67], a[144:147], a[104:107], a[64:67]
ds_read_b128 a[100:103], v168 offset:1024
ds_read_b64_tr_b16 a[136:137], v162 offset:32768
v_mfma_f32_16x16x32_bf16 a[68:71], a[144:147], a[108:111], a[68:71]
ds_read_b64_tr_b16 a[138:139], v162 offset:34816
buffer_load_dwordx4 v30, s[4:7], s38 offen offset:2048 nt lds
v_mfma_f32_16x16x32_bf16 a[72:75], a[148:151], a[104:107], a[72:75]
ds_read_b64_tr_b16 a[140:141], v163 offset:32768
v_mfma_f32_16x16x32_bf16 a[76:79], a[148:151], a[108:111], a[76:79]
ds_read_b64_tr_b16 a[142:143], v163 offset:34816
buffer_load_dwordx4 v31, s[4:7], s38 offen offset:3072 nt lds
s_add_u32 s38, s38, 16384
v_mfma_f32_16x16x32_bf16 a[80:83], a[152:155], a[104:107], a[80:83]
ds_read_b64_tr_b16 a[144:145], v164 offset:32768
s_add_u32 m0, s37, 98304
s_nop 0
v_mfma_f32_16x16x32_bf16 a[84:87], a[152:155], a[108:111], a[84:87]
ds_read_b64_tr_b16 a[146:147], v164 offset:34816
buffer_load_dwordx4 v32, s[8:11], s39 offen offset:0 nt lds
v_mfma_f32_16x16x32_bf16 a[88:91], a[156:159], a[104:107], a[88:91]
ds_read_b64_tr_b16 a[148:149], v165 offset:32768
v_mfma_f32_16x16x32_bf16 a[92:95], a[156:159], a[108:111], a[92:95]
ds_read_b64_tr_b16 a[150:151], v165 offset:34816
buffer_load_dwordx4 v33, s[8:11], s39 offen offset:1024 nt lds
s_waitcnt lgkmcnt(4)
v_mfma_f32_16x16x32_bf16 v[64:67], a[128:131], a[96:99], v[64:67]
ds_read_b64_tr_b16 a[152:153], v166 offset:32768
v_mfma_f32_16x16x32_bf16 v[68:71], a[128:131], a[100:103], v[68:71]
ds_read_b64_tr_b16 a[154:155], v166 offset:34816
buffer_load_dwordx4 v32, s[8:11], s39 offen offset:2048 nt lds
v_mfma_f32_16x16x32_bf16 v[72:75], a[132:135], a[96:99], v[72:75]
ds_read_b64_tr_b16 a[156:157], v167 offset:32768
v_mfma_f32_16x16x32_bf16 v[76:79], a[132:135], a[100:103], v[76:79]
ds_read_b64_tr_b16 a[158:159], v167 offset:34816
buffer_load_dwordx4 v33, s[8:11], s39 offen offset:3072 nt lds
s_add_u32 s39, s39, 16384
v_mfma_f32_16x16x32_bf16 v[80:83], a[136:139], a[96:99], v[80:83]
v_add_u32 v168, 8192, v168
ds_read_b64_tr_b16 a[128:129], v160 offset:33024
v_mfma_f32_16x16x32_bf16 v[84:87], a[136:139], a[100:103], v[84:87]
ds_read_b64_tr_b16 a[130:131], v160 offset:35072
v_mfma_f32_16x16x32_bf16 v[88:91], a[140:143], a[96:99], v[88:91]
ds_read_b64_tr_b16 a[132:133], v161 offset:33024
v_mfma_f32_16x16x32_bf16 v[92:95], a[140:143], a[100:103], v[92:95]
ds_read_b64_tr_b16 a[134:135], v161 offset:35072
s_waitcnt lgkmcnt(4)
v_mfma_f32_16x16x32_bf16 v[96:99], a[144:147], a[96:99], v[96:99]
ds_read_b64_tr_b16 a[136:137], v162 offset:33024
v_mfma_f32_16x16x32_bf16 v[100:103], a[144:147], a[100:103], v[100:103]
ds_read_b64_tr_b16 a[138:139], v162 offset:35072
v_mfma_f32_16x16x32_bf16 v[104:107], a[148:151], a[96:99], v[104:107]
ds_read_b64_tr_b16 a[140:141], v163 offset:33024
v_mfma_f32_16x16x32_bf16 v[108:111], a[148:151], a[100:103], v[108:111]
ds_read_b64_tr_b16 a[142:143], v163 offset:35072
v_mfma_f32_16x16x32_bf16 v[112:115], a[152:155], a[96:99], v[112:115]
ds_read_b64_tr_b16 a[144:145], v164 offset:33024
v_mfma_f32_16x16x32_bf16 v[116:119], a[152:155], a[100:103], v[116:119]
ds_read_b64_tr_b16 a[146:147], v164 offset:35072
v_mfma_f32_16x16x32_bf16 v[120:123], a[156:159], a[96:99], v[120:123]
ds_read_b64_tr_b16 a[148:149], v165 offset:33024
v_mfma_f32_16x16x32_bf16 v[124:127], a[156:159], a[100:103], v[124:127]
ds_read_b64_tr_b16 a[150:151], v165 offset:35072
s_waitcnt lgkmcnt(4)
v_mfma_f32_16x16x32_bf16 a[32:35], a[128:131], a[96:99], a[32:35]
ds_read_b64_tr_b16 a[152:153], v166 offset:33024
v_mfma_f32_16x16x32_bf16 a[36:39], a[128:131], a[100:103], a[36:39]
ds_read_b64_tr_b16 a[154:155], v166 offset:35072
v_mfma_f32_16x16x32_bf16 a[40:43], a[132:135], a[96:99], a[40:43]
ds_read_b64_tr_b16 a[156:157], v167 offset:33024
v_mfma_f32_16x16x32_bf16 a[44:47], a[132:135], a[100:103], a[44:47]
ds_read_b64_tr_b16 a[158:159], v167 offset:35072
v_mfma_f32_16x16x32_bf16 a[48:51], a[136:139], a[96:99], a[48:51]
s_waitcnt vmcnt(8)
s_barrier
ds_read_b64_tr_b16 a[128:129], v160 offset:49152
v_mfma_f32_16x16x32_bf16 a[52:55], a[136:139], a[100:103], a[52:55]
ds_read_b64_tr_b16 a[130:131], v160 offset:51200
v_mfma_f32_16x16x32_bf16 a[56:59], a[140:143], a[96:99], a[56:59]
ds_read_b128 a[104:107], v168 offset:0
ds_read_b64_tr_b16 a[132:133], v161 offset:49152
v_mfma_f32_16x16x32_bf16 a[60:63], a[140:143], a[100:103], a[60:63]
ds_read_b64_tr_b16 a[134:135], v161 offset:51200
s_waitcnt lgkmcnt(5)
v_mfma_f32_16x16x32_bf16 a[64:67], a[144:147], a[96:99], a[64:67]
ds_read_b128 a[108:111], v168 offset:1024
ds_read_b64_tr_b16 a[136:137], v162 offset:49152
v_mfma_f32_16x16x32_bf16 a[68:71], a[144:147], a[100:103], a[68:71]
ds_read_b64_tr_b16 a[138:139], v162 offset:51200
v_mfma_f32_16x16x32_bf16 a[72:75], a[148:151], a[96:99], a[72:75]
ds_read_b64_tr_b16 a[140:141], v163 offset:49152
v_mfma_f32_16x16x32_bf16 a[76:79], a[148:151], a[100:103], a[76:79]
ds_read_b64_tr_b16 a[142:143], v163 offset:51200
v_mfma_f32_16x16x32_bf16 a[80:83], a[152:155], a[96:99], a[80:83]
ds_read_b64_tr_b16 a[144:145], v164 offset:49152
v_mfma_f32_16x16x32_bf16 a[84:87], a[152:155], a[100:103], a[84:87]
ds_read_b64_tr_b16 a[146:147], v164 offset:51200
v_mfma_f32_16x16x32_bf16 a[88:91], a[156:159], a[96:99], a[88:91]
ds_read_b64_tr_b16 a[148:149], v165 offset:49152
v_mfma_f32_16x16x32_bf16 a[92:95], a[156:159], a[100:103], a[92:95]
ds_read_b64_tr_b16 a[150:151], v165 offset:51200
s_waitcnt lgkmcnt(4)
v_mfma_f32_16x16x32_bf16 v[64:67], a[128:131], a[104:107], v[64:67]
ds_read_b64_tr_b16 a[152:153], v166 offset:49152
v_mfma_f32_16x16x32_bf16 v[68:71], a[128:131], a[108:111], v[68:71]
ds_read_b64_tr_b16 a[154:155], v166 offset:51200
v_mfma_f32_16x16x32_bf16 v[72:75], a[132:135], a[104:107], v[72:75]
ds_read_b64_tr_b16 a[156:157], v167 offset:49152
v_mfma_f32_16x16x32_bf16 v[76:79], a[132:135], a[108:111], v[76:79]
ds_read_b64_tr_b16 a[158:159], v167 offset:51200
v_mfma_f32_16x16x32_bf16 v[80:83], a[136:139], a[104:107], v[80:83]
ds_read_b64_tr_b16 a[128:129], v160 offset:49408
v_mfma_f32_16x16x32_bf16 v[84:87], a[136:139], a[108:111], v[84:87]
ds_read_b64_tr_b16 a[130:131], v160 offset:51456
v_mfma_f32_16x16x32_bf16 v[88:91], a[140:143], a[104:107], v[88:91]
ds_read_b64_tr_b16 a[132:133], v161 offset:49408
v_mfma_f32_16x16x32_bf16 v[92:95], a[140:143], a[108:111], v[92:95]
ds_read_b64_tr_b16 a[134:135], v161 offset:51456
s_waitcnt lgkmcnt(4)
v_mfma_f32_16x16x32_bf16 v[96:99], a[144:147], a[104:107], v[96:99]
ds_read_b64_tr_b16 a[136:137], v162 offset:49408
v_mfma_f32_16x16x32_bf16 v[100:103], a[144:147], a[108:111], v[100:103]
ds_read_b64_tr_b16 a[138:139], v162 offset:51456
v_mfma_f32_16x16x32_bf16 v[104:107], a[148:151], a[104:107], v[104:107]
ds_read_b64_tr_b16 a[140:141], v163 offset:49408
v_mfma_f32_16x16x32_bf16 v[108:111], a[148:151], a[108:111], v[108:111]
ds_read_b64_tr_b16 a[142:143], v163 offset:51456
v_mfma_f32_16x16x32_bf16 v[112:115], a[152:155], a[104:107], v[112:115]
ds_read_b64_tr_b16 a[144:145], v164 offset:49408
v_mfma_f32_16x16x32_bf16 v[116:119], a[152:155], a[108:111], v[116:119]
ds_read_b64_tr_b16 a[146:147], v164 offset:51456
v_mfma_f32_16x16x32_bf16 v[120:123], a[156:159], a[104:107], v[120:123]
ds_read_b64_tr_b16 a[148:149], v165 offset:49408
v_mfma_f32_16x16x32_bf16 v[124:127], a[156:159], a[108:111], v[124:127]
ds_read_b64_tr_b16 a[150:151], v165 offset:51456
s_waitcnt lgkmcnt(4)
v_mfma_f32_16x16x32_bf16 a[32:35], a[128:131], a[104:107], a[32:35]
ds_read_b64_tr_b16 a[152:153], v166 offset:49408
v_mfma_f32_16x16x32_bf16 a[36:39], a[128:131], a[108:111], a[36:39]
ds_read_b64_tr_b16 a[154:155], v166 offset:51456
v_mfma_f32_16x16x32_bf16 a[40:43], a[132:135], a[104:107], a[40:43]
ds_read_b64_tr_b16 a[156:157], v167 offset:49408
v_mfma_f32_16x16x32_bf16 a[44:47], a[132:135], a[108:111], a[44:47]
ds_read_b64_tr_b16 a[158:159], v167 offset:51456
v_mfma_f32_16x16x32_bf16 a[48:51], a[136:139], a[104:107], a[48:51]
s_barrier
s_add_u32 m0, s37, 49152
s_nop 0
v_mfma_f32_16x16x32_bf16 a[52:55], a[136:139], a[108:111], a[52:55]
buffer_load_dwordx4 v28, s[4:7], s38 offen offset:0 nt lds
v_mfma_f32_16x16x32_bf16 a[56:59], a[140:143], a[104:107], a[56:59]
v_mfma_f32_16x16x32_bf16 a[60:63], a[140:143], a[108:111], a[60:63]
buffer_load_dwordx4 v29, s[4:7], s38 offen offset:1024 nt lds
s_waitcnt lgkmcnt(0)
v_mfma_f32_16x16x32_bf16 a[64:67], a[144:147], a[104:107], a[64:67]
v_mfma_f32_16x16x32_bf16 a[68:71], a[144:147], a[108:111], a[68:71]
buffer_load_dwordx4 v30, s[4:7], s38 offen offset:2048 nt lds
v_mfma_f32_16x16x32_bf16 a[72:75], a[148:151], a[104:107], a[72:75]
v_mfma_f32_16x16x32_bf16 a[76:79], a[148:151], a[108:111], a[76:79]
buffer_load_dwordx4 v31, s[4:7], s38 offen offset:3072 nt lds
s_add_u32 s38, s38, 16384
v_mfma_f32_16x16x32_bf16 a[80:83], a[152:155], a[104:107], a[80:83]
v_mfma_f32_16x16x32_bf16 a[84:87], a[152:155], a[108:111], a[84:87]
v_mfma_f32_16x16x32_bf16 a[88:91], a[156:159], a[104:107], a[88:91]
v_mfma_f32_16x16x32_bf16 a[92:95], a[156:159], a[108:111], a[92:95]
v_mov_b32 v38, s44
v_mov_b32 v39, s44
v_mov_b32 v56, 0
v_mov_b32 v57, 0
v_mov_b32 v58, 0
v_mov_b32 v59, 0
v_mov_b32 v60, 0
v_mov_b32 v61, 0
v_mov_b32 v62, 0
v_mov_b32 v63, 0
s_waitcnt vmcnt(63)
s_barrier
ds_read_b128 a[96:99], v16 offset:0
ds_read_b128 a[100:103], v17 offset:0
ds_read_b128 a[104:107], v18 offset:0
ds_read_b128 a[108:111], v19 offset:0
ds_read_b128 a[112:115], v16 offset:4096
ds_read_b128 a[116:119], v17 offset:4096
ds_read_b128 a[120:123], v18 offset:4096
v_pk_mul_f32 v[64:65], v[64:65], v[38:39]
v_pk_mul_f32 v[66:67], v[66:67], v[38:39]
v_pk_mul_f32 v[68:69], v[68:69], v[38:39]
v_pk_mul_f32 v[70:71], v[70:71], v[38:39]
v_pk_mul_f32 v[72:73], v[72:73], v[38:39]
v_pk_mul_f32 v[74:75], v[74:75], v[38:39]
v_pk_mul_f32 v[76:77], v[76:77], v[38:39]
v_pk_mul_f32 v[78:79], v[78:79], v[38:39]
v_cvt_pk_bf16_f32 v64, v64, v65
v_cvt_pk_bf16_f32 v65, v66, v67
v_cvt_pk_bf16_f32 v68, v68, v69
v_cvt_pk_bf16_f32 v69, v70, v71
v_cvt_pk_bf16_f32 v72, v72, v73
v_cvt_pk_bf16_f32 v73, v74, v75
v_cvt_pk_bf16_f32 v76, v76, v77
v_cvt_pk_bf16_f32 v77, v78, v79
s_nop 0
v_permlane32_swap_b32 v64, v72
v_permlane32_swap_b32 v65, v73
v_permlane32_swap_b32 v68, v76
v_permlane32_swap_b32 v69, v77
v_permlane16_swap_b32 v64, v72
v_permlane16_swap_b32 v65, v73
v_permlane16_swap_b32 v68, v76
v_permlane16_swap_b32 v69, v77
v_accvgpr_write_b32 a0, v64
v_accvgpr_write_b32 a1, v65
v_accvgpr_write_b32 a2, v72
v_accvgpr_write_b32 a3, v73
v_accvgpr_write_b32 a16, v68
v_accvgpr_write_b32 a17, v69
v_accvgpr_write_b32 a18, v76
v_accvgpr_write_b32 a19, v77
v_pk_mul_f32 v[80:81], v[80:81], v[38:39]
v_pk_mul_f32 v[82:83], v[82:83], v[38:39]
v_pk_mul_f32 v[84:85], v[84:85], v[38:39]
v_pk_mul_f32 v[86:87], v[86:87], v[38:39]
v_pk_mul_f32 v[88:89], v[88:89], v[38:39]
v_pk_mul_f32 v[90:91], v[90:91], v[38:39]
v_pk_mul_f32 v[92:93], v[92:93], v[38:39]
v_pk_mul_f32 v[94:95], v[94:95], v[38:39]
v_cvt_pk_bf16_f32 v80, v80, v81
v_cvt_pk_bf16_f32 v81, v82, v83
v_cvt_pk_bf16_f32 v84, v84, v85
v_cvt_pk_bf16_f32 v85, v86, v87
v_cvt_pk_bf16_f32 v88, v88, v89
v_cvt_pk_bf16_f32 v89, v90, v91
v_cvt_pk_bf16_f32 v92, v92, v93
v_cvt_pk_bf16_f32 v93, v94, v95
s_nop 0
v_permlane32_swap_b32 v80, v88
v_permlane32_swap_b32 v81, v89
v_permlane32_swap_b32 v84, v92
v_permlane32_swap_b32 v85, v93
v_permlane16_swap_b32 v80, v88
v_permlane16_swap_b32 v81, v89
v_permlane16_swap_b32 v84, v92
v_permlane16_swap_b32 v85, v93
v_accvgpr_write_b32 a4, v80
v_accvgpr_write_b32 a5, v81
v_accvgpr_write_b32 a6, v88
v_accvgpr_write_b32 a7, v89
v_accvgpr_write_b32 a20, v84
v_accvgpr_write_b32 a21, v85
v_accvgpr_write_b32 a22, v92
v_accvgpr_write_b32 a23, v93
v_pk_mul_f32 v[96:97], v[96:97], v[38:39]
v_pk_mul_f32 v[98:99], v[98:99], v[38:39]
v_pk_mul_f32 v[100:101], v[100:101], v[38:39]
v_pk_mul_f32 v[102:103], v[102:103], v[38:39]
v_pk_mul_f32 v[104:105], v[104:105], v[38:39]
v_pk_mul_f32 v[106:107], v[106:107], v[38:39]
v_pk_mul_f32 v[108:109], v[108:109], v[38:39]
v_pk_mul_f32 v[110:111], v[110:111], v[38:39]
v_cvt_pk_bf16_f32 v96, v96, v97
v_cvt_pk_bf16_f32 v97, v98, v99
v_cvt_pk_bf16_f32 v100, v100, v101
v_cvt_pk_bf16_f32 v101, v102, v103
v_cvt_pk_bf16_f32 v104, v104, v105
v_cvt_pk_bf16_f32 v105, v106, v107
v_cvt_pk_bf16_f32 v108, v108, v109
v_cvt_pk_bf16_f32 v109, v110, v111
s_nop 0
v_permlane32_swap_b32 v96, v104
v_permlane32_swap_b32 v97, v105
v_permlane32_swap_b32 v100, v108
v_permlane32_swap_b32 v101, v109
v_permlane16_swap_b32 v96, v104
v_permlane16_swap_b32 v97, v105
v_permlane16_swap_b32 v100, v108
v_permlane16_swap_b32 v101, v109
v_accvgpr_write_b32 a8, v96
v_accvgpr_write_b32 a9, v97
v_accvgpr_write_b32 a10, v104
v_accvgpr_write_b32 a11, v105
v_accvgpr_write_b32 a24, v100
v_accvgpr_write_b32 a25, v101
v_accvgpr_write_b32 a26, v108
v_accvgpr_write_b32 a27, v109
v_pk_mul_f32 v[112:113], v[112:113], v[38:39]
v_pk_mul_f32 v[114:115], v[114:115], v[38:39]
v_pk_mul_f32 v[116:117], v[116:117], v[38:39]
v_pk_mul_f32 v[118:119], v[118:119], v[38:39]
v_pk_mul_f32 v[120:121], v[120:121], v[38:39]
v_pk_mul_f32 v[122:123], v[122:123], v[38:39]
v_pk_mul_f32 v[124:125], v[124:125], v[38:39]
v_pk_mul_f32 v[126:127], v[126:127], v[38:39]
v_cvt_pk_bf16_f32 v112, v112, v113
v_cvt_pk_bf16_f32 v113, v114, v115
v_cvt_pk_bf16_f32 v116, v116, v117
v_cvt_pk_bf16_f32 v117, v118, v119
v_cvt_pk_bf16_f32 v120, v120, v121
v_cvt_pk_bf16_f32 v121, v122, v123
v_cvt_pk_bf16_f32 v124, v124, v125
v_cvt_pk_bf16_f32 v125, v126, v127
s_nop 0
v_permlane32_swap_b32 v112, v120
v_permlane32_swap_b32 v113, v121
v_permlane32_swap_b32 v116, v124
v_permlane32_swap_b32 v117, v125
v_permlane16_swap_b32 v112, v120
v_permlane16_swap_b32 v113, v121
v_permlane16_swap_b32 v116, v124
v_permlane16_swap_b32 v117, v125
v_accvgpr_write_b32 a12, v112
v_accvgpr_write_b32 a13, v113
v_accvgpr_write_b32 a14, v120
v_accvgpr_write_b32 a15, v121
v_accvgpr_write_b32 a28, v116
v_accvgpr_write_b32 a29, v117
v_accvgpr_write_b32 a30, v124
v_accvgpr_write_b32 a31, v125
s_waitcnt lgkmcnt(3)
v_mfma_f32_16x16x32_bf16 v[128:131], a[96:99], a[0:3], v[56:59]
ds_read_b128 a[124:127], v19 offset:4096
v_mov_b64 v[64:65], 0
v_mfma_f32_16x16x32_bf16 v[132:135], a[96:99], a[16:19], v[60:63]
v_mov_b64 v[66:67], 0
v_mfma_f32_16x16x32_bf16 v[128:131], a[100:103], a[4:7], v[128:131]
ds_read_b128 a[96:99], v16 offset:8192
v_mov_b64 v[68:69], 0
v_mfma_f32_16x16x32_bf16 v[132:135], a[100:103], a[20:23], v[132:135]
v_mov_b64 v[70:71], 0
v_mfma_f32_16x16x32_bf16 v[128:131], a[104:107], a[8:11], v[128:131]
ds_read_b128 a[100:103], v17 offset:8192
v_mov_b64 v[72:73], 0
v_mfma_f32_16x16x32_bf16 v[132:135], a[104:107], a[24:27], v[132:135]
v_mov_b64 v[74:75], 0
v_mfma_f32_16x16x32_bf16 v[128:131], a[108:111], a[12:15], v[128:131]
ds_read_b128 a[104:107], v18 offset:8192
v_mov_b64 v[76:77], 0
v_mfma_f32_16x16x32_bf16 v[132:135], a[108:111], a[28:31], v[132:135]
v_mov_b64 v[78:79], 0
s_waitcnt lgkmcnt(3)
v_mfma_f32_16x16x32_bf16 v[136:139], a[112:115], a[0:3], v[56:59]
ds_read_b128 a[108:111], v19 offset:8192
v_mov_b64 v[80:81], 0
v_mfma_f32_16x16x32_bf16 v[140:143], a[112:115], a[16:19], v[60:63]
v_mov_b64 v[82:83], 0
v_mfma_f32_16x16x32_bf16 v[136:139], a[116:119], a[4:7], v[136:139]
ds_read_b128 a[112:115], v16 offset:12288
v_mov_b64 v[84:85], 0
v_mfma_f32_16x16x32_bf16 v[140:143], a[116:119], a[20:23], v[140:143]
v_mov_b64 v[86:87], 0
v_mfma_f32_16x16x32_bf16 v[136:139], a[120:123], a[8:11], v[136:139]
ds_read_b128 a[116:119], v17 offset:12288
v_mov_b64 v[88:89], 0
v_mfma_f32_16x16x32_bf16 v[140:143], a[120:123], a[24:27], v[140:143]
v_mov_b64 v[90:91], 0
v_mfma_f32_16x16x32_bf16 v[136:139], a[124:127], a[12:15], v[136:139]
ds_read_b128 a[120:123], v18 offset:12288
v_mov_b64 v[92:93], 0
v_mfma_f32_16x16x32_bf16 v[140:143], a[124:127], a[28:31], v[140:143]
v_mov_b64 v[94:95], 0
s_waitcnt lgkmcnt(3)
v_mfma_f32_16x16x32_bf16 v[144:147], a[96:99], a[0:3], v[56:59]
ds_read_b128 a[124:127], v19 offset:12288
v_mov_b64 v[96:97], 0
v_mfma_f32_16x16x32_bf16 v[148:151], a[96:99], a[16:19], v[60:63]
v_mov_b64 v[98:99], 0
v_mfma_f32_16x16x32_bf16 v[144:147], a[100:103], a[4:7], v[144:147]
s_waitcnt vmcnt(50)
s_barrier
ds_read_b128 a[96:99], v16 offset:16384
v_mov_b64 v[100:101], 0
v_mfma_f32_16x16x32_bf16 v[148:151], a[100:103], a[20:23], v[148:151]
v_mov_b64 v[102:103], 0
v_mfma_f32_16x16x32_bf16 v[144:147], a[104:107], a[8:11], v[144:147]
ds_read_b128 a[100:103], v17 offset:16384
v_mov_b64 v[104:105], 0
v_mfma_f32_16x16x32_bf16 v[148:151], a[104:107], a[24:27], v[148:151]
v_mov_b64 v[106:107], 0
v_mfma_f32_16x16x32_bf16 v[144:147], a[108:111], a[12:15], v[144:147]
ds_read_b128 a[104:107], v18 offset:16384
v_mov_b64 v[108:109], 0
v_mfma_f32_16x16x32_bf16 v[148:151], a[108:111], a[28:31], v[148:151]
v_mov_b64 v[110:111], 0
s_waitcnt lgkmcnt(3)
v_mfma_f32_16x16x32_bf16 v[152:155], a[112:115], a[0:3], v[56:59]
ds_read_b128 a[108:111], v19 offset:16384
v_mov_b64 v[112:113], 0
v_mfma_f32_16x16x32_bf16 v[156:159], a[112:115], a[16:19], v[60:63]
v_mov_b64 v[114:115], 0
v_mfma_f32_16x16x32_bf16 v[152:155], a[116:119], a[4:7], v[152:155]
ds_read_b128 a[112:115], v16 offset:20480
v_mov_b64 v[116:117], 0
v_mfma_f32_16x16x32_bf16 v[156:159], a[116:119], a[20:23], v[156:159]
v_mov_b64 v[118:119], 0
v_mfma_f32_16x16x32_bf16 v[152:155], a[120:123], a[8:11], v[152:155]
ds_read_b128 a[116:119], v17 offset:20480
v_mov_b64 v[120:121], 0
v_mfma_f32_16x16x32_bf16 v[156:159], a[120:123], a[24:27], v[156:159]
v_mov_b64 v[122:123], 0
v_mfma_f32_16x16x32_bf16 v[152:155], a[124:127], a[12:15], v[152:155]
ds_read_b128 a[120:123], v18 offset:20480
v_mov_b64 v[124:125], 0
v_mfma_f32_16x16x32_bf16 v[156:159], a[124:127], a[28:31], v[156:159]
v_mov_b64 v[126:127], 0
s_barrier
s_add_u32 m0, s37, 0
s_nop 0
buffer_load_dwordx4 v28, s[4:7], s38 offen offset:0 nt lds
buffer_load_dwordx4 v29, s[4:7], s38 offen offset:1024 nt lds
v_max3_f32 v34, v128, v129, v130
v_max3_f32 v35, v132, v133, v134
v_max3_f32 v34, v34, v131, v136
v_max3_f32 v35, v35, v135, v140
v_max3_f32 v34, v34, v137, v138
v_max3_f32 v35, v35, v141, v142
v_max3_f32 v34, v34, v139, v144
v_max3_f32 v35, v35, v143, v148
v_max3_f32 v34, v34, v145, v146
v_max3_f32 v35, v35, v149, v150
v_max3_f32 v34, v34, v147, v152
v_max3_f32 v35, v35, v151, v156
v_max3_f32 v34, v34, v153, v154
v_max3_f32 v35, v35, v157, v158
v_max_f32 v34, v34, v155
v_max_f32 v35, v35, v159
v_max_f32 v36, v34, v35
buffer_load_dwordx4 v30, s[4:7], s38 offen offset:2048 nt lds
buffer_load_dwordx4 v31, s[4:7], s38 offen offset:3072 nt lds
s_add_u32 s38, s38, 16384
s_mov_b32 s43, 0
s_call_b64 s[92:93], L_init
L_loop:
s_waitcnt lgkmcnt(3)
v_mfma_f32_16x16x32_bf16 v[160:163], a[96:99], a[0:3], v[56:59]
ds_read_b128 a[124:127], v19 offset:20480
v_exp_f32 v128, v128
v_mfma_f32_16x16x32_bf16 v[164:167], a[96:99], a[16:19], v[60:63]
v_exp_f32 v129, v129
v_exp_f32 v130, v130
v_mfma_f32_16x16x32_bf16 v[160:163], a[100:103], a[4:7], v[160:163]
ds_read_b128 a[96:99], v16 offset:24576
v_exp_f32_e64 v131, v131
v_mfma_f32_16x16x32_bf16 v[164:167], a[100:103], a[20:23], v[164:167]
v_cvt_pk_bf16_f32 v192, v128, v129
v_exp_f32_e64 v132, v132
v_mfma_f32_16x16x32_bf16 v[160:163], a[104:107], a[8:11], v[160:163]
ds_read_b128 a[100:103], v17 offset:24576
v_exp_f32_e64 v133, v133
v_cvt_pk_bf16_f32 v193, v130, v131
v_mfma_f32_16x16x32_bf16 v[164:167], a[104:107], a[24:27], v[164:167]
v_exp_f32 v134, v134
v_exp_f32 v135, v135
v_mfma_f32_16x16x32_bf16 v[160:163], a[108:111], a[12:15], v[160:163]
ds_read_b128 a[104:107], v18 offset:24576
v_cvt_pk_bf16_f32 v196, v132, v133
v_mfma_f32_16x16x32_bf16 v[164:167], a[108:111], a[28:31], v[164:167]
v_exp_f32 v136, v136
v_exp_f32_e64 v137, v137
s_waitcnt lgkmcnt(3)
v_mfma_f32_16x16x32_bf16 v[168:171], a[112:115], a[0:3], v[56:59]
ds_read_b128 a[108:111], v19 offset:24576
v_cvt_pk_bf16_f32 v197, v134, v135
v_mfma_f32_16x16x32_bf16 v[172:175], a[112:115], a[16:19], v[60:63]
v_exp_f32 v138, v138
v_exp_f32 v139, v139
v_mfma_f32_16x16x32_bf16 v[168:171], a[116:119], a[4:7], v[168:171]
ds_read_b128 a[112:115], v16 offset:28672
v_cvt_pk_bf16_f32 v194, v136, v137
v_exp_f32_e64 v140, v140
v_mfma_f32_16x16x32_bf16 v[172:175], a[116:119], a[20:23], v[172:175]
v_exp_f32_e64 v141, v141
v_cvt_pk_bf16_f32 v195, v138, v139
v_mfma_f32_16x16x32_bf16 v[168:171], a[120:123], a[8:11], v[168:171]
ds_read_b128 a[116:119], v17 offset:28672
v_exp_f32_e64 v142, v142
v_mfma_f32_16x16x32_bf16 v[172:175], a[120:123], a[24:27], v[172:175]
v_exp_f32_e64 v143, v143
v_cvt_pk_bf16_f32 v198, v140, v141
v_mfma_f32_16x16x32_bf16 v[168:171], a[124:127], a[12:15], v[168:171]
ds_read_b128 a[120:123], v18 offset:28672
v_exp_f32 v144, v144
v_exp_f32 v145, v145
v_mfma_f32_16x16x32_bf16 v[172:175], a[124:127], a[28:31], v[172:175]
v_cvt_pk_bf16_f32 v199, v142, v143
s_waitcnt lgkmcnt(3)
v_mfma_f32_16x16x32_bf16 v[176:179], a[96:99], a[0:3], v[56:59]
ds_read_b128 a[124:127], v19 offset:28672
v_exp_f32 v146, v146
v_mfma_f32_16x16x32_bf16 v[180:183], a[96:99], a[16:19], v[60:63]
v_exp_f32_e64 v147, v147
v_cvt_pk_bf16_f32 v200, v144, v145
v_exp_f32_e64 v148, v148
v_mfma_f32_16x16x32_bf16 v[176:179], a[100:103], a[4:7], v[176:179]
s_waitcnt vmcnt(5)
s_barrier
ds_read_b64_tr_b16 a[128:129], v20 offset:0
s_add_u32 m0, s37, 114688
v_mfma_f32_16x16x32_bf16 v[180:183], a[100:103], a[20:23], v[180:183]
ds_read_b64_tr_b16 a[130:131], v20 offset:4096
buffer_load_dwordx4 v32, s[8:11], s39 offen offset:0 nt lds
v_mfma_f32_16x16x32_bf16 v[176:179], a[104:107], a[8:11], v[176:179]
ds_read_b64_tr_b16 a[132:133], v21 offset:0
v_mfma_f32_16x16x32_bf16 v[180:183], a[104:107], a[24:27], v[180:183]
ds_read_b64_tr_b16 a[134:135], v21 offset:4096
v_mfma_f32_16x16x32_bf16 v[176:179], a[108:111], a[12:15], v[176:179]
ds_read_b64_tr_b16 a[136:137], v22 offset:0
v_exp_f32_e64 v149, v149
v_cvt_pk_bf16_f32 v201, v146, v147
v_mfma_f32_16x16x32_bf16 v[180:183], a[108:111], a[28:31], v[180:183]
ds_read_b64_tr_b16 a[138:139], v22 offset:4096
buffer_load_dwordx4 v33, s[8:11], s39 offen offset:1024 nt lds
s_waitcnt lgkmcnt(6)
v_mfma_f32_16x16x32_bf16 v[184:187], a[112:115], a[0:3], v[56:59]
ds_read_b64_tr_b16 a[140:141], v23 offset:0
v_mfma_f32_16x16x32_bf16 v[188:191], a[112:115], a[16:19], v[60:63]
ds_read_b64_tr_b16 a[142:143], v23 offset:4096
v_exp_f32 v150, v150
v_mfma_f32_16x16x32_bf16 v[184:187], a[116:119], a[4:7], v[184:187]
ds_read_b64_tr_b16 a[144:145], v24 offset:0
v_exp_f32_e64 v151, v151
v_cvt_pk_bf16_f32 v204, v148, v149
v_mfma_f32_16x16x32_bf16 v[188:191], a[116:119], a[20:23], v[188:191]
ds_read_b64_tr_b16 a[146:147], v24 offset:4096
buffer_load_dwordx4 v32, s[8:11], s39 offen offset:2048 nt lds
v_mfma_f32_16x16x32_bf16 v[184:187], a[120:123], a[8:11], v[184:187]
ds_read_b64_tr_b16 a[148:149], v25 offset:0
s_nop 0
v_mfma_f32_16x16x32_bf16 v[188:191], a[120:123], a[24:27], v[188:191]
ds_read_b64_tr_b16 a[150:151], v25 offset:4096
v_cvt_pk_bf16_f32 v205, v150, v151
v_mfma_f32_16x16x32_bf16 v[184:187], a[124:127], a[12:15], v[184:187]
ds_read_b64_tr_b16 a[152:153], v26 offset:0
v_mfma_f32_16x16x32_bf16 v[188:191], a[124:127], a[28:31], v[188:191]
ds_read_b64_tr_b16 a[154:155], v26 offset:4096
buffer_load_dwordx4 v33, s[8:11], s39 offen offset:3072 nt lds
s_add_u32 s39, s39, 16384
s_waitcnt lgkmcnt(6)
v_mfma_f32_16x16x32_bf16 v[64:67], a[128:131], v[192:195], v[64:67]
ds_read_b64_tr_b16 a[156:157], v27 offset:0
v_exp_f32_e64 v152, v152
v_mfma_f32_16x16x32_bf16 v[68:71], a[128:131], v[196:199], v[68:71]
ds_read_b64_tr_b16 a[158:159], v27 offset:4096
v_exp_f32_e64 v153, v153
v_mfma_f32_16x16x32_bf16 v[72:75], a[132:135], v[192:195], v[72:75]
ds_read_b64_tr_b16 a[128:129], v20 offset:8192
v_exp_f32_e64 v154, v154
v_mfma_f32_16x16x32_bf16 v[76:79], a[132:135], v[196:199], v[76:79]
ds_read_b64_tr_b16 a[130:131], v20 offset:12288
v_exp_f32_e64 v155, v155
v_mfma_f32_16x16x32_bf16 v[80:83], a[136:139], v[192:195], v[80:83]
ds_read_b64_tr_b16 a[132:133], v21 offset:8192
v_cvt_pk_bf16_f32 v202, v152, v153
v_mfma_f32_16x16x32_bf16 v[84:87], a[136:139], v[196:199], v[84:87]
ds_read_b64_tr_b16 a[134:135], v21 offset:12288
v_exp_f32_e64 v156, v156
v_mfma_f32_16x16x32_bf16 v[88:91], a[140:143], v[192:195], v[88:91]
ds_read_b64_tr_b16 a[136:137], v22 offset:8192
v_exp_f32_e64 v157, v157
v_mfma_f32_16x16x32_bf16 v[92:95], a[140:143], v[196:199], v[92:95]
ds_read_b64_tr_b16 a[138:139], v22 offset:12288
v_cvt_pk_bf16_f32 v203, v154, v155
v_mfma_f32_16x16x32_bf16 v[48:51], v[44:47], v[192:195], v[48:51]
s_waitcnt lgkmcnt(6)
v_mfma_f32_16x16x32_bf16 v[96:99], a[144:147], v[192:195], v[96:99]
ds_read_b64_tr_b16 a[140:141], v23 offset:8192
v_exp_f32 v158, v158
v_mfma_f32_16x16x32_bf16 v[100:103], a[144:147], v[196:199], v[100:103]
ds_read_b64_tr_b16 a[142:143], v23 offset:12288
v_exp_f32_e64 v159, v159
v_mfma_f32_16x16x32_bf16 v[104:107], a[148:151], v[192:195], v[104:107]
ds_read_b64_tr_b16 a[144:145], v24 offset:8192
v_cvt_pk_bf16_f32 v206, v156, v157
v_mfma_f32_16x16x32_bf16 v[108:111], a[148:151], v[196:199], v[108:111]
ds_read_b64_tr_b16 a[146:147], v24 offset:12288
s_nop 0
v_cvt_pk_bf16_f32 v207, v158, v159
v_mfma_f32_16x16x32_bf16 v[112:115], a[152:155], v[192:195], v[112:115]
ds_read_b64_tr_b16 a[148:149], v25 offset:8192
v_max3_f32 v34, v160, v161, v162
v_max3_f32 v35, v164, v165, v166
v_mfma_f32_16x16x32_bf16 v[116:119], a[152:155], v[196:199], v[116:119]
ds_read_b64_tr_b16 a[150:151], v25 offset:12288
v_max3_f32 v34, v34, v163, v168
v_mfma_f32_16x16x32_bf16 v[120:123], a[156:159], v[192:195], v[120:123]
ds_read_b64_tr_b16 a[152:153], v26 offset:8192
v_max3_f32 v35, v35, v167, v172
v_max3_f32 v34, v34, v169, v170
v_mfma_f32_16x16x32_bf16 v[124:127], a[156:159], v[196:199], v[124:127]
ds_read_b64_tr_b16 a[154:155], v26 offset:12288
v_max3_f32 v35, v35, v173, v174
v_mfma_f32_16x16x32_bf16 v[52:55], v[44:47], v[196:199], v[52:55]
s_waitcnt lgkmcnt(6)
v_mfma_f32_16x16x32_bf16 v[64:67], a[128:131], v[200:203], v[64:67]
ds_read_b64_tr_b16 a[156:157], v27 offset:8192
v_max3_f32 v34, v34, v171, v176
v_max3_f32 v35, v35, v175, v180
v_mfma_f32_16x16x32_bf16 v[68:71], a[128:131], v[204:207], v[68:71]
ds_read_b64_tr_b16 a[158:159], v27 offset:12288
v_max3_f32 v34, v34, v177, v178
v_mfma_f32_16x16x32_bf16 v[72:75], a[132:135], v[200:203], v[72:75]
s_waitcnt vmcnt(5)
s_barrier
ds_read_b128 a[96:99], v16 offset:32768
s_add_u32 m0, s37, 16384
v_mfma_f32_16x16x32_bf16 v[76:79], a[132:135], v[204:207], v[76:79]
buffer_load_dwordx4 v28, s[4:7], s38 offen offset:0 nt lds
v_mfma_f32_16x16x32_bf16 v[80:83], a[136:139], v[200:203], v[80:83]
ds_read_b128 a[100:103], v17 offset:32768
v_mfma_f32_16x16x32_bf16 v[84:87], a[136:139], v[204:207], v[84:87]
v_max3_f32 v35, v35, v181, v182
v_mfma_f32_16x16x32_bf16 v[88:91], a[140:143], v[200:203], v[88:91]
ds_read_b128 a[104:107], v18 offset:32768
v_max3_f32 v34, v34, v179, v184
v_max3_f32 v35, v35, v183, v188
v_mfma_f32_16x16x32_bf16 v[92:95], a[140:143], v[204:207], v[92:95]
buffer_load_dwordx4 v29, s[4:7], s38 offen offset:1024 nt lds
v_mfma_f32_16x16x32_bf16 v[48:51], v[44:47], v[200:203], v[48:51]
s_waitcnt lgkmcnt(3)
v_mfma_f32_16x16x32_bf16 v[96:99], a[144:147], v[200:203], v[96:99]
ds_read_b128 a[108:111], v19 offset:32768
v_mfma_f32_16x16x32_bf16 v[100:103], a[144:147], v[204:207], v[100:103]
v_max3_f32 v34, v34, v185, v186
v_max3_f32 v35, v35, v189, v190
v_mfma_f32_16x16x32_bf16 v[104:107], a[148:151], v[200:203], v[104:107]
ds_read_b128 a[112:115], v16 offset:36864
v_max_f32 v34, v34, v187
v_max_f32_e64 v35, v35, v191
v_mfma_f32_16x16x32_bf16 v[108:111], a[148:151], v[204:207], v[108:111]
buffer_load_dwordx4 v30, s[4:7], s38 offen offset:2048 nt lds
v_mfma_f32_16x16x32_bf16 v[112:115], a[152:155], v[200:203], v[112:115]
ds_read_b128 a[116:119], v17 offset:36864
v_mfma_f32_16x16x32_bf16 v[116:119], a[152:155], v[204:207], v[116:119]
v_max_f32_e64 v36, v34, v35
v_mfma_f32_16x16x32_bf16 v[120:123], a[156:159], v[200:203], v[120:123]
ds_read_b128 a[120:123], v18 offset:36864
v_mfma_f32_16x16x32_bf16 v[124:127], a[156:159], v[204:207], v[124:127]
buffer_load_dwordx4 v31, s[4:7], s38 offen offset:3072 nt lds
s_add_u32 s38, s38, 16384
v_mfma_f32_16x16x32_bf16 v[52:55], v[44:47], v[204:207], v[52:55]
s_bitcmp1_b32 0x0422c550, s43
s_cbranch_scc1 L_x_0
L_c_0:
v_cmp_lt_f32 vcc, s42, v36
s_cbranch_vccnz L_r_0
L_n_0:
s_add_u32 s43, s43, 1
s_waitcnt lgkmcnt(3)
v_mfma_f32_16x16x32_bf16 v[128:131], a[96:99], a[0:3], v[56:59]
ds_read_b128 a[124:127], v19 offset:36864
v_exp_f32 v160, v160
v_mfma_f32_16x16x32_bf16 v[132:135], a[96:99], a[16:19], v[60:63]
v_exp_f32 v161, v161
v_exp_f32 v162, v162
v_mfma_f32_16x16x32_bf16 v[128:131], a[100:103], a[4:7], v[128:131]
ds_read_b128 a[96:99], v16 offset:40960
v_exp_f32_e64 v163, v163
v_mfma_f32_16x16x32_bf16 v[132:135], a[100:103], a[20:23], v[132:135]
v_cvt_pk_bf16_f32 v192, v160, v161
v_exp_f32_e64 v164, v164
v_mfma_f32_16x16x32_bf16 v[128:131], a[104:107], a[8:11], v[128:131]
ds_read_b128 a[100:103], v17 offset:40960
v_exp_f32_e64 v165, v165
v_cvt_pk_bf16_f32 v193, v162, v163
v_mfma_f32_16x16x32_bf16 v[132:135], a[104:107], a[24:27], v[132:135]
v_exp_f32 v166, v166
v_exp_f32 v167, v167
v_mfma_f32_16x16x32_bf16 v[128:131], a[108:111], a[12:15], v[128:131]
ds_read_b128 a[104:107], v18 offset:40960
v_cvt_pk_bf16_f32 v196, v164, v165
v_mfma_f32_16x16x32_bf16 v[132:135], a[108:111], a[28:31], v[132:135]
v_exp_f32 v168, v168
v_exp_f32_e64 v169, v169
s_waitcnt lgkmcnt(3)
v_mfma_f32_16x16x32_bf16 v[136:139], a[112:115], a[0:3], v[56:59]
ds_read_b128 a[108:111], v19 offset:40960
v_cvt_pk_bf16_f32 v197, v166, v167
v_mfma_f32_16x16x32_bf16 v[140:143], a[112:115], a[16:19], v[60:63]
v_exp_f32 v170, v170
v_exp_f32 v171, v171
v_mfma_f32_16x16x32_bf16 v[136:139], a[116:119], a[4:7], v[136:139]
ds_read_b128 a[112:115], v16 offset:45056
v_cvt_pk_bf16_f32 v194, v168, v169
v_exp_f32_e64 v172, v172
v_mfma_f32_16x16x32_bf16 v[140:143], a[116:119], a[20:23], v[140:143]
v_exp_f32_e64 v173, v173
v_cvt_pk_bf16_f32 v195, v170, v171
v_mfma_f32_16x16x32_bf16 v[136:139], a[120:123], a[8:11], v[136:139]
ds_read_b128 a[116:119], v17 offset:45056
v_exp_f32_e64 v174, v174
v_mfma_f32_16x16x32_bf16 v[140:143], a[120:123], a[24:27], v[140:143]
v_exp_f32_e64 v175, v175
v_cvt_pk_bf16_f32 v198, v172, v173
v_mfma_f32_16x16x32_bf16 v[136:139], a[124:127], a[12:15], v[136:139]
ds_read_b128 a[120:123], v18 offset:45056
v_exp_f32 v176, v176
v_exp_f32 v177, v177
v_mfma_f32_16x16x32_bf16 v[140:143], a[124:127], a[28:31], v[140:143]
v_cvt_pk_bf16_f32 v199, v174, v175
s_waitcnt lgkmcnt(3)
v_mfma_f32_16x16x32_bf16 v[144:147], a[96:99], a[0:3], v[56:59]
ds_read_b128 a[124:127], v19 offset:45056
v_exp_f32 v178, v178
v_mfma_f32_16x16x32_bf16 v[148:151], a[96:99], a[16:19], v[60:63]
v_exp_f32_e64 v179, v179
v_cvt_pk_bf16_f32 v200, v176, v177
v_exp_f32_e64 v180, v180
v_mfma_f32_16x16x32_bf16 v[144:147], a[100:103], a[4:7], v[144:147]
s_waitcnt vmcnt(5)
s_barrier
ds_read_b64_tr_b16 a[128:129], v20 offset:16384
s_add_u32 m0, s37, 65536
v_mfma_f32_16x16x32_bf16 v[148:151], a[100:103], a[20:23], v[148:151]
ds_read_b64_tr_b16 a[130:131], v20 offset:20480
buffer_load_dwordx4 v32, s[8:11], s39 offen offset:0 nt lds
v_mfma_f32_16x16x32_bf16 v[144:147], a[104:107], a[8:11], v[144:147]
ds_read_b64_tr_b16 a[132:133], v21 offset:16384
v_mfma_f32_16x16x32_bf16 v[148:151], a[104:107], a[24:27], v[148:151]
ds_read_b64_tr_b16 a[134:135], v21 offset:20480
v_mfma_f32_16x16x32_bf16 v[144:147], a[108:111], a[12:15], v[144:147]
ds_read_b64_tr_b16 a[136:137], v22 offset:16384
v_exp_f32_e64 v181, v181
v_cvt_pk_bf16_f32 v201, v178, v179
v_mfma_f32_16x16x32_bf16 v[148:151], a[108:111], a[28:31], v[148:151]
ds_read_b64_tr_b16 a[138:139], v22 offset:20480
buffer_load_dwordx4 v33, s[8:11], s39 offen offset:1024 nt lds
s_waitcnt lgkmcnt(6)
v_mfma_f32_16x16x32_bf16 v[152:155], a[112:115], a[0:3], v[56:59]
ds_read_b64_tr_b16 a[140:141], v23 offset:16384
v_mfma_f32_16x16x32_bf16 v[156:159], a[112:115], a[16:19], v[60:63]
ds_read_b64_tr_b16 a[142:143], v23 offset:20480
v_exp_f32 v182, v182
v_mfma_f32_16x16x32_bf16 v[152:155], a[116:119], a[4:7], v[152:155]
ds_read_b64_tr_b16 a[144:145], v24 offset:16384
v_exp_f32_e64 v183, v183
v_cvt_pk_bf16_f32 v204, v180, v181
v_mfma_f32_16x16x32_bf16 v[156:159], a[116:119], a[20:23], v[156:159]
ds_read_b64_tr_b16 a[146:147], v24 offset:20480
buffer_load_dwordx4 v32, s[8:11], s39 offen offset:2048 nt lds
v_mfma_f32_16x16x32_bf16 v[152:155], a[120:123], a[8:11], v[152:155]
ds_read_b64_tr_b16 a[148:149], v25 offset:16384
s_nop 0
v_mfma_f32_16x16x32_bf16 v[156:159], a[120:123], a[24:27], v[156:159]
ds_read_b64_tr_b16 a[150:151], v25 offset:20480
v_cvt_pk_bf16_f32 v205, v182, v183
v_mfma_f32_16x16x32_bf16 v[152:155], a[124:127], a[12:15], v[152:155]
ds_read_b64_tr_b16 a[152:153], v26 offset:16384
v_mfma_f32_16x16x32_bf16 v[156:159], a[124:127], a[28:31], v[156:159]
ds_read_b64_tr_b16 a[154:155], v26 offset:20480
buffer_load_dwordx4 v33, s[8:11], s39 offen offset:3072 nt lds
s_add_u32 s39, s39, 16384
s_waitcnt lgkmcnt(6)
v_mfma_f32_16x16x32_bf16 v[64:67], a[128:131], v[192:195], v[64:67]
ds_read_b64_tr_b16 a[156:157], v27 offset:16384
v_exp_f32_e64 v184, v184
v_mfma_f32_16x16x32_bf16 v[68:71], a[128:131], v[196:199], v[68:71]
ds_read_b64_tr_b16 a[158:159], v27 offset:20480
v_exp_f32_e64 v185, v185
v_mfma_f32_16x16x32_bf16 v[72:75], a[132:135], v[192:195], v[72:75]
ds_read_b64_tr_b16 a[128:129], v20 offset:24576
v_exp_f32_e64 v186, v186
v_mfma_f32_16x16x32_bf16 v[76:79], a[132:135], v[196:199], v[76:79]
ds_read_b64_tr_b16 a[130:131], v20 offset:28672
v_exp_f32_e64 v187, v187
v_mfma_f32_16x16x32_bf16 v[80:83], a[136:139], v[192:195], v[80:83]
ds_read_b64_tr_b16 a[132:133], v21 offset:24576
v_cvt_pk_bf16_f32 v202, v184, v185
v_mfma_f32_16x16x32_bf16 v[84:87], a[136:139], v[196:199], v[84:87]
ds_read_b64_tr_b16 a[134:135], v21 offset:28672
v_exp_f32_e64 v188, v188
v_mfma_f32_16x16x32_bf16 v[88:91], a[140:143], v[192:195], v[88:91]
ds_read_b64_tr_b16 a[136:137], v22 offset:24576
v_exp_f32_e64 v189, v189
v_mfma_f32_16x16x32_bf16 v[92:95], a[140:143], v[196:199], v[92:95]
ds_read_b64_tr_b16 a[138:139], v22 offset:28672
v_cvt_pk_bf16_f32 v203, v186, v187
v_mfma_f32_16x16x32_bf16 v[48:51], v[44:47], v[192:195], v[48:51]
s_waitcnt lgkmcnt(6)
v_mfma_f32_16x16x32_bf16 v[96:99], a[144:147], v[192:195], v[96:99]
ds_read_b64_tr_b16 a[140:141], v23 offset:24576
v_exp_f32 v190, v190
v_mfma_f32_16x16x32_bf16 v[100:103], a[144:147], v[196:199], v[100:103]
ds_read_b64_tr_b16 a[142:143], v23 offset:28672
v_exp_f32_e64 v191, v191
v_mfma_f32_16x16x32_bf16 v[104:107], a[148:151], v[192:195], v[104:107]
ds_read_b64_tr_b16 a[144:145], v24 offset:24576
v_cvt_pk_bf16_f32 v206, v188, v189
v_mfma_f32_16x16x32_bf16 v[108:111], a[148:151], v[196:199], v[108:111]
ds_read_b64_tr_b16 a[146:147], v24 offset:28672
s_nop 0
v_cvt_pk_bf16_f32 v207, v190, v191
v_mfma_f32_16x16x32_bf16 v[112:115], a[152:155], v[192:195], v[112:115]
ds_read_b64_tr_b16 a[148:149], v25 offset:24576
v_max3_f32 v34, v128, v129, v130
v_max3_f32 v35, v132, v133, v134
v_mfma_f32_16x16x32_bf16 v[116:119], a[152:155], v[196:199], v[116:119]
ds_read_b64_tr_b16 a[150:151], v25 offset:28672
v_max3_f32 v34, v34, v131, v136
v_mfma_f32_16x16x32_bf16 v[120:123], a[156:159], v[192:195], v[120:123]
ds_read_b64_tr_b16 a[152:153], v26 offset:24576
v_max3_f32 v35, v35, v135, v140
v_max3_f32 v34, v34, v137, v138
v_mfma_f32_16x16x32_bf16 v[124:127], a[156:159], v[196:199], v[124:127]
ds_read_b64_tr_b16 a[154:155], v26 offset:28672
v_max3_f32 v35, v35, v141, v142
v_mfma_f32_16x16x32_bf16 v[52:55], v[44:47], v[196:199], v[52:55]
s_waitcnt lgkmcnt(6)
v_mfma_f32_16x16x32_bf16 v[64:67], a[128:131], v[200:203], v[64:67]
ds_read_b64_tr_b16 a[156:157], v27 offset:24576
v_max3_f32 v34, v34, v139, v144
v_max3_f32 v35, v35, v143, v148
v_mfma_f32_16x16x32_bf16 v[68:71], a[128:131], v[204:207], v[68:71]
ds_read_b64_tr_b16 a[158:159], v27 offset:28672
v_max3_f32 v34, v34, v145, v146
v_mfma_f32_16x16x32_bf16 v[72:75], a[132:135], v[200:203], v[72:75]
s_waitcnt vmcnt(5)
s_barrier
ds_read_b128 a[96:99], v16 offset:49152
s_add_u32 m0, s37, 32768
v_mfma_f32_16x16x32_bf16 v[76:79], a[132:135], v[204:207], v[76:79]
buffer_load_dwordx4 v28, s[4:7], s38 offen offset:0 nt lds
v_mfma_f32_16x16x32_bf16 v[80:83], a[136:139], v[200:203], v[80:83]
ds_read_b128 a[100:103], v17 offset:49152
v_mfma_f32_16x16x32_bf16 v[84:87], a[136:139], v[204:207], v[84:87]
v_max3_f32 v35, v35, v149, v150
v_mfma_f32_16x16x32_bf16 v[88:91], a[140:143], v[200:203], v[88:91]
ds_read_b128 a[104:107], v18 offset:49152
v_max3_f32 v34, v34, v147, v152
v_max3_f32 v35, v35, v151, v156
v_mfma_f32_16x16x32_bf16 v[92:95], a[140:143], v[204:207], v[92:95]
buffer_load_dwordx4 v29, s[4:7], s38 offen offset:1024 nt lds
v_mfma_f32_16x16x32_bf16 v[48:51], v[44:47], v[200:203], v[48:51]
s_waitcnt lgkmcnt(3)
v_mfma_f32_16x16x32_bf16 v[96:99], a[144:147], v[200:203], v[96:99]
ds_read_b128 a[108:111], v19 offset:49152
v_mfma_f32_16x16x32_bf16 v[100:103], a[144:147], v[204:207], v[100:103]
v_max3_f32 v34, v34, v153, v154
v_max3_f32 v35, v35, v157, v158
v_mfma_f32_16x16x32_bf16 v[104:107], a[148:151], v[200:203], v[104:107]
ds_read_b128 a[112:115], v16 offset:53248
v_max_f32 v34, v34, v155
v_max_f32_e64 v35, v35, v159
v_mfma_f32_16x16x32_bf16 v[108:111], a[148:151], v[204:207], v[108:111]
buffer_load_dwordx4 v30, s[4:7], s38 offen offset:2048 nt lds
v_mfma_f32_16x16x32_bf16 v[112:115], a[152:155], v[200:203], v[112:115]
ds_read_b128 a[116:119], v17 offset:53248
v_mfma_f32_16x16x32_bf16 v[116:119], a[152:155], v[204:207], v[116:119]
v_max_f32_e64 v36, v34, v35
v_mfma_f32_16x16x32_bf16 v[120:123], a[156:159], v[200:203], v[120:123]
ds_read_b128 a[120:123], v18 offset:53248
v_mfma_f32_16x16x32_bf16 v[124:127], a[156:159], v[204:207], v[124:127]
buffer_load_dwordx4 v31, s[4:7], s38 offen offset:3072 nt lds
s_add_u32 s38, s38, 16384
v_mfma_f32_16x16x32_bf16 v[52:55], v[44:47], v[204:207], v[52:55]
s_bitcmp1_b32 0x0422c550, s43
s_cbranch_scc1 L_x_1
L_c_1:
v_cmp_lt_f32 vcc, s42, v36
s_cbranch_vccnz L_r_1
L_n_1:
s_add_u32 s43, s43, 1
s_waitcnt lgkmcnt(3)
v_mfma_f32_16x16x32_bf16 v[160:163], a[96:99], a[0:3], v[56:59]
ds_read_b128 a[124:127], v19 offset:53248
v_exp_f32 v128, v128
v_mfma_f32_16x16x32_bf16 v[164:167], a[96:99], a[16:19], v[60:63]
v_exp_f32 v129, v129
v_exp_f32 v130, v130
v_mfma_f32_16x16x32_bf16 v[160:163], a[100:103], a[4:7], v[160:163]
ds_read_b128 a[96:99], v16 offset:57344
v_exp_f32_e64 v131, v131
v_mfma_f32_16x16x32_bf16 v[164:167], a[100:103], a[20:23], v[164:167]
v_cvt_pk_bf16_f32 v192, v128, v129
v_exp_f32_e64 v132, v132
v_mfma_f32_16x16x32_bf16 v[160:163], a[104:107], a[8:11], v[160:163]
ds_read_b128 a[100:103], v17 offset:57344
v_exp_f32_e64 v133, v133
v_cvt_pk_bf16_f32 v193, v130, v131
v_mfma_f32_16x16x32_bf16 v[164:167], a[104:107], a[24:27], v[164:167]
v_exp_f32 v134, v134
v_exp_f32 v135, v135
v_mfma_f32_16x16x32_bf16 v[160:163], a[108:111], a[12:15], v[160:163]
ds_read_b128 a[104:107], v18 offset:57344
v_cvt_pk_bf16_f32 v196, v132, v133
v_mfma_f32_16x16x32_bf16 v[164:167], a[108:111], a[28:31], v[164:167]
v_exp_f32 v136, v136
v_exp_f32_e64 v137, v137
s_waitcnt lgkmcnt(3)
v_mfma_f32_16x16x32_bf16 v[168:171], a[112:115], a[0:3], v[56:59]
ds_read_b128 a[108:111], v19 offset:57344
v_cvt_pk_bf16_f32 v197, v134, v135
v_mfma_f32_16x16x32_bf16 v[172:175], a[112:115], a[16:19], v[60:63]
v_exp_f32 v138, v138
v_exp_f32 v139, v139
v_mfma_f32_16x16x32_bf16 v[168:171], a[116:119], a[4:7], v[168:171]
ds_read_b128 a[112:115], v16 offset:61440
v_cvt_pk_bf16_f32 v194, v136, v137
v_exp_f32_e64 v140, v140
v_mfma_f32_16x16x32_bf16 v[172:175], a[116:119], a[20:23], v[172:175]
v_exp_f32_e64 v141, v141
v_cvt_pk_bf16_f32 v195, v138, v139
v_mfma_f32_16x16x32_bf16 v[168:171], a[120:123], a[8:11], v[168:171]
ds_read_b128 a[116:119], v17 offset:61440
v_exp_f32_e64 v142, v142
v_mfma_f32_16x16x32_bf16 v[172:175], a[120:123], a[24:27], v[172:175]
v_exp_f32_e64 v143, v143
v_cvt_pk_bf16_f32 v198, v140, v141
v_mfma_f32_16x16x32_bf16 v[168:171], a[124:127], a[12:15], v[168:171]
ds_read_b128 a[120:123], v18 offset:61440
v_exp_f32 v144, v144
v_exp_f32 v145, v145
v_mfma_f32_16x16x32_bf16 v[172:175], a[124:127], a[28:31], v[172:175]
v_cvt_pk_bf16_f32 v199, v142, v143
s_waitcnt lgkmcnt(3)
v_mfma_f32_16x16x32_bf16 v[176:179], a[96:99], a[0:3], v[56:59]
ds_read_b128 a[124:127], v19 offset:61440
v_exp_f32 v146, v146
v_mfma_f32_16x16x32_bf16 v[180:183], a[96:99], a[16:19], v[60:63]
v_exp_f32_e64 v147, v147
v_cvt_pk_bf16_f32 v200, v144, v145
v_exp_f32_e64 v148, v148
v_mfma_f32_16x16x32_bf16 v[176:179], a[100:103], a[4:7], v[176:179]
s_waitcnt vmcnt(5)
s_barrier
ds_read_b64_tr_b16 a[128:129], v20 offset:32768
s_add_u32 m0, s37, 81920
v_mfma_f32_16x16x32_bf16 v[180:183], a[100:103], a[20:23], v[180:183]
ds_read_b64_tr_b16 a[130:131], v20 offset:36864
buffer_load_dwordx4 v32, s[8:11], s39 offen offset:0 nt lds
v_mfma_f32_16x16x32_bf16 v[176:179], a[104:107], a[8:11], v[176:179]
ds_read_b64_tr_b16 a[132:133], v21 offset:32768
v_mfma_f32_16x16x32_bf16 v[180:183], a[104:107], a[24:27], v[180:183]
ds_read_b64_tr_b16 a[134:135], v21 offset:36864
v_mfma_f32_16x16x32_bf16 v[176:179], a[108:111], a[12:15], v[176:179]
ds_read_b64_tr_b16 a[136:137], v22 offset:32768
v_exp_f32_e64 v149, v149
v_cvt_pk_bf16_f32 v201, v146, v147
v_mfma_f32_16x16x32_bf16 v[180:183], a[108:111], a[28:31], v[180:183]
ds_read_b64_tr_b16 a[138:139], v22 offset:36864
buffer_load_dwordx4 v33, s[8:11], s39 offen offset:1024 nt lds
s_waitcnt lgkmcnt(6)
v_mfma_f32_16x16x32_bf16 v[184:187], a[112:115], a[0:3], v[56:59]
ds_read_b64_tr_b16 a[140:141], v23 offset:32768
v_mfma_f32_16x16x32_bf16 v[188:191], a[112:115], a[16:19], v[60:63]
ds_read_b64_tr_b16 a[142:143], v23 offset:36864
v_exp_f32 v150, v150
v_mfma_f32_16x16x32_bf16 v[184:187], a[116:119], a[4:7], v[184:187]
ds_read_b64_tr_b16 a[144:145], v24 offset:32768
v_exp_f32_e64 v151, v151
v_cvt_pk_bf16_f32 v204, v148, v149
v_mfma_f32_16x16x32_bf16 v[188:191], a[116:119], a[20:23], v[188:191]
ds_read_b64_tr_b16 a[146:147], v24 offset:36864
buffer_load_dwordx4 v32, s[8:11], s39 offen offset:2048 nt lds
v_mfma_f32_16x16x32_bf16 v[184:187], a[120:123], a[8:11], v[184:187]
ds_read_b64_tr_b16 a[148:149], v25 offset:32768
s_nop 0
v_mfma_f32_16x16x32_bf16 v[188:191], a[120:123], a[24:27], v[188:191]
ds_read_b64_tr_b16 a[150:151], v25 offset:36864
v_cvt_pk_bf16_f32 v205, v150, v151
v_mfma_f32_16x16x32_bf16 v[184:187], a[124:127], a[12:15], v[184:187]
ds_read_b64_tr_b16 a[152:153], v26 offset:32768
v_mfma_f32_16x16x32_bf16 v[188:191], a[124:127], a[28:31], v[188:191]
ds_read_b64_tr_b16 a[154:155], v26 offset:36864
buffer_load_dwordx4 v33, s[8:11], s39 offen offset:3072 nt lds
s_add_u32 s39, s39, 16384
s_waitcnt lgkmcnt(6)
v_mfma_f32_16x16x32_bf16 v[64:67], a[128:131], v[192:195], v[64:67]
ds_read_b64_tr_b16 a[156:157], v27 offset:32768
v_exp_f32_e64 v152, v152
v_mfma_f32_16x16x32_bf16 v[68:71], a[128:131], v[196:199], v[68:71]
ds_read_b64_tr_b16 a[158:159], v27 offset:36864
v_exp_f32_e64 v153, v153
v_mfma_f32_16x16x32_bf16 v[72:75], a[132:135], v[192:195], v[72:75]
ds_read_b64_tr_b16 a[128:129], v20 offset:40960
v_exp_f32_e64 v154, v154
v_mfma_f32_16x16x32_bf16 v[76:79], a[132:135], v[196:199], v[76:79]
ds_read_b64_tr_b16 a[130:131], v20 offset:45056
v_exp_f32_e64 v155, v155
v_mfma_f32_16x16x32_bf16 v[80:83], a[136:139], v[192:195], v[80:83]
ds_read_b64_tr_b16 a[132:133], v21 offset:40960
v_cvt_pk_bf16_f32 v202, v152, v153
v_mfma_f32_16x16x32_bf16 v[84:87], a[136:139], v[196:199], v[84:87]
ds_read_b64_tr_b16 a[134:135], v21 offset:45056
v_exp_f32_e64 v156, v156
v_mfma_f32_16x16x32_bf16 v[88:91], a[140:143], v[192:195], v[88:91]
ds_read_b64_tr_b16 a[136:137], v22 offset:40960
v_exp_f32_e64 v157, v157
v_mfma_f32_16x16x32_bf16 v[92:95], a[140:143], v[196:199], v[92:95]
ds_read_b64_tr_b16 a[138:139], v22 offset:45056
v_cvt_pk_bf16_f32 v203, v154, v155
v_mfma_f32_16x16x32_bf16 v[48:51], v[44:47], v[192:195], v[48:51]
s_waitcnt lgkmcnt(6)
v_mfma_f32_16x16x32_bf16 v[96:99], a[144:147], v[192:195], v[96:99]
ds_read_b64_tr_b16 a[140:141], v23 offset:40960
v_exp_f32 v158, v158
v_mfma_f32_16x16x32_bf16 v[100:103], a[144:147], v[196:199], v[100:103]
ds_read_b64_tr_b16 a[142:143], v23 offset:45056
v_exp_f32_e64 v159, v159
v_mfma_f32_16x16x32_bf16 v[104:107], a[148:151], v[192:195], v[104:107]
ds_read_b64_tr_b16 a[144:145], v24 offset:40960
v_cvt_pk_bf16_f32 v206, v156, v157
v_mfma_f32_16x16x32_bf16 v[108:111], a[148:151], v[196:199], v[108:111]
ds_read_b64_tr_b16 a[146:147], v24 offset:45056
s_nop 0
v_cvt_pk_bf16_f32 v207, v158, v159
v_mfma_f32_16x16x32_bf16 v[112:115], a[152:155], v[192:195], v[112:115]
ds_read_b64_tr_b16 a[148:149], v25 offset:40960
v_max3_f32 v34, v160, v161, v162
v_max3_f32 v35, v164, v165, v166
v_mfma_f32_16x16x32_bf16 v[116:119], a[152:155], v[196:199], v[116:119]
ds_read_b64_tr_b16 a[150:151], v25 offset:45056
v_max3_f32 v34, v34, v163, v168
v_mfma_f32_16x16x32_bf16 v[120:123], a[156:159], v[192:195], v[120:123]
ds_read_b64_tr_b16 a[152:153], v26 offset:40960
v_max3_f32 v35, v35, v167, v172
v_max3_f32 v34, v34, v169, v170
v_mfma_f32_16x16x32_bf16 v[124:127], a[156:159], v[196:199], v[124:127]
ds_read_b64_tr_b16 a[154:155], v26 offset:45056
v_max3_f32 v35, v35, v173, v174
v_mfma_f32_16x16x32_bf16 v[52:55], v[44:47], v[196:199], v[52:55]
s_waitcnt lgkmcnt(6)
v_mfma_f32_16x16x32_bf16 v[64:67], a[128:131], v[200:203], v[64:67]
ds_read_b64_tr_b16 a[156:157], v27 offset:40960
v_max3_f32 v34, v34, v171, v176
v_max3_f32 v35, v35, v175, v180
v_mfma_f32_16x16x32_bf16 v[68:71], a[128:131], v[204:207], v[68:71]
ds_read_b64_tr_b16 a[158:159], v27 offset:45056
v_max3_f32 v34, v34, v177, v178
v_mfma_f32_16x16x32_bf16 v[72:75], a[132:135], v[200:203], v[72:75]
s_waitcnt vmcnt(5)
s_barrier
ds_read_b128 a[96:99], v16 offset:0
s_add_u32 m0, s37, 49152
v_mfma_f32_16x16x32_bf16 v[76:79], a[132:135], v[204:207], v[76:79]
buffer_load_dwordx4 v28, s[4:7], s38 offen offset:0 nt lds
v_mfma_f32_16x16x32_bf16 v[80:83], a[136:139], v[200:203], v[80:83]
ds_read_b128 a[100:103], v17 offset:0
v_mfma_f32_16x16x32_bf16 v[84:87], a[136:139], v[204:207], v[84:87]
v_max3_f32 v35, v35, v181, v182
v_mfma_f32_16x16x32_bf16 v[88:91], a[140:143], v[200:203], v[88:91]
ds_read_b128 a[104:107], v18 offset:0
v_max3_f32 v34, v34, v179, v184
v_max3_f32 v35, v35, v183, v188
v_mfma_f32_16x16x32_bf16 v[92:95], a[140:143], v[204:207], v[92:95]
buffer_load_dwordx4 v29, s[4:7], s38 offen offset:1024 nt lds
v_mfma_f32_16x16x32_bf16 v[48:51], v[44:47], v[200:203], v[48:51]
s_waitcnt lgkmcnt(3)
v_mfma_f32_16x16x32_bf16 v[96:99], a[144:147], v[200:203], v[96:99]
ds_read_b128 a[108:111], v19 offset:0
v_mfma_f32_16x16x32_bf16 v[100:103], a[144:147], v[204:207], v[100:103]
v_max3_f32 v34, v34, v185, v186
v_max3_f32 v35, v35, v189, v190
v_mfma_f32_16x16x32_bf16 v[104:107], a[148:151], v[200:203], v[104:107]
ds_read_b128 a[112:115], v16 offset:4096
v_max_f32 v34, v34, v187
v_max_f32_e64 v35, v35, v191
v_mfma_f32_16x16x32_bf16 v[108:111], a[148:151], v[204:207], v[108:111]
buffer_load_dwordx4 v30, s[4:7], s38 offen offset:2048 nt lds
v_mfma_f32_16x16x32_bf16 v[112:115], a[152:155], v[200:203], v[112:115]
ds_read_b128 a[116:119], v17 offset:4096
v_mfma_f32_16x16x32_bf16 v[116:119], a[152:155], v[204:207], v[116:119]
v_max_f32_e64 v36, v34, v35
v_mfma_f32_16x16x32_bf16 v[120:123], a[156:159], v[200:203], v[120:123]
ds_read_b128 a[120:123], v18 offset:4096
v_mfma_f32_16x16x32_bf16 v[124:127], a[156:159], v[204:207], v[124:127]
buffer_load_dwordx4 v31, s[4:7], s38 offen offset:3072 nt lds
s_add_u32 s38, s38, 16384
v_mfma_f32_16x16x32_bf16 v[52:55], v[44:47], v[204:207], v[52:55]
s_bitcmp1_b32 0x0422c550, s43
s_cbranch_scc1 L_x_2
L_c_2:
v_cmp_lt_f32 vcc, s42, v36
s_cbranch_vccnz L_r_2
L_n_2:
s_add_u32 s43, s43, 1
s_waitcnt lgkmcnt(3)
v_mfma_f32_16x16x32_bf16 v[128:131], a[96:99], a[0:3], v[56:59]
ds_read_b128 a[124:127], v19 offset:4096
v_exp_f32 v160, v160
v_mfma_f32_16x16x32_bf16 v[132:135], a[96:99], a[16:19], v[60:63]
v_exp_f32 v161, v161
v_exp_f32 v162, v162
v_mfma_f32_16x16x32_bf16 v[128:131], a[100:103], a[4:7], v[128:131]
ds_read_b128 a[96:99], v16 offset:8192
v_exp_f32_e64 v163, v163
v_mfma_f32_16x16x32_bf16 v[132:135], a[100:103], a[20:23], v[132:135]
v_cvt_pk_bf16_f32 v192, v160, v161
v_exp_f32_e64 v164, v164
v_mfma_f32_16x16x32_bf16 v[128:131], a[104:107], a[8:11], v[128:131]
ds_read_b128 a[100:103], v17 offset:8192
v_exp_f32_e64 v165, v165
v_cvt_pk_bf16_f32 v193, v162, v163
v_mfma_f32_16x16x32_bf16 v[132:135], a[104:107], a[24:27], v[132:135]
v_exp_f32 v166, v166
v_exp_f32 v167, v167
v_mfma_f32_16x16x32_bf16 v[128:131], a[108:111], a[12:15], v[128:131]
ds_read_b128 a[104:107], v18 offset:8192
v_cvt_pk_bf16_f32 v196, v164, v165
v_mfma_f32_16x16x32_bf16 v[132:135], a[108:111], a[28:31], v[132:135]
v_exp_f32 v168, v168
v_exp_f32_e64 v169, v169
s_waitcnt lgkmcnt(3)
v_mfma_f32_16x16x32_bf16 v[136:139], a[112:115], a[0:3], v[56:59]
ds_read_b128 a[108:111], v19 offset:8192
v_cvt_pk_bf16_f32 v197, v166, v167
v_mfma_f32_16x16x32_bf16 v[140:143], a[112:115], a[16:19], v[60:63]
v_exp_f32 v170, v170
v_exp_f32 v171, v171
v_mfma_f32_16x16x32_bf16 v[136:139], a[116:119], a[4:7], v[136:139]
ds_read_b128 a[112:115], v16 offset:12288
v_cvt_pk_bf16_f32 v194, v168, v169
v_exp_f32_e64 v172, v172
v_mfma_f32_16x16x32_bf16 v[140:143], a[116:119], a[20:23], v[140:143]
v_exp_f32_e64 v173, v173
v_cvt_pk_bf16_f32 v195, v170, v171
v_mfma_f32_16x16x32_bf16 v[136:139], a[120:123], a[8:11], v[136:139]
ds_read_b128 a[116:119], v17 offset:12288
v_exp_f32_e64 v174, v174
v_mfma_f32_16x16x32_bf16 v[140:143], a[120:123], a[24:27], v[140:143]
v_exp_f32_e64 v175, v175
v_cvt_pk_bf16_f32 v198, v172, v173
v_mfma_f32_16x16x32_bf16 v[136:139], a[124:127], a[12:15], v[136:139]
ds_read_b128 a[120:123], v18 offset:12288
v_exp_f32 v176, v176
v_exp_f32 v177, v177
v_mfma_f32_16x16x32_bf16 v[140:143], a[124:127], a[28:31], v[140:143]
v_cvt_pk_bf16_f32 v199, v174, v175
s_waitcnt lgkmcnt(3)
v_mfma_f32_16x16x32_bf16 v[144:147], a[96:99], a[0:3], v[56:59]
ds_read_b128 a[124:127], v19 offset:12288
v_exp_f32 v178, v178
v_mfma_f32_16x16x32_bf16 v[148:151], a[96:99], a[16:19], v[60:63]
v_exp_f32_e64 v179, v179
v_cvt_pk_bf16_f32 v200, v176, v177
v_exp_f32_e64 v180, v180
v_mfma_f32_16x16x32_bf16 v[144:147], a[100:103], a[4:7], v[144:147]
s_waitcnt vmcnt(5)
s_barrier
ds_read_b64_tr_b16 a[128:129], v20 offset:49152
s_add_u32 m0, s37, 98304
v_mfma_f32_16x16x32_bf16 v[148:151], a[100:103], a[20:23], v[148:151]
ds_read_b64_tr_b16 a[130:131], v20 offset:53248
buffer_load_dwordx4 v32, s[8:11], s39 offen offset:0 nt lds
v_mfma_f32_16x16x32_bf16 v[144:147], a[104:107], a[8:11], v[144:147]
ds_read_b64_tr_b16 a[132:133], v21 offset:49152
v_mfma_f32_16x16x32_bf16 v[148:151], a[104:107], a[24:27], v[148:151]
ds_read_b64_tr_b16 a[134:135], v21 offset:53248
v_mfma_f32_16x16x32_bf16 v[144:147], a[108:111], a[12:15], v[144:147]
ds_read_b64_tr_b16 a[136:137], v22 offset:49152
v_exp_f32_e64 v181, v181
v_cvt_pk_bf16_f32 v201, v178, v179
v_mfma_f32_16x16x32_bf16 v[148:151], a[108:111], a[28:31], v[148:151]
ds_read_b64_tr_b16 a[138:139], v22 offset:53248
buffer_load_dwordx4 v33, s[8:11], s39 offen offset:1024 nt lds
s_waitcnt lgkmcnt(6)
v_mfma_f32_16x16x32_bf16 v[152:155], a[112:115], a[0:3], v[56:59]
ds_read_b64_tr_b16 a[140:141], v23 offset:49152
v_mfma_f32_16x16x32_bf16 v[156:159], a[112:115], a[16:19], v[60:63]
ds_read_b64_tr_b16 a[142:143], v23 offset:53248
v_exp_f32 v182, v182
v_mfma_f32_16x16x32_bf16 v[152:155], a[116:119], a[4:7], v[152:155]
ds_read_b64_tr_b16 a[144:145], v24 offset:49152
v_exp_f32_e64 v183, v183
v_cvt_pk_bf16_f32 v204, v180, v181
v_mfma_f32_16x16x32_bf16 v[156:159], a[116:119], a[20:23], v[156:159]
ds_read_b64_tr_b16 a[146:147], v24 offset:53248
buffer_load_dwordx4 v32, s[8:11], s39 offen offset:2048 nt lds
v_mfma_f32_16x16x32_bf16 v[152:155], a[120:123], a[8:11], v[152:155]
ds_read_b64_tr_b16 a[148:149], v25 offset:49152
s_nop 0
v_mfma_f32_16x16x32_bf16 v[156:159], a[120:123], a[24:27], v[156:159]
ds_read_b64_tr_b16 a[150:151], v25 offset:53248
v_cvt_pk_bf16_f32 v205, v182, v183
v_mfma_f32_16x16x32_bf16 v[152:155], a[124:127], a[12:15], v[152:155]
ds_read_b64_tr_b16 a[152:153], v26 offset:49152
v_mfma_f32_16x16x32_bf16 v[156:159], a[124:127], a[28:31], v[156:159]
ds_read_b64_tr_b16 a[154:155], v26 offset:53248
buffer_load_dwordx4 v33, s[8:11], s39 offen offset:3072 nt lds
s_add_u32 s39, s39, 16384
s_waitcnt lgkmcnt(6)
v_mfma_f32_16x16x32_bf16 v[64:67], a[128:131], v[192:195], v[64:67]
ds_read_b64_tr_b16 a[156:157], v27 offset:49152
v_exp_f32_e64 v184, v184
v_mfma_f32_16x16x32_bf16 v[68:71], a[128:131], v[196:199], v[68:71]
ds_read_b64_tr_b16 a[158:159], v27 offset:53248
v_exp_f32_e64 v185, v185
v_mfma_f32_16x16x32_bf16 v[72:75], a[132:135], v[192:195], v[72:75]
ds_read_b64_tr_b16 a[128:129], v20 offset:57344
v_exp_f32_e64 v186, v186
v_mfma_f32_16x16x32_bf16 v[76:79], a[132:135], v[196:199], v[76:79]
ds_read_b64_tr_b16 a[130:131], v20 offset:61440
v_exp_f32_e64 v187, v187
v_mfma_f32_16x16x32_bf16 v[80:83], a[136:139], v[192:195], v[80:83]
ds_read_b64_tr_b16 a[132:133], v21 offset:57344
v_cvt_pk_bf16_f32 v202, v184, v185
v_mfma_f32_16x16x32_bf16 v[84:87], a[136:139], v[196:199], v[84:87]
ds_read_b64_tr_b16 a[134:135], v21 offset:61440
v_exp_f32_e64 v188, v188
v_mfma_f32_16x16x32_bf16 v[88:91], a[140:143], v[192:195], v[88:91]
ds_read_b64_tr_b16 a[136:137], v22 offset:57344
v_exp_f32_e64 v189, v189
v_mfma_f32_16x16x32_bf16 v[92:95], a[140:143], v[196:199], v[92:95]
ds_read_b64_tr_b16 a[138:139], v22 offset:61440
v_cvt_pk_bf16_f32 v203, v186, v187
v_mfma_f32_16x16x32_bf16 v[48:51], v[44:47], v[192:195], v[48:51]
s_waitcnt lgkmcnt(6)
v_mfma_f32_16x16x32_bf16 v[96:99], a[144:147], v[192:195], v[96:99]
ds_read_b64_tr_b16 a[140:141], v23 offset:57344
v_exp_f32 v190, v190
v_mfma_f32_16x16x32_bf16 v[100:103], a[144:147], v[196:199], v[100:103]
ds_read_b64_tr_b16 a[142:143], v23 offset:61440
v_exp_f32_e64 v191, v191
v_mfma_f32_16x16x32_bf16 v[104:107], a[148:151], v[192:195], v[104:107]
ds_read_b64_tr_b16 a[144:145], v24 offset:57344
v_cvt_pk_bf16_f32 v206, v188, v189
v_mfma_f32_16x16x32_bf16 v[108:111], a[148:151], v[196:199], v[108:111]
ds_read_b64_tr_b16 a[146:147], v24 offset:61440
s_nop 0
v_cvt_pk_bf16_f32 v207, v190, v191
v_mfma_f32_16x16x32_bf16 v[112:115], a[152:155], v[192:195], v[112:115]
ds_read_b64_tr_b16 a[148:149], v25 offset:57344
v_max3_f32 v34, v128, v129, v130
v_max3_f32 v35, v132, v133, v134
v_mfma_f32_16x16x32_bf16 v[116:119], a[152:155], v[196:199], v[116:119]
ds_read_b64_tr_b16 a[150:151], v25 offset:61440
v_max3_f32 v34, v34, v131, v136
v_mfma_f32_16x16x32_bf16 v[120:123], a[156:159], v[192:195], v[120:123]
ds_read_b64_tr_b16 a[152:153], v26 offset:57344
v_max3_f32 v35, v35, v135, v140
v_max3_f32 v34, v34, v137, v138
v_mfma_f32_16x16x32_bf16 v[124:127], a[156:159], v[196:199], v[124:127]
ds_read_b64_tr_b16 a[154:155], v26 offset:61440
v_max3_f32 v35, v35, v141, v142
v_mfma_f32_16x16x32_bf16 v[52:55], v[44:47], v[196:199], v[52:55]
s_waitcnt lgkmcnt(6)
v_mfma_f32_16x16x32_bf16 v[64:67], a[128:131], v[200:203], v[64:67]
ds_read_b64_tr_b16 a[156:157], v27 offset:57344
v_max3_f32 v34, v34, v139, v144
v_max3_f32 v35, v35, v143, v148
v_mfma_f32_16x16x32_bf16 v[68:71], a[128:131], v[204:207], v[68:71]
ds_read_b64_tr_b16 a[158:159], v27 offset:61440
v_max3_f32 v34, v34, v145, v146
v_mfma_f32_16x16x32_bf16 v[72:75], a[132:135], v[200:203], v[72:75]
s_waitcnt vmcnt(5)
s_barrier
ds_read_b128 a[96:99], v16 offset:16384
s_add_u32 m0, s37, 0
v_mfma_f32_16x16x32_bf16 v[76:79], a[132:135], v[204:207], v[76:79]
buffer_load_dwordx4 v28, s[4:7], s38 offen offset:0 nt lds
v_mfma_f32_16x16x32_bf16 v[80:83], a[136:139], v[200:203], v[80:83]
ds_read_b128 a[100:103], v17 offset:16384
v_mfma_f32_16x16x32_bf16 v[84:87], a[136:139], v[204:207], v[84:87]
v_max3_f32 v35, v35, v149, v150
v_mfma_f32_16x16x32_bf16 v[88:91], a[140:143], v[200:203], v[88:91]
ds_read_b128 a[104:107], v18 offset:16384
v_max3_f32 v34, v34, v147, v152
v_max3_f32 v35, v35, v151, v156
v_mfma_f32_16x16x32_bf16 v[92:95], a[140:143], v[204:207], v[92:95]
buffer_load_dwordx4 v29, s[4:7], s38 offen offset:1024 nt lds
v_mfma_f32_16x16x32_bf16 v[48:51], v[44:47], v[200:203], v[48:51]
s_waitcnt lgkmcnt(3)
v_mfma_f32_16x16x32_bf16 v[96:99], a[144:147], v[200:203], v[96:99]
ds_read_b128 a[108:111], v19 offset:16384
v_mfma_f32_16x16x32_bf16 v[100:103], a[144:147], v[204:207], v[100:103]
v_max3_f32 v34, v34, v153, v154
v_max3_f32 v35, v35, v157, v158
v_mfma_f32_16x16x32_bf16 v[104:107], a[148:151], v[200:203], v[104:107]
ds_read_b128 a[112:115], v16 offset:20480
v_max_f32 v34, v34, v155
v_max_f32 v35, v35, v159
v_mfma_f32_16x16x32_bf16 v[108:111], a[148:151], v[204:207], v[108:111]
buffer_load_dwordx4 v30, s[4:7], s38 offen offset:2048 nt lds
v_mfma_f32_16x16x32_bf16 v[112:115], a[152:155], v[200:203], v[112:115]
ds_read_b128 a[116:119], v17 offset:20480
v_mfma_f32_16x16x32_bf16 v[116:119], a[152:155], v[204:207], v[116:119]
v_max_f32_e64 v36, v34, v35
v_mfma_f32_16x16x32_bf16 v[120:123], a[156:159], v[200:203], v[120:123]
ds_read_b128 a[120:123], v18 offset:20480
v_mfma_f32_16x16x32_bf16 v[124:127], a[156:159], v[204:207], v[124:127]
buffer_load_dwordx4 v31, s[4:7], s38 offen offset:3072 nt lds
s_add_u32 s38, s38, 16384
v_mfma_f32_16x16x32_bf16 v[52:55], v[44:47], v[204:207], v[52:55]
s_bitcmp1_b32 0x0422c550, s43
s_cbranch_scc1 L_x_3
L_c_3:
v_cmp_lt_f32 vcc, s42, v36
s_cbranch_vccnz L_r_3
L_n_3:
s_add_u32 s43, s43, 1
s_branch L_loop
L_x_0:
s_call_b64 s[92:93], L_extras
s_branch L_c_0
L_r_0:
s_call_b64 s[94:95], L_rare
s_branch L_n_0
L_x_1:
s_call_b64 s[92:93], L_extras
s_branch L_c_1
L_r_1:
s_call_b64 s[94:95], L_rare
s_branch L_n_1
L_x_2:
s_call_b64 s[92:93], L_extras
s_branch L_c_2
L_r_2:
s_call_b64 s[94:95], L_rare
s_branch L_n_2
L_x_3:
s_call_b64 s[92:93], L_extras
s_branch L_c_3
L_r_3:
s_call_b64 s[94:95], L_rare
s_branch L_n_3
.p2align 3
L_init:
s_mov_b32 s46, 0xf149f2ca
v_mov_b32 v37, v34
v_mov_b32 v36, v35
s_nop 0
v_permlane32_swap_b32 v34, v37
v_permlane32_swap_b32 v35, v36
v_max_f32 v34, v34, v37
v_max_f32 v35, v35, v36
v_mov_b32 v37, v34
v_mov_b32 v36, v35
s_nop 0
v_permlane16_swap_b32 v34, v37
v_permlane16_swap_b32 v35, v36
v_max3_f32 v34, v34, v37, s46
v_max3_f32 v35, v35, v36, s46
v_sub_f32 v56, 0, v34
v_sub_f32 v57, 0, v34
v_sub_f32 v58, 0, v34
v_sub_f32 v59, 0, v34
v_sub_f32 v60, 0, v35
v_sub_f32 v61, 0, v35
v_sub_f32 v62, 0, v35
v_sub_f32 v63, 0, v35
v_sub_f32 v128, v128, v34
v_sub_f32 v129, v129, v34
v_sub_f32 v130, v130, v34
v_sub_f32 v131, v131, v34
v_sub_f32 v132, v132, v35
v_sub_f32 v133, v133, v35
v_sub_f32 v134, v134, v35
v_sub_f32 v135, v135, v35
v_sub_f32 v136, v136, v34
v_sub_f32 v137, v137, v34
v_sub_f32 v138, v138, v34
v_sub_f32 v139, v139, v34
v_sub_f32 v140, v140, v35
v_sub_f32 v141, v141, v35
v_sub_f32 v142, v142, v35
v_sub_f32 v143, v143, v35
v_sub_f32 v144, v144, v34
v_sub_f32 v145, v145, v34
v_sub_f32 v146, v146, v34
v_sub_f32 v147, v147, v34
v_sub_f32 v148, v148, v35
v_sub_f32 v149, v149, v35
v_sub_f32 v150, v150, v35
v_sub_f32 v151, v151, v35
v_sub_f32 v152, v152, v34
v_sub_f32 v153, v153, v34
v_sub_f32 v154, v154, v34
v_sub_f32 v155, v155, v34
v_sub_f32 v156, v156, v35
v_sub_f32 v157, v157, v35
v_sub_f32 v158, v158, v35
v_sub_f32 v159, v159, v35
v_mov_b32 v36, 0
s_setpc_b64 s[92:93]
L_rare:
v_mov_b32 v37, v34
v_mov_b32 v36, v35
s_nop 0
v_permlane32_swap_b32 v34, v37
v_permlane32_swap_b32 v35, v36
v_max_f32 v34, v34, v37
v_max_f32 v35, v35, v36
v_mov_b32 v37, v34
v_mov_b32 v36, v35
s_nop 0
v_permlane16_swap_b32 v34, v37
v_permlane16_swap_b32 v35, v36
v_max3_f32 v34, v34, v37, 0
v_max3_f32 v35, v35, v36, 0
v_exp_f32 v38, -v34
v_exp_f32 v39, -v35
v_sub_f32 v56, v56, v34
v_sub_f32 v57, v57, v34
v_sub_f32 v58, v58, v34
v_sub_f32 v59, v59, v34
v_sub_f32 v60, v60, v35
v_sub_f32 v61, v61, v35
v_sub_f32 v62, v62, v35
v_sub_f32 v63, v63, v35
v_mul_f32 v48, v38, v48
v_mul_f32 v52, v39, v52
v_mul_f32 v64, v38, v64
v_mul_f32 v65, v38, v65
v_mul_f32 v66, v38, v66
v_mul_f32 v67, v38, v67
v_mul_f32 v68, v39, v68
v_mul_f32 v69, v39, v69
v_mul_f32 v70, v39, v70
v_mul_f32 v71, v39, v71
v_mul_f32 v72, v38, v72
v_mul_f32 v73, v38, v73
v_mul_f32 v74, v38, v74
v_mul_f32 v75, v38, v75
v_mul_f32 v76, v39, v76
v_mul_f32 v77, v39, v77
v_mul_f32 v78, v39, v78
v_mul_f32 v79, v39, v79
v_mul_f32 v80, v38, v80
v_mul_f32 v81, v38, v81
v_mul_f32 v82, v38, v82
v_mul_f32 v83, v38, v83
v_mul_f32 v84, v39, v84
v_mul_f32 v85, v39, v85
v_mul_f32 v86, v39, v86
v_mul_f32 v87, v39, v87
v_mul_f32 v88, v38, v88
v_mul_f32 v89, v38, v89
v_mul_f32 v90, v38, v90
v_mul_f32 v91, v38, v91
v_mul_f32 v92, v39, v92
v_mul_f32 v93, v39, v93
v_mul_f32 v94, v39, v94
v_mul_f32 v95, v39, v95
v_mul_f32 v96, v38, v96
v_mul_f32 v97, v38, v97
v_mul_f32 v98, v38, v98
v_mul_f32 v99, v38, v99
v_mul_f32 v100, v39, v100
v_mul_f32 v101, v39, v101
v_mul_f32 v102, v39, v102
v_mul_f32 v103, v39, v103
v_mul_f32 v104, v38, v104
v_mul_f32 v105, v38, v105
v_mul_f32 v106, v38, v106
v_mul_f32 v107, v38, v107
v_mul_f32 v108, v39, v108
v_mul_f32 v109, v39, v109
v_mul_f32 v110, v39, v110
v_mul_f32 v111, v39, v111
v_mul_f32 v112, v38, v112
v_mul_f32 v113, v38, v113
v_mul_f32 v114, v38, v114
v_mul_f32 v115, v38, v115
v_mul_f32 v116, v39, v116
v_mul_f32 v117, v39, v117
v_mul_f32 v118, v39, v118
v_mul_f32 v119, v39, v119
v_mul_f32 v120, v38, v120
v_mul_f32 v121, v38, v121
v_mul_f32 v122, v38, v122
v_mul_f32 v123, v38, v123
v_mul_f32 v124, v39, v124
v_mul_f32 v125, v39, v125
v_mul_f32 v126, v39, v126
v_mul_f32 v127, v39, v127
s_bitcmp1_b32 s43, 0
s_cbranch_scc1 L_rare_a
v_sub_f32 v160, v160, v34
v_sub_f32 v161, v161, v34
v_sub_f32 v162, v162, v34
v_sub_f32 v163, v163, v34
v_sub_f32 v164, v164, v35
v_sub_f32 v165, v165, v35
v_sub_f32 v166, v166, v35
v_sub_f32 v167, v167, v35
v_sub_f32 v168, v168, v34
v_sub_f32 v169, v169, v34
v_sub_f32 v170, v170, v34
v_sub_f32 v171, v171, v34
v_sub_f32 v172, v172, v35
v_sub_f32 v173, v173, v35
v_sub_f32 v174, v174, v35
v_sub_f32 v175, v175, v35
v_sub_f32 v176, v176, v34
v_sub_f32 v177, v177, v34
v_sub_f32 v178, v178, v34
v_sub_f32 v179, v179, v34
v_sub_f32 v180, v180, v35
v_sub_f32 v181, v181, v35
v_sub_f32 v182, v182, v35
v_sub_f32 v183, v183, v35
v_sub_f32 v184, v184, v34
v_sub_f32 v185, v185, v34
v_sub_f32 v186, v186, v34
v_sub_f32 v187, v187, v34
v_sub_f32 v188, v188, v35
v_sub_f32 v189, v189, v35
v_sub_f32 v190, v190, v35
v_sub_f32 v191, v191, v35
s_setpc_b64 s[94:95]
L_rare_a:
v_sub_f32 v128, v128, v34
v_sub_f32 v129, v129, v34
v_sub_f32 v130, v130, v34
v_sub_f32 v131, v131, v34
v_sub_f32 v132, v132, v35
v_sub_f32 v133, v133, v35
v_sub_f32 v134, v134, v35
v_sub_f32 v135, v135, v35
v_sub_f32 v136, v136, v34
v_sub_f32 v137, v137, v34
v_sub_f32 v138, v138, v34
v_sub_f32 v139, v139, v34
v_sub_f32 v140, v140, v35
v_sub_f32 v141, v141, v35
v_sub_f32 v142, v142, v35
v_sub_f32 v143, v143, v35
v_sub_f32 v144, v144, v34
v_sub_f32 v145, v145, v34
v_sub_f32 v146, v146, v34
v_sub_f32 v147, v147, v34
v_sub_f32 v148, v148, v35
v_sub_f32 v149, v149, v35
v_sub_f32 v150, v150, v35
v_sub_f32 v151, v151, v35
v_sub_f32 v152, v152, v34
v_sub_f32 v153, v153, v34
v_sub_f32 v154, v154, v34
v_sub_f32 v155, v155, v34
v_sub_f32 v156, v156, v35
v_sub_f32 v157, v157, v35
v_sub_f32 v158, v158, v35
v_sub_f32 v159, v159, v35
s_setpc_b64 s[94:95]
L_extras:
s_cmp_ge_u32 s43, 14
s_cbranch_scc1 Ld_1
s_cmp_ge_u32 s43, 8
s_cbranch_scc1 Ld_2
s_cmp_eq_u32 s43, 4
s_cbranch_scc1 L_t4
s_branch L_t6
Ld_2:
s_cmp_eq_u32 s43, 8
s_cbranch_scc1 L_t8
s_branch L_t10
Ld_1:
s_cmp_ge_u32 s43, 17
s_cbranch_scc1 Ld_3
s_cmp_eq_u32 s43, 14
s_cbranch_scc1 L_t14
s_branch L_t15
Ld_3:
s_cmp_ge_u32 s43, 21
s_cbranch_scc1 Ld_4
s_branch L_t17
Ld_4:
s_cmp_eq_u32 s43, 21
s_cbranch_scc1 L_t21
s_branch L_t26
L_t4:
v_mov_b32 v38, s44
v_mov_b32_e64 v39, s44
v_accvgpr_read_b32 v192, a32
v_accvgpr_read_b32 v193, a33
v_accvgpr_read_b32 v194, a34
v_accvgpr_read_b32 v195, a35
v_accvgpr_read_b32 v196, a36
v_accvgpr_read_b32 v197, a37
v_accvgpr_read_b32 v198, a38
v_accvgpr_read_b32 v199, a39
v_accvgpr_read_b32 v200, a40
v_accvgpr_read_b32 v201, a41
v_accvgpr_read_b32 v202, a42
v_accvgpr_read_b32 v203, a43
v_accvgpr_read_b32 v204, a44
v_accvgpr_read_b32 v205, a45
v_accvgpr_read_b32 v206, a46
v_accvgpr_read_b32 v207, a47
v_pk_mul_f32 v[192:193], v[192:193], v[38:39]
v_pk_mul_f32 v[194:195], v[194:195], v[38:39]
v_pk_mul_f32 v[196:197], v[196:197], v[38:39]
v_pk_mul_f32 v[198:199], v[198:199], v[38:39]
v_pk_mul_f32 v[200:201], v[200:201], v[38:39]
v_pk_mul_f32 v[202:203], v[202:203], v[38:39]
v_pk_mul_f32 v[204:205], v[204:205], v[38:39]
v_pk_mul_f32 v[206:207], v[206:207], v[38:39]
v_cvt_pk_bf16_f32 v192, v192, v193
v_cvt_pk_bf16_f32 v193, v194, v195
v_cvt_pk_bf16_f32 v196, v196, v197
v_cvt_pk_bf16_f32 v197, v198, v199
v_cvt_pk_bf16_f32 v200, v200, v201
v_cvt_pk_bf16_f32 v201, v202, v203
v_cvt_pk_bf16_f32 v204, v204, v205
v_cvt_pk_bf16_f32 v205, v206, v207
s_nop 0
v_permlane32_swap_b32 v192, v200
v_permlane32_swap_b32 v193, v201
v_permlane32_swap_b32 v196, v204
v_permlane32_swap_b32 v197, v205
v_permlane16_swap_b32 v192, v200
v_permlane16_swap_b32 v193, v201
v_permlane16_swap_b32 v196, v204
v_permlane16_swap_b32 v197, v205
v_accvgpr_write_b32 a224, v192
v_accvgpr_write_b32 a225, v193
v_accvgpr_write_b32 a226, v200
v_accvgpr_write_b32 a227, v201
v_accvgpr_write_b32 a240, v196
v_accvgpr_write_b32 a241, v197
v_accvgpr_write_b32 a242, v204
v_accvgpr_write_b32 a243, v205
s_setpc_b64 s[92:93]
L_t6:
v_mov_b32 v38, s44
v_mov_b32 v39, s44
v_accvgpr_read_b32 v192, a48
v_accvgpr_read_b32 v193, a49
v_accvgpr_read_b32 v194, a50
v_accvgpr_read_b32 v195, a51
v_accvgpr_read_b32 v196, a52
v_accvgpr_read_b32 v197, a53
v_accvgpr_read_b32 v198, a54
v_accvgpr_read_b32 v199, a55
v_accvgpr_read_b32 v200, a56
v_accvgpr_read_b32 v201, a57
v_accvgpr_read_b32 v202, a58
v_accvgpr_read_b32 v203, a59
v_accvgpr_read_b32 v204, a60
v_accvgpr_read_b32 v205, a61
v_accvgpr_read_b32 v206, a62
v_accvgpr_read_b32 v207, a63
v_pk_mul_f32 v[192:193], v[192:193], v[38:39]
v_pk_mul_f32 v[194:195], v[194:195], v[38:39]
v_pk_mul_f32 v[196:197], v[196:197], v[38:39]
v_pk_mul_f32 v[198:199], v[198:199], v[38:39]
v_pk_mul_f32 v[200:201], v[200:201], v[38:39]
v_pk_mul_f32 v[202:203], v[202:203], v[38:39]
v_pk_mul_f32 v[204:205], v[204:205], v[38:39]
v_pk_mul_f32 v[206:207], v[206:207], v[38:39]
v_cvt_pk_bf16_f32 v192, v192, v193
v_cvt_pk_bf16_f32 v193, v194, v195
v_cvt_pk_bf16_f32 v196, v196, v197
v_cvt_pk_bf16_f32 v197, v198, v199
v_cvt_pk_bf16_f32 v200, v200, v201
v_cvt_pk_bf16_f32 v201, v202, v203
v_cvt_pk_bf16_f32 v204, v204, v205
v_cvt_pk_bf16_f32 v205, v206, v207
s_nop 0
v_permlane32_swap_b32 v192, v200
v_permlane32_swap_b32 v193, v201
v_permlane32_swap_b32 v196, v204
v_permlane32_swap_b32 v197, v205
v_permlane16_swap_b32 v192, v200
v_permlane16_swap_b32 v193, v201
v_permlane16_swap_b32 v196, v204
v_permlane16_swap_b32 v197, v205
v_accvgpr_write_b32 a228, v192
v_accvgpr_write_b32 a229, v193
v_accvgpr_write_b32 a230, v200
v_accvgpr_write_b32 a231, v201
v_accvgpr_write_b32 a244, v196
v_accvgpr_write_b32 a245, v197
v_accvgpr_write_b32 a246, v204
v_accvgpr_write_b32 a247, v205
s_setpc_b64 s[92:93]
L_t8:
v_mov_b32 v38, s44
v_mov_b32 v39, s44
v_accvgpr_read_b32 v192, a64
v_accvgpr_read_b32 v193, a65
v_accvgpr_read_b32 v194, a66
v_accvgpr_read_b32 v195, a67
v_accvgpr_read_b32 v196, a68
v_accvgpr_read_b32 v197, a69
v_accvgpr_read_b32 v198, a70
v_accvgpr_read_b32 v199, a71
v_accvgpr_read_b32 v200, a72
v_accvgpr_read_b32 v201, a73
v_accvgpr_read_b32 v202, a74
v_accvgpr_read_b32 v203, a75
v_accvgpr_read_b32 v204, a76
v_accvgpr_read_b32 v205, a77
v_accvgpr_read_b32 v206, a78
v_accvgpr_read_b32 v207, a79
v_pk_mul_f32 v[192:193], v[192:193], v[38:39]
v_pk_mul_f32 v[194:195], v[194:195], v[38:39]
v_pk_mul_f32 v[196:197], v[196:197], v[38:39]
v_pk_mul_f32 v[198:199], v[198:199], v[38:39]
v_pk_mul_f32 v[200:201], v[200:201], v[38:39]
v_pk_mul_f32 v[202:203], v[202:203], v[38:39]
v_pk_mul_f32 v[204:205], v[204:205], v[38:39]
v_pk_mul_f32 v[206:207], v[206:207], v[38:39]
v_cvt_pk_bf16_f32 v192, v192, v193
v_cvt_pk_bf16_f32 v193, v194, v195
v_cvt_pk_bf16_f32 v196, v196, v197
v_cvt_pk_bf16_f32 v197, v198, v199
v_cvt_pk_bf16_f32 v200, v200, v201
v_cvt_pk_bf16_f32 v201, v202, v203
v_cvt_pk_bf16_f32 v204, v204, v205
v_cvt_pk_bf16_f32 v205, v206, v207
s_nop 0
v_permlane32_swap_b32 v192, v200
v_permlane32_swap_b32 v193, v201
v_permlane32_swap_b32 v196, v204
v_permlane32_swap_b32 v197, v205
v_permlane16_swap_b32 v192, v200
v_permlane16_swap_b32 v193, v201
v_permlane16_swap_b32 v196, v204
v_permlane16_swap_b32 v197, v205
v_accvgpr_write_b32 a232, v192
v_accvgpr_write_b32 a233, v193
v_accvgpr_write_b32 a234, v200
v_accvgpr_write_b32 a235, v201
v_accvgpr_write_b32 a248, v196
v_accvgpr_write_b32 a249, v197
v_accvgpr_write_b32 a250, v204
v_accvgpr_write_b32 a251, v205
s_setpc_b64 s[92:93]
L_t10:
v_mov_b32 v38, s44
v_mov_b32 v39, s44
v_accvgpr_read_b32 v192, a80
v_accvgpr_read_b32 v193, a81
v_accvgpr_read_b32 v194, a82
v_accvgpr_read_b32 v195, a83
v_accvgpr_read_b32 v196, a84
v_accvgpr_read_b32 v197, a85
v_accvgpr_read_b32 v198, a86
v_accvgpr_read_b32 v199, a87
v_accvgpr_read_b32 v200, a88
v_accvgpr_read_b32 v201, a89
v_accvgpr_read_b32 v202, a90
v_accvgpr_read_b32 v203, a91
v_accvgpr_read_b32 v204, a92
v_accvgpr_read_b32 v205, a93
v_accvgpr_read_b32 v206, a94
v_accvgpr_read_b32 v207, a95
v_pk_mul_f32 v[192:193], v[192:193], v[38:39]
v_pk_mul_f32 v[194:195], v[194:195], v[38:39]
v_pk_mul_f32 v[196:197], v[196:197], v[38:39]
v_pk_mul_f32 v[198:199], v[198:199], v[38:39]
v_pk_mul_f32 v[200:201], v[200:201], v[38:39]
v_pk_mul_f32 v[202:203], v[202:203], v[38:39]
v_pk_mul_f32 v[204:205], v[204:205], v[38:39]
v_pk_mul_f32 v[206:207], v[206:207], v[38:39]
v_cvt_pk_bf16_f32 v192, v192, v193
v_cvt_pk_bf16_f32 v193, v194, v195
v_cvt_pk_bf16_f32 v196, v196, v197
v_cvt_pk_bf16_f32 v197, v198, v199
v_cvt_pk_bf16_f32 v200, v200, v201
v_cvt_pk_bf16_f32 v201, v202, v203
v_cvt_pk_bf16_f32 v204, v204, v205
v_cvt_pk_bf16_f32 v205, v206, v207
s_nop 0
v_permlane32_swap_b32 v192, v200
v_permlane32_swap_b32 v193, v201
v_permlane32_swap_b32 v196, v204
v_permlane32_swap_b32 v197, v205
v_permlane16_swap_b32 v192, v200
v_permlane16_swap_b32 v193, v201
v_permlane16_swap_b32 v196, v204
v_permlane16_swap_b32 v197, v205
v_accvgpr_write_b32 a236, v192
v_accvgpr_write_b32 a237, v193
v_accvgpr_write_b32 a238, v200
v_accvgpr_write_b32 a239, v201
v_accvgpr_write_b32 a252, v196
v_accvgpr_write_b32 a253, v197
v_accvgpr_write_b32 a254, v204
v_accvgpr_write_b32 a255, v205
s_setpc_b64 s[92:93]
L_t14:
v_cmp_lt_f32 vcc, s42, v36
s_cbranch_vccz L_x14b
s_call_b64 s[94:95], L_rare
L_x14b:
v_accvgpr_mov_b32 a0, a224
v_accvgpr_mov_b32 a1, a225
v_accvgpr_mov_b32 a2, a226
v_accvgpr_mov_b32 a3, a227
v_accvgpr_mov_b32 a4, a228
v_accvgpr_mov_b32 a5, a229
v_accvgpr_mov_b32 a6, a230
v_accvgpr_mov_b32 a7, a231
v_accvgpr_mov_b32 a8, a232
v_accvgpr_mov_b32 a9, a233
v_accvgpr_mov_b32 a10, a234
v_accvgpr_mov_b32 a11, a235
v_accvgpr_mov_b32 a12, a236
v_accvgpr_mov_b32 a13, a237
v_accvgpr_mov_b32 a14, a238
v_accvgpr_mov_b32 a15, a239
v_accvgpr_mov_b32 a16, a240
v_accvgpr_mov_b32 a17, a241
v_accvgpr_mov_b32 a18, a242
v_accvgpr_mov_b32 a19, a243
v_accvgpr_mov_b32 a20, a244
v_accvgpr_mov_b32 a21, a245
v_accvgpr_mov_b32 a22, a246
v_accvgpr_mov_b32 a23, a247
v_accvgpr_mov_b32 a24, a248
v_accvgpr_mov_b32 a25, a249
v_accvgpr_mov_b32 a26, a250
v_accvgpr_mov_b32 a27, a251
v_accvgpr_mov_b32 a28, a252
v_accvgpr_mov_b32 a29, a253
v_accvgpr_mov_b32 a30, a254
v_accvgpr_mov_b32 a31, a255
v_mov_b32 v56, 0
v_mov_b32 v57, 0
v_mov_b32 v58, 0
v_mov_b32 v59, 0
v_mov_b32 v60, 0
v_mov_b32 v61, 0
v_mov_b32 v62, 0
v_mov_b32 v63, 0
v_mov_b32 v36, 0
s_setpc_b64 s[92:93]
L_t15:
s_nop 4
v_rcp_f32 v8, v48
v_rcp_f32 v9, v48
v_rcp_f32 v10, v52
v_rcp_f32_e64 v11, v52
s_nop 0
v_pk_mul_f32 v[64:65], v[64:65], v[8:9]
v_pk_mul_f32 v[66:67], v[66:67], v[8:9]
v_pk_mul_f32 v[72:73], v[72:73], v[8:9]
v_pk_mul_f32 v[74:75], v[74:75], v[8:9]
v_cvt_pk_bf16_f32 v208, v64, v65
v_cvt_pk_bf16_f32 v209, v66, v67
v_cvt_pk_bf16_f32 v210, v72, v73
v_cvt_pk_bf16_f32 v211, v74, v75
v_pk_mul_f32 v[68:69], v[68:69], v[10:11]
v_pk_mul_f32 v[70:71], v[70:71], v[10:11]
v_pk_mul_f32 v[76:77], v[76:77], v[10:11]
v_pk_mul_f32 v[78:79], v[78:79], v[10:11]
v_cvt_pk_bf16_f32 v212, v68, v69
v_cvt_pk_bf16_f32 v213, v70, v71
v_cvt_pk_bf16_f32 v214, v76, v77
v_cvt_pk_bf16_f32 v215, v78, v79
v_pk_mul_f32 v[80:81], v[80:81], v[8:9]
v_pk_mul_f32 v[82:83], v[82:83], v[8:9]
v_pk_mul_f32 v[88:89], v[88:89], v[8:9]
v_pk_mul_f32 v[90:91], v[90:91], v[8:9]
v_cvt_pk_bf16_f32 v216, v80, v81
v_cvt_pk_bf16_f32 v217, v82, v83
v_cvt_pk_bf16_f32 v218, v88, v89
v_cvt_pk_bf16_f32 v219, v90, v91
v_pk_mul_f32 v[84:85], v[84:85], v[10:11]
v_pk_mul_f32 v[86:87], v[86:87], v[10:11]
v_pk_mul_f32 v[92:93], v[92:93], v[10:11]
v_pk_mul_f32 v[94:95], v[94:95], v[10:11]
v_cvt_pk_bf16_f32 v220, v84, v85
v_cvt_pk_bf16_f32 v221, v86, v87
v_cvt_pk_bf16_f32 v222, v92, v93
v_cvt_pk_bf16_f32 v223, v94, v95
v_pk_mul_f32 v[96:97], v[96:97], v[8:9]
v_pk_mul_f32 v[98:99], v[98:99], v[8:9]
v_pk_mul_f32 v[104:105], v[104:105], v[8:9]
v_pk_mul_f32 v[106:107], v[106:107], v[8:9]
v_cvt_pk_bf16_f32 v224, v96, v97
v_cvt_pk_bf16_f32 v225, v98, v99
v_cvt_pk_bf16_f32 v226, v104, v105
v_cvt_pk_bf16_f32 v227, v106, v107
v_pk_mul_f32 v[100:101], v[100:101], v[10:11]
v_pk_mul_f32 v[102:103], v[102:103], v[10:11]
v_pk_mul_f32 v[108:109], v[108:109], v[10:11]
v_pk_mul_f32 v[110:111], v[110:111], v[10:11]
v_cvt_pk_bf16_f32 v228, v100, v101
v_cvt_pk_bf16_f32 v229, v102, v103
v_cvt_pk_bf16_f32 v230, v108, v109
v_cvt_pk_bf16_f32 v231, v110, v111
v_pk_mul_f32 v[112:113], v[112:113], v[8:9]
v_pk_mul_f32 v[114:115], v[114:115], v[8:9]
v_pk_mul_f32 v[120:121], v[120:121], v[8:9]
v_pk_mul_f32 v[122:123], v[122:123], v[8:9]
v_cvt_pk_bf16_f32 v232, v112, v113
v_cvt_pk_bf16_f32 v233, v114, v115
v_cvt_pk_bf16_f32 v234, v120, v121
v_cvt_pk_bf16_f32 v235, v122, v123
v_pk_mul_f32 v[116:117], v[116:117], v[10:11]
v_pk_mul_f32 v[118:119], v[118:119], v[10:11]
v_pk_mul_f32 v[124:125], v[124:125], v[10:11]
v_pk_mul_f32 v[126:127], v[126:127], v[10:11]
v_cvt_pk_bf16_f32 v236, v116, v117
v_cvt_pk_bf16_f32 v237, v118, v119
v_cvt_pk_bf16_f32 v238, v124, v125
v_cvt_pk_bf16_f32 v239, v126, v127
v_mov_b64 v[64:65], 0
v_mov_b64 v[66:67], 0
v_mov_b64 v[68:69], 0
v_mov_b64 v[70:71], 0
v_mov_b64 v[72:73], 0
v_mov_b64 v[74:75], 0
v_mov_b64 v[76:77], 0
v_mov_b64 v[78:79], 0
v_mov_b64 v[80:81], 0
v_mov_b64 v[82:83], 0
v_mov_b64 v[84:85], 0
v_mov_b64 v[86:87], 0
v_mov_b64 v[88:89], 0
v_mov_b64 v[90:91], 0
v_mov_b64 v[92:93], 0
v_mov_b64 v[94:95], 0
v_mov_b64 v[96:97], 0
v_mov_b64 v[98:99], 0
v_mov_b64 v[100:101], 0
v_mov_b64 v[102:103], 0
v_mov_b64 v[104:105], 0
v_mov_b64 v[106:107], 0
v_mov_b64 v[108:109], 0
v_mov_b64 v[110:111], 0
v_mov_b64 v[112:113], 0
v_mov_b64 v[114:115], 0
v_mov_b64 v[116:117], 0
v_mov_b64 v[118:119], 0
v_mov_b64 v[120:121], 0
v_mov_b64 v[122:123], 0
v_mov_b64 v[124:125], 0
v_mov_b64 v[126:127], 0
v_mov_b32 v48, 0
v_mov_b32_e64 v52, 0
s_branch L_init
L_t17:
s_add_u32 m0, s37, 131072
s_add_u32 s57, s64, 0
buffer_load_dwordx4 v3, s[20:23], s57 offen offset:0 lds
buffer_load_dwordx4 v4, s[20:23], s57 offen offset:1024 lds
buffer_load_dwordx4 v5, s[20:23], s57 offen offset:2048 lds
buffer_load_dwordx4 v6, s[20:23], s57 offen offset:3072 lds
s_setpc_b64 s[92:93]
L_t21:
s_add_u32 m0, s37, 147456
s_add_u32 s57, s64, 65536
buffer_load_dwordx4 v3, s[20:23], s57 offen offset:0 lds
buffer_load_dwordx4 v4, s[20:23], s57 offen offset:1024 lds
buffer_load_dwordx4 v5, s[20:23], s57 offen offset:2048 lds
buffer_load_dwordx4 v6, s[20:23], s57 offen offset:3072 lds
s_setpc_b64 s[92:93]
L_t26:
v_cmp_lt_f32 vcc, s42, v36
s_cbranch_vccz L_f26
s_call_b64 s[94:95], L_rare
L_f26:
s_add_u32 s43, s43, 1
s_waitcnt lgkmcnt(3)
v_mfma_f32_16x16x32_bf16 v[128:131], a[96:99], a[0:3], v[56:59]
ds_read_b128 a[124:127], v19 offset:4096
v_exp_f32_e64 v160, v160
v_mfma_f32_16x16x32_bf16 v[132:135], a[96:99], a[16:19], v[60:63]
v_exp_f32 v161, v161
v_exp_f32 v162, v162
v_mfma_f32_16x16x32_bf16 v[128:131], a[100:103], a[4:7], v[128:131]
ds_read_b128 a[96:99], v16 offset:8192
v_exp_f32_e64 v163, v163
v_mfma_f32_16x16x32_bf16 v[132:135], a[100:103], a[20:23], v[132:135]
v_cvt_pk_bf16_f32 v192, v160, v161
v_exp_f32_e64 v164, v164
v_mfma_f32_16x16x32_bf16 v[128:131], a[104:107], a[8:11], v[128:131]
ds_read_b128 a[100:103], v17 offset:8192
v_exp_f32_e64 v165, v165
v_mfma_f32_16x16x32_bf16 v[132:135], a[104:107], a[24:27], v[132:135]
v_cvt_pk_bf16_f32 v193, v162, v163
v_exp_f32_e64 v166, v166
v_mfma_f32_16x16x32_bf16 v[128:131], a[108:111], a[12:15], v[128:131]
ds_read_b128 a[104:107], v18 offset:8192
v_exp_f32_e64 v167, v167
v_mfma_f32_16x16x32_bf16 v[132:135], a[108:111], a[28:31], v[132:135]
v_cvt_pk_bf16_f32 v196, v164, v165
v_exp_f32 v168, v168
s_waitcnt lgkmcnt(3)
v_mfma_f32_16x16x32_bf16 v[136:139], a[112:115], a[0:3], v[56:59]
ds_read_b128 a[108:111], v19 offset:8192
v_exp_f32_e64 v169, v169
v_cvt_pk_bf16_f32 v197, v166, v167
v_mfma_f32_16x16x32_bf16 v[140:143], a[112:115], a[16:19], v[60:63]
v_exp_f32_e64 v170, v170
v_mfma_f32_16x16x32_bf16 v[136:139], a[116:119], a[4:7], v[136:139]
ds_read_b128 a[112:115], v16 offset:12288
v_exp_f32_e64 v171, v171
v_cvt_pk_bf16_f32 v194, v168, v169
v_mfma_f32_16x16x32_bf16 v[140:143], a[116:119], a[20:23], v[140:143]
v_exp_f32 v172, v172
v_exp_f32 v173, v173
v_mfma_f32_16x16x32_bf16 v[136:139], a[120:123], a[8:11], v[136:139]
ds_read_b128 a[116:119], v17 offset:12288
v_cvt_pk_bf16_f32 v195, v170, v171
v_mfma_f32_16x16x32_bf16 v[140:143], a[120:123], a[24:27], v[140:143]
v_exp_f32 v174, v174
v_exp_f32 v175, v175
v_mfma_f32_16x16x32_bf16 v[136:139], a[124:127], a[12:15], v[136:139]
ds_read_b128 a[120:123], v18 offset:12288
v_cvt_pk_bf16_f32 v198, v172, v173
v_mfma_f32_16x16x32_bf16 v[140:143], a[124:127], a[28:31], v[140:143]
v_exp_f32 v176, v176
v_exp_f32_e64 v177, v177
s_waitcnt lgkmcnt(3)
v_mfma_f32_16x16x32_bf16 v[144:147], a[96:99], a[0:3], v[56:59]
ds_read_b128 a[124:127], v19 offset:12288
v_cvt_pk_bf16_f32 v199, v174, v175
v_exp_f32_e64 v178, v178
v_mfma_f32_16x16x32_bf16 v[148:151], a[96:99], a[16:19], v[60:63]
v_exp_f32_e64 v179, v179
v_mfma_f32_16x16x32_bf16 v[144:147], a[100:103], a[4:7], v[144:147]
s_waitcnt vmcnt(4)
s_barrier
ds_read_b64_tr_b16 a[128:129], v20 offset:49152
s_add_u32 m0, s37, 98304
v_cvt_pk_bf16_f32 v200, v176, v177
v_mfma_f32_16x16x32_bf16 v[148:151], a[100:103], a[20:23], v[148:151]
ds_read_b64_tr_b16 a[130:131], v20 offset:53248
buffer_load_dwordx4 v32, s[8:11], s39 offen offset:0 nt lds
v_mfma_f32_16x16x32_bf16 v[144:147], a[104:107], a[8:11], v[144:147]
ds_read_b64_tr_b16 a[132:133], v21 offset:49152
v_mfma_f32_16x16x32_bf16 v[148:151], a[104:107], a[24:27], v[148:151]
ds_read_b64_tr_b16 a[134:135], v21 offset:53248
v_exp_f32 v180, v180
v_exp_f32 v181, v181
v_mfma_f32_16x16x32_bf16 v[144:147], a[108:111], a[12:15], v[144:147]
ds_read_b64_tr_b16 a[136:137], v22 offset:49152
v_cvt_pk_bf16_f32 v201, v178, v179
v_mfma_f32_16x16x32_bf16 v[148:151], a[108:111], a[28:31], v[148:151]
ds_read_b64_tr_b16 a[138:139], v22 offset:53248
buffer_load_dwordx4 v33, s[8:11], s39 offen offset:1024 nt lds
s_waitcnt lgkmcnt(6)
v_mfma_f32_16x16x32_bf16 v[152:155], a[112:115], a[0:3], v[56:59]
ds_read_b64_tr_b16 a[140:141], v23 offset:49152
v_mfma_f32_16x16x32_bf16 v[156:159], a[112:115], a[16:19], v[60:63]
ds_read_b64_tr_b16 a[142:143], v23 offset:53248
v_exp_f32 v182, v182
v_mfma_f32_16x16x32_bf16 v[152:155], a[116:119], a[4:7], v[152:155]
ds_read_b64_tr_b16 a[144:145], v24 offset:49152
v_exp_f32_e64 v183, v183
v_cvt_pk_bf16_f32 v204, v180, v181
v_mfma_f32_16x16x32_bf16 v[156:159], a[116:119], a[20:23], v[156:159]
ds_read_b64_tr_b16 a[146:147], v24 offset:53248
buffer_load_dwordx4 v32, s[8:11], s39 offen offset:2048 nt lds
v_mfma_f32_16x16x32_bf16 v[152:155], a[120:123], a[8:11], v[152:155]
ds_read_b64_tr_b16 a[148:149], v25 offset:49152
v_mfma_f32_16x16x32_bf16 v[156:159], a[120:123], a[24:27], v[156:159]
ds_read_b64_tr_b16 a[150:151], v25 offset:53248
s_nop 0
v_cvt_pk_bf16_f32 v205, v182, v183
v_mfma_f32_16x16x32_bf16 v[152:155], a[124:127], a[12:15], v[152:155]
ds_read_b64_tr_b16 a[152:153], v26 offset:49152
v_mfma_f32_16x16x32_bf16 v[156:159], a[124:127], a[28:31], v[156:159]
ds_read_b64_tr_b16 a[154:155], v26 offset:53248
buffer_load_dwordx4 v33, s[8:11], s39 offen offset:3072 nt lds
s_add_u32 s39, s39, 16384
s_waitcnt lgkmcnt(6)
v_mfma_f32_16x16x32_bf16 v[64:67], a[128:131], v[192:195], v[64:67]
ds_read_b64_tr_b16 a[156:157], v27 offset:49152
v_exp_f32_e64 v184, v184
v_mfma_f32_16x16x32_bf16 v[68:71], a[128:131], v[196:199], v[68:71]
ds_read_b64_tr_b16 a[158:159], v27 offset:53248
v_exp_f32_e64 v185, v185
v_mfma_f32_16x16x32_bf16 v[72:75], a[132:135], v[192:195], v[72:75]
ds_read_b64_tr_b16 a[128:129], v20 offset:57344
v_exp_f32_e64 v186, v186
v_mfma_f32_16x16x32_bf16 v[76:79], a[132:135], v[196:199], v[76:79]
ds_read_b64_tr_b16 a[130:131], v20 offset:61440
v_exp_f32_e64 v187, v187
v_mfma_f32_16x16x32_bf16 v[80:83], a[136:139], v[192:195], v[80:83]
ds_read_b64_tr_b16 a[132:133], v21 offset:57344
v_cvt_pk_bf16_f32 v202, v184, v185
v_mfma_f32_16x16x32_bf16 v[84:87], a[136:139], v[196:199], v[84:87]
ds_read_b64_tr_b16 a[134:135], v21 offset:61440
v_exp_f32_e64 v188, v188
v_mfma_f32_16x16x32_bf16 v[88:91], a[140:143], v[192:195], v[88:91]
ds_read_b64_tr_b16 a[136:137], v22 offset:57344
v_exp_f32_e64 v189, v189
v_mfma_f32_16x16x32_bf16 v[92:95], a[140:143], v[196:199], v[92:95]
ds_read_b64_tr_b16 a[138:139], v22 offset:61440
v_cvt_pk_bf16_f32 v203, v186, v187
v_mfma_f32_16x16x32_bf16 v[48:51], v[44:47], v[192:195], v[48:51]
s_waitcnt lgkmcnt(6)
v_mfma_f32_16x16x32_bf16 v[96:99], a[144:147], v[192:195], v[96:99]
ds_read_b64_tr_b16 a[140:141], v23 offset:57344
v_exp_f32 v190, v190
v_mfma_f32_16x16x32_bf16 v[100:103], a[144:147], v[196:199], v[100:103]
ds_read_b64_tr_b16 a[142:143], v23 offset:61440
v_exp_f32_e64 v191, v191
v_mfma_f32_16x16x32_bf16 v[104:107], a[148:151], v[192:195], v[104:107]
ds_read_b64_tr_b16 a[144:145], v24 offset:57344
v_cvt_pk_bf16_f32 v206, v188, v189
v_mfma_f32_16x16x32_bf16 v[108:111], a[148:151], v[196:199], v[108:111]
ds_read_b64_tr_b16 a[146:147], v24 offset:61440
s_nop 0
v_cvt_pk_bf16_f32 v207, v190, v191
v_mfma_f32_16x16x32_bf16 v[112:115], a[152:155], v[192:195], v[112:115]
ds_read_b64_tr_b16 a[148:149], v25 offset:57344
v_max3_f32 v34, v128, v129, v130
v_mfma_f32_16x16x32_bf16 v[116:119], a[152:155], v[196:199], v[116:119]
ds_read_b64_tr_b16 a[150:151], v25 offset:61440
v_max3_f32 v35, v132, v133, v134
v_max3_f32 v34, v34, v131, v136
v_mfma_f32_16x16x32_bf16 v[120:123], a[156:159], v[192:195], v[120:123]
ds_read_b64_tr_b16 a[152:153], v26 offset:57344
v_max3_f32 v35, v35, v135, v140
v_mfma_f32_16x16x32_bf16 v[124:127], a[156:159], v[196:199], v[124:127]
ds_read_b64_tr_b16 a[154:155], v26 offset:61440
v_max3_f32 v34, v34, v137, v138
v_max3_f32 v35, v35, v141, v142
v_mfma_f32_16x16x32_bf16 v[52:55], v[44:47], v[196:199], v[52:55]
s_waitcnt lgkmcnt(6)
v_mfma_f32_16x16x32_bf16 v[64:67], a[128:131], v[200:203], v[64:67]
ds_read_b64_tr_b16 a[156:157], v27 offset:57344
v_max3_f32 v34, v34, v139, v144
v_mfma_f32_16x16x32_bf16 v[68:71], a[128:131], v[204:207], v[68:71]
ds_read_b64_tr_b16 a[158:159], v27 offset:61440
v_max3_f32 v35, v35, v143, v148
v_mfma_f32_16x16x32_bf16 v[72:75], a[132:135], v[200:203], v[72:75]
s_waitcnt vmcnt(4)
s_barrier
ds_read_b128 a[96:99], v16 offset:16384
v_max3_f32 v34, v34, v145, v146
v_max3_f32 v35, v35, v149, v150
v_mfma_f32_16x16x32_bf16 v[76:79], a[132:135], v[204:207], v[76:79]
s_add_u32 m0, s37, 0
s_add_u32 s57, s64, 131072
buffer_load_dwordx4 v3, s[20:23], s57 offen offset:0 lds
v_mfma_f32_16x16x32_bf16 v[80:83], a[136:139], v[200:203], v[80:83]
ds_read_b128 a[100:103], v17 offset:16384
v_mfma_f32_16x16x32_bf16 v[84:87], a[136:139], v[204:207], v[84:87]
buffer_load_dwordx4 v4, s[20:23], s57 offen offset:1024 lds
v_mfma_f32_16x16x32_bf16 v[88:91], a[140:143], v[200:203], v[88:91]
ds_read_b128 a[104:107], v18 offset:16384
v_mfma_f32_16x16x32_bf16 v[92:95], a[140:143], v[204:207], v[92:95]
buffer_load_dwordx4 v5, s[20:23], s57 offen offset:2048 lds
v_mfma_f32_16x16x32_bf16 v[48:51], v[44:47], v[200:203], v[48:51]
s_waitcnt lgkmcnt(3)
v_mfma_f32_16x16x32_bf16 v[96:99], a[144:147], v[200:203], v[96:99]
ds_read_b128 a[108:111], v19 offset:16384
v_mfma_f32_16x16x32_bf16 v[100:103], a[144:147], v[204:207], v[100:103]
buffer_load_dwordx4 v6, s[20:23], s57 offen offset:3072 lds
v_mfma_f32_16x16x32_bf16 v[104:107], a[148:151], v[200:203], v[104:107]
ds_read_b128 a[112:115], v16 offset:20480
v_mfma_f32_16x16x32_bf16 v[108:111], a[148:151], v[204:207], v[108:111]
v_mfma_f32_16x16x32_bf16 v[112:115], a[152:155], v[200:203], v[112:115]
ds_read_b128 a[116:119], v17 offset:20480
v_max3_f32 v34, v34, v147, v152
v_mfma_f32_16x16x32_bf16 v[116:119], a[152:155], v[204:207], v[116:119]
v_max3_f32 v35, v35, v151, v156
v_max3_f32 v34, v34, v153, v154
v_mfma_f32_16x16x32_bf16 v[120:123], a[156:159], v[200:203], v[120:123]
ds_read_b128 a[120:123], v18 offset:20480
v_max3_f32 v35, v35, v157, v158
v_max_f32_e64 v34, v34, v155
v_mfma_f32_16x16x32_bf16 v[124:127], a[156:159], v[204:207], v[124:127]
v_max_f32 v35, v35, v159
v_max_f32 v36, v34, v35
v_mfma_f32_16x16x32_bf16 v[52:55], v[44:47], v[204:207], v[52:55]
v_cmp_lt_f32 vcc, s42, v36
s_cbranch_vccz L_f27
s_call_b64 s[94:95], L_rare
L_f27:
s_add_u32 s43, s43, 1
s_waitcnt lgkmcnt(3)
v_mfma_f32_16x16x32_bf16 v[160:163], a[96:99], a[0:3], v[56:59]
ds_read_b128 a[124:127], v19 offset:20480
v_exp_f32 v128, v128
v_mfma_f32_16x16x32_bf16 v[164:167], a[96:99], a[16:19], v[60:63]
v_exp_f32 v129, v129
v_exp_f32 v130, v130
v_mfma_f32_16x16x32_bf16 v[160:163], a[100:103], a[4:7], v[160:163]
ds_read_b128 a[96:99], v16 offset:24576
v_exp_f32_e64 v131, v131
v_mfma_f32_16x16x32_bf16 v[164:167], a[100:103], a[20:23], v[164:167]
v_cvt_pk_bf16_f32 v192, v128, v129
v_exp_f32_e64 v132, v132
v_mfma_f32_16x16x32_bf16 v[160:163], a[104:107], a[8:11], v[160:163]
ds_read_b128 a[100:103], v17 offset:24576
v_exp_f32_e64 v133, v133
v_mfma_f32_16x16x32_bf16 v[164:167], a[104:107], a[24:27], v[164:167]
v_cvt_pk_bf16_f32 v193, v130, v131
v_exp_f32_e64 v134, v134
v_mfma_f32_16x16x32_bf16 v[160:163], a[108:111], a[12:15], v[160:163]
ds_read_b128 a[104:107], v18 offset:24576
v_exp_f32_e64 v135, v135
v_mfma_f32_16x16x32_bf16 v[164:167], a[108:111], a[28:31], v[164:167]
v_cvt_pk_bf16_f32 v196, v132, v133
v_exp_f32 v136, v136
s_waitcnt lgkmcnt(3)
v_mfma_f32_16x16x32_bf16 v[168:171], a[112:115], a[0:3], v[56:59]
ds_read_b128 a[108:111], v19 offset:24576
v_exp_f32_e64 v137, v137
v_cvt_pk_bf16_f32 v197, v134, v135
v_mfma_f32_16x16x32_bf16 v[172:175], a[112:115], a[16:19], v[60:63]
v_exp_f32_e64 v138, v138
v_mfma_f32_16x16x32_bf16 v[168:171], a[116:119], a[4:7], v[168:171]
ds_read_b128 a[112:115], v16 offset:28672
v_exp_f32_e64 v139, v139
v_cvt_pk_bf16_f32 v194, v136, v137
v_mfma_f32_16x16x32_bf16 v[172:175], a[116:119], a[20:23], v[172:175]
v_exp_f32 v140, v140
v_exp_f32 v141, v141
v_mfma_f32_16x16x32_bf16 v[168:171], a[120:123], a[8:11], v[168:171]
ds_read_b128 a[116:119], v17 offset:28672
v_cvt_pk_bf16_f32 v195, v138, v139
v_mfma_f32_16x16x32_bf16 v[172:175], a[120:123], a[24:27], v[172:175]
v_exp_f32 v142, v142
v_exp_f32 v143, v143
v_mfma_f32_16x16x32_bf16 v[168:171], a[124:127], a[12:15], v[168:171]
ds_read_b128 a[120:123], v18 offset:28672
v_cvt_pk_bf16_f32 v198, v140, v141
v_mfma_f32_16x16x32_bf16 v[172:175], a[124:127], a[28:31], v[172:175]
v_exp_f32 v144, v144
v_exp_f32_e64 v145, v145
s_waitcnt lgkmcnt(3)
v_mfma_f32_16x16x32_bf16 v[176:179], a[96:99], a[0:3], v[56:59]
ds_read_b128 a[124:127], v19 offset:28672
v_cvt_pk_bf16_f32 v199, v142, v143
v_exp_f32_e64 v146, v146
v_mfma_f32_16x16x32_bf16 v[180:183], a[96:99], a[16:19], v[60:63]
v_exp_f32_e64 v147, v147
v_mfma_f32_16x16x32_bf16 v[176:179], a[100:103], a[4:7], v[176:179]
s_waitcnt vmcnt(4)
s_barrier
ds_read_b64_tr_b16 a[128:129], v20 offset:0
s_add_u32 m0, s37, 114688
v_cvt_pk_bf16_f32 v200, v144, v145
v_mfma_f32_16x16x32_bf16 v[180:183], a[100:103], a[20:23], v[180:183]
ds_read_b64_tr_b16 a[130:131], v20 offset:4096
buffer_load_dwordx4 v32, s[8:11], s39 offen offset:0 nt lds
v_mfma_f32_16x16x32_bf16 v[176:179], a[104:107], a[8:11], v[176:179]
ds_read_b64_tr_b16 a[132:133], v21 offset:0
v_mfma_f32_16x16x32_bf16 v[180:183], a[104:107], a[24:27], v[180:183]
ds_read_b64_tr_b16 a[134:135], v21 offset:4096
v_exp_f32 v148, v148
v_exp_f32 v149, v149
v_mfma_f32_16x16x32_bf16 v[176:179], a[108:111], a[12:15], v[176:179]
ds_read_b64_tr_b16 a[136:137], v22 offset:0
v_cvt_pk_bf16_f32 v201, v146, v147
v_mfma_f32_16x16x32_bf16 v[180:183], a[108:111], a[28:31], v[180:183]
ds_read_b64_tr_b16 a[138:139], v22 offset:4096
buffer_load_dwordx4 v33, s[8:11], s39 offen offset:1024 nt lds
s_waitcnt lgkmcnt(6)
v_mfma_f32_16x16x32_bf16 v[184:187], a[112:115], a[0:3], v[56:59]
ds_read_b64_tr_b16 a[140:141], v23 offset:0
v_mfma_f32_16x16x32_bf16 v[188:191], a[112:115], a[16:19], v[60:63]
ds_read_b64_tr_b16 a[142:143], v23 offset:4096
v_exp_f32 v150, v150
v_mfma_f32_16x16x32_bf16 v[184:187], a[116:119], a[4:7], v[184:187]
ds_read_b64_tr_b16 a[144:145], v24 offset:0
v_exp_f32_e64 v151, v151
v_cvt_pk_bf16_f32 v204, v148, v149
v_mfma_f32_16x16x32_bf16 v[188:191], a[116:119], a[20:23], v[188:191]
ds_read_b64_tr_b16 a[146:147], v24 offset:4096
buffer_load_dwordx4 v32, s[8:11], s39 offen offset:2048 nt lds
v_mfma_f32_16x16x32_bf16 v[184:187], a[120:123], a[8:11], v[184:187]
ds_read_b64_tr_b16 a[148:149], v25 offset:0
v_mfma_f32_16x16x32_bf16 v[188:191], a[120:123], a[24:27], v[188:191]
ds_read_b64_tr_b16 a[150:151], v25 offset:4096
s_nop 0
v_cvt_pk_bf16_f32 v205, v150, v151
v_mfma_f32_16x16x32_bf16 v[184:187], a[124:127], a[12:15], v[184:187]
ds_read_b64_tr_b16 a[152:153], v26 offset:0
v_mfma_f32_16x16x32_bf16 v[188:191], a[124:127], a[28:31], v[188:191]
ds_read_b64_tr_b16 a[154:155], v26 offset:4096
buffer_load_dwordx4 v33, s[8:11], s39 offen offset:3072 nt lds
s_add_u32 s39, s39, 16384
s_waitcnt lgkmcnt(6)
v_mfma_f32_16x16x32_bf16 v[64:67], a[128:131], v[192:195], v[64:67]
ds_read_b64_tr_b16 a[156:157], v27 offset:0
v_exp_f32 v152, v152
v_exp_f32 v153, v153
v_mfma_f32_16x16x32_bf16 v[68:71], a[128:131], v[196:199], v[68:71]
ds_read_b64_tr_b16 a[158:159], v27 offset:4096
buffer_store_dwordx4 v[208:211], v40, s[24:27], s50 offen offset:0 sc1
v_mfma_f32_16x16x32_bf16 v[72:75], a[132:135], v[192:195], v[72:75]
ds_read_b64_tr_b16 a[128:129], v20 offset:8192
v_exp_f32 v154, v154
v_exp_f32 v155, v155
v_mfma_f32_16x16x32_bf16 v[76:79], a[132:135], v[196:199], v[76:79]
ds_read_b64_tr_b16 a[130:131], v20 offset:12288
buffer_store_dwordx4 v[212:215], v40, s[24:27], s50 offen offset:1024 sc1
s_add_u32 s50, s50, 8192
v_mfma_f32_16x16x32_bf16 v[80:83], a[136:139], v[192:195], v[80:83]
ds_read_b64_tr_b16 a[132:133], v21 offset:8192
v_cvt_pk_bf16_f32 v202, v152, v153
v_exp_f32_e64 v156, v156
v_mfma_f32_16x16x32_bf16 v[84:87], a[136:139], v[196:199], v[84:87]
ds_read_b64_tr_b16 a[134:135], v21 offset:12288
buffer_store_dwordx4 v[216:219], v40, s[24:27], s50 offen offset:0 sc1
v_mfma_f32_16x16x32_bf16 v[88:91], a[140:143], v[192:195], v[88:91]
ds_read_b64_tr_b16 a[136:137], v22 offset:8192
v_exp_f32_e64 v157, v157
v_cvt_pk_bf16_f32 v203, v154, v155
v_exp_f32_e64 v158, v158
v_mfma_f32_16x16x32_bf16 v[92:95], a[140:143], v[196:199], v[92:95]
ds_read_b64_tr_b16 a[138:139], v22 offset:12288
buffer_store_dwordx4 v[220:223], v40, s[24:27], s50 offen offset:1024 sc1
s_add_u32 s50, s50, 8192
v_mfma_f32_16x16x32_bf16 v[48:51], v[44:47], v[192:195], v[48:51]
s_waitcnt lgkmcnt(6)
v_mfma_f32_16x16x32_bf16 v[96:99], a[144:147], v[192:195], v[96:99]
ds_read_b64_tr_b16 a[140:141], v23 offset:8192
v_exp_f32 v159, v159
v_mfma_f32_16x16x32_bf16 v[100:103], a[144:147], v[196:199], v[100:103]
ds_read_b64_tr_b16 a[142:143], v23 offset:12288
buffer_store_dwordx4 v[224:227], v40, s[24:27], s50 offen offset:0 sc1
v_mfma_f32_16x16x32_bf16 v[104:107], a[148:151], v[192:195], v[104:107]
ds_read_b64_tr_b16 a[144:145], v24 offset:8192
v_cvt_pk_bf16_f32 v206, v156, v157
s_nop 0
v_cvt_pk_bf16_f32 v207, v158, v159
v_mfma_f32_16x16x32_bf16 v[108:111], a[148:151], v[196:199], v[108:111]
ds_read_b64_tr_b16 a[146:147], v24 offset:12288
buffer_store_dwordx4 v[228:231], v40, s[24:27], s50 offen offset:1024 sc1
s_add_u32 s50, s50, 8192
v_mfma_f32_16x16x32_bf16 v[112:115], a[152:155], v[192:195], v[112:115]
ds_read_b64_tr_b16 a[148:149], v25 offset:8192
v_max3_f32 v34, v160, v161, v162
v_max3_f32 v35, v164, v165, v166
v_mfma_f32_16x16x32_bf16 v[116:119], a[152:155], v[196:199], v[116:119]
ds_read_b64_tr_b16 a[150:151], v25 offset:12288
buffer_store_dwordx4 v[232:235], v40, s[24:27], s50 offen offset:0 sc1
v_mfma_f32_16x16x32_bf16 v[120:123], a[156:159], v[192:195], v[120:123]
ds_read_b64_tr_b16 a[152:153], v26 offset:8192
v_mfma_f32_16x16x32_bf16 v[124:127], a[156:159], v[196:199], v[124:127]
ds_read_b64_tr_b16 a[154:155], v26 offset:12288
buffer_store_dwordx4 v[236:239], v40, s[24:27], s50 offen offset:1024 sc1
s_add_u32 s50, s50, 8192
v_mfma_f32_16x16x32_bf16 v[52:55], v[44:47], v[196:199], v[52:55]
s_waitcnt lgkmcnt(6)
v_mfma_f32_16x16x32_bf16 v[64:67], a[128:131], v[200:203], v[64:67]
ds_read_b64_tr_b16 a[156:157], v27 offset:8192
v_mfma_f32_16x16x32_bf16 v[68:71], a[128:131], v[204:207], v[68:71]
ds_read_b64_tr_b16 a[158:159], v27 offset:12288
v_mfma_f32_16x16x32_bf16 v[72:75], a[132:135], v[200:203], v[72:75]
s_waitcnt vmcnt(28)
s_barrier
ds_read_b128 a[96:99], v16 offset:32768
v_max3_f32 v34, v34, v163, v168
v_max3_f32 v35, v35, v167, v172
v_mfma_f32_16x16x32_bf16 v[76:79], a[132:135], v[204:207], v[76:79]
s_add_u32 m0, s37, 16384
s_add_u32 s57, s64, 196608
buffer_load_dwordx4 v3, s[20:23], s57 offen offset:0 lds
v_mfma_f32_16x16x32_bf16 v[80:83], a[136:139], v[200:203], v[80:83]
ds_read_b128 a[100:103], v17 offset:32768
v_mfma_f32_16x16x32_bf16 v[84:87], a[136:139], v[204:207], v[84:87]
buffer_load_dwordx4 v4, s[20:23], s57 offen offset:1024 lds
v_mfma_f32_16x16x32_bf16 v[88:91], a[140:143], v[200:203], v[88:91]
ds_read_b128 a[104:107], v18 offset:32768
v_mfma_f32_16x16x32_bf16 v[92:95], a[140:143], v[204:207], v[92:95]
buffer_load_dwordx4 v5, s[20:23], s57 offen offset:2048 lds
v_mfma_f32_16x16x32_bf16 v[48:51], v[44:47], v[200:203], v[48:51]
s_waitcnt lgkmcnt(3)
v_mfma_f32_16x16x32_bf16 v[96:99], a[144:147], v[200:203], v[96:99]
ds_read_b128 a[108:111], v19 offset:32768
v_mfma_f32_16x16x32_bf16 v[100:103], a[144:147], v[204:207], v[100:103]
buffer_load_dwordx4 v6, s[20:23], s57 offen offset:3072 lds
v_mfma_f32_16x16x32_bf16 v[104:107], a[148:151], v[200:203], v[104:107]
ds_read_b128 a[112:115], v16 offset:36864
v_max3_f32 v34, v34, v169, v170
v_mfma_f32_16x16x32_bf16 v[108:111], a[148:151], v[204:207], v[108:111]
v_max3_f32 v35, v35, v173, v174
v_max3_f32 v34, v34, v171, v176
v_max3_f32 v35, v35, v175, v180
v_mfma_f32_16x16x32_bf16 v[112:115], a[152:155], v[200:203], v[112:115]
ds_read_b128 a[116:119], v17 offset:36864
v_max3_f32 v34, v34, v177, v178
v_mfma_f32_16x16x32_bf16 v[116:119], a[152:155], v[204:207], v[116:119]
v_max3_f32 v35, v35, v181, v182
v_max3_f32 v34, v34, v179, v184
v_max3_f32 v35, v35, v183, v188
v_mfma_f32_16x16x32_bf16 v[120:123], a[156:159], v[200:203], v[120:123]
ds_read_b128 a[120:123], v18 offset:36864
v_max3_f32 v34, v34, v185, v186
v_max3_f32 v35, v35, v189, v190
v_mfma_f32_16x16x32_bf16 v[124:127], a[156:159], v[204:207], v[124:127]
v_max_f32 v34, v34, v187
v_max_f32 v35, v35, v191
v_max_f32 v36, v34, v35
v_mfma_f32_16x16x32_bf16 v[52:55], v[44:47], v[204:207], v[52:55]
v_cmp_lt_f32 vcc, s42, v36
s_cbranch_vccz L_f28
s_call_b64 s[94:95], L_rare
L_f28:
s_add_u32 s43, s43, 1
s_waitcnt lgkmcnt(3)
v_mfma_f32_16x16x32_bf16 v[128:131], a[96:99], a[0:3], v[56:59]
ds_read_b128 a[124:127], v19 offset:36864
v_exp_f32 v160, v160
v_mfma_f32_16x16x32_bf16 v[132:135], a[96:99], a[16:19], v[60:63]
v_exp_f32 v161, v161
v_exp_f32 v162, v162
v_mfma_f32_16x16x32_bf16 v[128:131], a[100:103], a[4:7], v[128:131]
ds_read_b128 a[96:99], v16 offset:40960
v_exp_f32_e64 v163, v163
v_mfma_f32_16x16x32_bf16 v[132:135], a[100:103], a[20:23], v[132:135]
v_cvt_pk_bf16_f32 v192, v160, v161
v_exp_f32_e64 v164, v164
v_mfma_f32_16x16x32_bf16 v[128:131], a[104:107], a[8:11], v[128:131]
ds_read_b128 a[100:103], v17 offset:40960
v_exp_f32_e64 v165, v165
v_mfma_f32_16x16x32_bf16 v[132:135], a[104:107], a[24:27], v[132:135]
v_cvt_pk_bf16_f32 v193, v162, v163
v_exp_f32_e64 v166, v166
v_mfma_f32_16x16x32_bf16 v[128:131], a[108:111], a[12:15], v[128:131]
ds_read_b128 a[104:107], v18 offset:40960
v_exp_f32_e64 v167, v167
v_mfma_f32_16x16x32_bf16 v[132:135], a[108:111], a[28:31], v[132:135]
v_cvt_pk_bf16_f32 v196, v164, v165
v_exp_f32 v168, v168
s_waitcnt lgkmcnt(3)
v_mfma_f32_16x16x32_bf16 v[136:139], a[112:115], a[0:3], v[56:59]
ds_read_b128 a[108:111], v19 offset:40960
v_exp_f32_e64 v169, v169
v_cvt_pk_bf16_f32 v197, v166, v167
v_mfma_f32_16x16x32_bf16 v[140:143], a[112:115], a[16:19], v[60:63]
v_exp_f32_e64 v170, v170
v_mfma_f32_16x16x32_bf16 v[136:139], a[116:119], a[4:7], v[136:139]
ds_read_b128 a[112:115], v16 offset:45056
v_exp_f32_e64 v171, v171
v_cvt_pk_bf16_f32 v194, v168, v169
v_mfma_f32_16x16x32_bf16 v[140:143], a[116:119], a[20:23], v[140:143]
v_exp_f32 v172, v172
v_exp_f32 v173, v173
v_mfma_f32_16x16x32_bf16 v[136:139], a[120:123], a[8:11], v[136:139]
ds_read_b128 a[116:119], v17 offset:45056
v_cvt_pk_bf16_f32 v195, v170, v171
v_mfma_f32_16x16x32_bf16 v[140:143], a[120:123], a[24:27], v[140:143]
v_exp_f32 v174, v174
v_exp_f32 v175, v175
v_mfma_f32_16x16x32_bf16 v[136:139], a[124:127], a[12:15], v[136:139]
ds_read_b128 a[120:123], v18 offset:45056
v_cvt_pk_bf16_f32 v198, v172, v173
v_mfma_f32_16x16x32_bf16 v[140:143], a[124:127], a[28:31], v[140:143]
v_exp_f32 v176, v176
v_exp_f32_e64 v177, v177
s_waitcnt lgkmcnt(3)
v_mfma_f32_16x16x32_bf16 v[144:147], a[96:99], a[0:3], v[56:59]
ds_read_b128 a[124:127], v19 offset:45056
v_cvt_pk_bf16_f32 v199, v174, v175
v_exp_f32_e64 v178, v178
v_mfma_f32_16x16x32_bf16 v[148:151], a[96:99], a[16:19], v[60:63]
v_exp_f32_e64 v179, v179
v_mfma_f32_16x16x32_bf16 v[144:147], a[100:103], a[4:7], v[144:147]
s_waitcnt vmcnt(28)
s_barrier
ds_read_b64_tr_b16 a[128:129], v20 offset:16384
v_cvt_pk_bf16_f32 v200, v176, v177
v_exp_f32_e64 v180, v180
v_mfma_f32_16x16x32_bf16 v[148:151], a[100:103], a[20:23], v[148:151]
ds_read_b64_tr_b16 a[130:131], v20 offset:20480
s_add_u32 m0, s37, 65536
s_add_u32 s57, s65, 0
buffer_load_dwordx4 v3, s[20:23], s57 offen offset:0 lds
v_mfma_f32_16x16x32_bf16 v[144:147], a[104:107], a[8:11], v[144:147]
ds_read_b64_tr_b16 a[132:133], v21 offset:16384
v_mfma_f32_16x16x32_bf16 v[148:151], a[104:107], a[24:27], v[148:151]
ds_read_b64_tr_b16 a[134:135], v21 offset:20480
buffer_load_dwordx4 v4, s[20:23], s57 offen offset:1024 lds
v_mfma_f32_16x16x32_bf16 v[144:147], a[108:111], a[12:15], v[144:147]
ds_read_b64_tr_b16 a[136:137], v22 offset:16384
v_mfma_f32_16x16x32_bf16 v[148:151], a[108:111], a[28:31], v[148:151]
ds_read_b64_tr_b16 a[138:139], v22 offset:20480
buffer_load_dwordx4 v5, s[20:23], s57 offen offset:2048 lds
s_waitcnt lgkmcnt(6)
v_mfma_f32_16x16x32_bf16 v[152:155], a[112:115], a[0:3], v[56:59]
ds_read_b64_tr_b16 a[140:141], v23 offset:16384
v_mfma_f32_16x16x32_bf16 v[156:159], a[112:115], a[16:19], v[60:63]
ds_read_b64_tr_b16 a[142:143], v23 offset:20480
buffer_load_dwordx4 v6, s[20:23], s57 offen offset:3072 lds
v_mfma_f32_16x16x32_bf16 v[152:155], a[116:119], a[4:7], v[152:155]
ds_read_b64_tr_b16 a[144:145], v24 offset:16384
v_mfma_f32_16x16x32_bf16 v[156:159], a[116:119], a[20:23], v[156:159]
ds_read_b64_tr_b16 a[146:147], v24 offset:20480
v_exp_f32_e64 v181, v181
v_mfma_f32_16x16x32_bf16 v[152:155], a[120:123], a[8:11], v[152:155]
ds_read_b64_tr_b16 a[148:149], v25 offset:16384
v_cvt_pk_bf16_f32 v201, v178, v179
v_mfma_f32_16x16x32_bf16 v[156:159], a[120:123], a[24:27], v[156:159]
ds_read_b64_tr_b16 a[150:151], v25 offset:20480
v_exp_f32_e64 v182, v182
v_mfma_f32_16x16x32_bf16 v[152:155], a[124:127], a[12:15], v[152:155]
ds_read_b64_tr_b16 a[152:153], v26 offset:16384
v_exp_f32_e64 v183, v183
v_cvt_pk_bf16_f32 v204, v180, v181
v_mfma_f32_16x16x32_bf16 v[156:159], a[124:127], a[28:31], v[156:159]
ds_read_b64_tr_b16 a[154:155], v26 offset:20480
s_nop 0
v_cvt_pk_bf16_f32 v205, v182, v183
s_waitcnt lgkmcnt(6)
v_mfma_f32_16x16x32_bf16 v[64:67], a[128:131], v[192:195], v[64:67]
ds_read_b64_tr_b16 a[156:157], v27 offset:16384
v_exp_f32_e64 v184, v184
v_mfma_f32_16x16x32_bf16 v[68:71], a[128:131], v[196:199], v[68:71]
ds_read_b64_tr_b16 a[158:159], v27 offset:20480
v_exp_f32_e64 v185, v185
v_mfma_f32_16x16x32_bf16 v[72:75], a[132:135], v[192:195], v[72:75]
ds_read_b64_tr_b16 a[128:129], v20 offset:24576
v_exp_f32_e64 v186, v186
v_mfma_f32_16x16x32_bf16 v[76:79], a[132:135], v[196:199], v[76:79]
ds_read_b64_tr_b16 a[130:131], v20 offset:28672
v_exp_f32_e64 v187, v187
v_mfma_f32_16x16x32_bf16 v[80:83], a[136:139], v[192:195], v[80:83]
ds_read_b64_tr_b16 a[132:133], v21 offset:24576
v_cvt_pk_bf16_f32 v202, v184, v185
v_mfma_f32_16x16x32_bf16 v[84:87], a[136:139], v[196:199], v[84:87]
ds_read_b64_tr_b16 a[134:135], v21 offset:28672
v_exp_f32_e64 v188, v188
v_mfma_f32_16x16x32_bf16 v[88:91], a[140:143], v[192:195], v[88:91]
ds_read_b64_tr_b16 a[136:137], v22 offset:24576
v_exp_f32_e64 v189, v189
v_mfma_f32_16x16x32_bf16 v[92:95], a[140:143], v[196:199], v[92:95]
ds_read_b64_tr_b16 a[138:139], v22 offset:28672
v_cvt_pk_bf16_f32 v203, v186, v187
v_mfma_f32_16x16x32_bf16 v[48:51], v[44:47], v[192:195], v[48:51]
s_waitcnt lgkmcnt(6)
v_mfma_f32_16x16x32_bf16 v[96:99], a[144:147], v[192:195], v[96:99]
ds_read_b64_tr_b16 a[140:141], v23 offset:24576
v_exp_f32 v190, v190
v_mfma_f32_16x16x32_bf16 v[100:103], a[144:147], v[196:199], v[100:103]
ds_read_b64_tr_b16 a[142:143], v23 offset:28672
v_exp_f32_e64 v191, v191
v_mfma_f32_16x16x32_bf16 v[104:107], a[148:151], v[192:195], v[104:107]
ds_read_b64_tr_b16 a[144:145], v24 offset:24576
v_cvt_pk_bf16_f32 v206, v188, v189
v_mfma_f32_16x16x32_bf16 v[108:111], a[148:151], v[196:199], v[108:111]
ds_read_b64_tr_b16 a[146:147], v24 offset:28672
s_nop 0
v_cvt_pk_bf16_f32 v207, v190, v191
v_mfma_f32_16x16x32_bf16 v[112:115], a[152:155], v[192:195], v[112:115]
ds_read_b64_tr_b16 a[148:149], v25 offset:24576
v_max3_f32 v34, v128, v129, v130
v_mfma_f32_16x16x32_bf16 v[116:119], a[152:155], v[196:199], v[116:119]
ds_read_b64_tr_b16 a[150:151], v25 offset:28672
v_max3_f32 v35, v132, v133, v134
v_max3_f32 v34, v34, v131, v136
v_mfma_f32_16x16x32_bf16 v[120:123], a[156:159], v[192:195], v[120:123]
ds_read_b64_tr_b16 a[152:153], v26 offset:24576
v_max3_f32 v35, v35, v135, v140
v_mfma_f32_16x16x32_bf16 v[124:127], a[156:159], v[196:199], v[124:127]
ds_read_b64_tr_b16 a[154:155], v26 offset:28672
v_max3_f32 v34, v34, v137, v138
v_max3_f32 v35, v35, v141, v142
v_mfma_f32_16x16x32_bf16 v[52:55], v[44:47], v[196:199], v[52:55]
s_waitcnt lgkmcnt(6)
v_mfma_f32_16x16x32_bf16 v[64:67], a[128:131], v[200:203], v[64:67]
ds_read_b64_tr_b16 a[156:157], v27 offset:24576
v_max3_f32 v34, v34, v139, v144
v_mfma_f32_16x16x32_bf16 v[68:71], a[128:131], v[204:207], v[68:71]
ds_read_b64_tr_b16 a[158:159], v27 offset:28672
v_max3_f32 v35, v35, v143, v148
v_mfma_f32_16x16x32_bf16 v[72:75], a[132:135], v[200:203], v[72:75]
s_waitcnt vmcnt(28)
s_barrier
ds_read_b128 a[96:99], v16 offset:49152
v_max3_f32 v34, v34, v145, v146
v_max3_f32 v35, v35, v149, v150
v_mfma_f32_16x16x32_bf16 v[76:79], a[132:135], v[204:207], v[76:79]
s_add_u32 m0, s37, 32768
s_add_u32 s57, s65, 65536
buffer_load_dwordx4 v3, s[20:23], s57 offen offset:0 lds
v_mfma_f32_16x16x32_bf16 v[80:83], a[136:139], v[200:203], v[80:83]
ds_read_b128 a[100:103], v17 offset:49152
v_mfma_f32_16x16x32_bf16 v[84:87], a[136:139], v[204:207], v[84:87]
buffer_load_dwordx4 v4, s[20:23], s57 offen offset:1024 lds
v_mfma_f32_16x16x32_bf16 v[88:91], a[140:143], v[200:203], v[88:91]
ds_read_b128 a[104:107], v18 offset:49152
v_mfma_f32_16x16x32_bf16 v[92:95], a[140:143], v[204:207], v[92:95]
buffer_load_dwordx4 v5, s[20:23], s57 offen offset:2048 lds
v_mfma_f32_16x16x32_bf16 v[48:51], v[44:47], v[200:203], v[48:51]
s_waitcnt lgkmcnt(3)
v_mfma_f32_16x16x32_bf16 v[96:99], a[144:147], v[200:203], v[96:99]
ds_read_b128 a[108:111], v19 offset:49152
v_mfma_f32_16x16x32_bf16 v[100:103], a[144:147], v[204:207], v[100:103]
buffer_load_dwordx4 v6, s[20:23], s57 offen offset:3072 lds
v_mfma_f32_16x16x32_bf16 v[104:107], a[148:151], v[200:203], v[104:107]
ds_read_b128 a[112:115], v16 offset:53248
v_mfma_f32_16x16x32_bf16 v[108:111], a[148:151], v[204:207], v[108:111]
v_mfma_f32_16x16x32_bf16 v[112:115], a[152:155], v[200:203], v[112:115]
ds_read_b128 a[116:119], v17 offset:53248
v_max3_f32 v34, v34, v147, v152
v_mfma_f32_16x16x32_bf16 v[116:119], a[152:155], v[204:207], v[116:119]
v_max3_f32 v35, v35, v151, v156
v_max3_f32 v34, v34, v153, v154
v_mfma_f32_16x16x32_bf16 v[120:123], a[156:159], v[200:203], v[120:123]
ds_read_b128 a[120:123], v18 offset:53248
v_max3_f32 v35, v35, v157, v158
v_max_f32 v34, v34, v155
v_mfma_f32_16x16x32_bf16 v[124:127], a[156:159], v[204:207], v[124:127]
v_max_f32 v35, v35, v159
v_max_f32 v36, v34, v35
v_mfma_f32_16x16x32_bf16 v[52:55], v[44:47], v[204:207], v[52:55]
v_cmp_lt_f32 vcc, s42, v36
s_cbranch_vccz L_f29
s_call_b64 s[94:95], L_rare
L_f29:
s_add_u32 s43, s43, 1
s_waitcnt lgkmcnt(3)
v_mfma_f32_16x16x32_bf16 v[160:163], a[96:99], a[0:3], v[56:59]
ds_read_b128 a[124:127], v19 offset:53248
v_exp_f32 v128, v128
v_mfma_f32_16x16x32_bf16 v[164:167], a[96:99], a[16:19], v[60:63]
v_exp_f32 v129, v129
v_exp_f32 v130, v130
v_mfma_f32_16x16x32_bf16 v[160:163], a[100:103], a[4:7], v[160:163]
ds_read_b128 a[96:99], v16 offset:57344
v_exp_f32_e64 v131, v131
v_mfma_f32_16x16x32_bf16 v[164:167], a[100:103], a[20:23], v[164:167]
v_cvt_pk_bf16_f32 v192, v128, v129
v_exp_f32_e64 v132, v132
v_mfma_f32_16x16x32_bf16 v[160:163], a[104:107], a[8:11], v[160:163]
ds_read_b128 a[100:103], v17 offset:57344
v_exp_f32_e64 v133, v133
v_mfma_f32_16x16x32_bf16 v[164:167], a[104:107], a[24:27], v[164:167]
v_cvt_pk_bf16_f32 v193, v130, v131
v_exp_f32_e64 v134, v134
v_mfma_f32_16x16x32_bf16 v[160:163], a[108:111], a[12:15], v[160:163]
ds_read_b128 a[104:107], v18 offset:57344
v_exp_f32_e64 v135, v135
v_mfma_f32_16x16x32_bf16 v[164:167], a[108:111], a[28:31], v[164:167]
v_cvt_pk_bf16_f32 v196, v132, v133
v_exp_f32 v136, v136
s_waitcnt lgkmcnt(3)
v_mfma_f32_16x16x32_bf16 v[168:171], a[112:115], a[0:3], v[56:59]
ds_read_b128 a[108:111], v19 offset:57344
v_exp_f32_e64 v137, v137
v_cvt_pk_bf16_f32 v197, v134, v135
v_mfma_f32_16x16x32_bf16 v[172:175], a[112:115], a[16:19], v[60:63]
v_exp_f32_e64 v138, v138
v_mfma_f32_16x16x32_bf16 v[168:171], a[116:119], a[4:7], v[168:171]
ds_read_b128 a[112:115], v16 offset:61440
v_exp_f32_e64 v139, v139
v_cvt_pk_bf16_f32 v194, v136, v137
v_mfma_f32_16x16x32_bf16 v[172:175], a[116:119], a[20:23], v[172:175]
v_exp_f32 v140, v140
v_exp_f32 v141, v141
v_mfma_f32_16x16x32_bf16 v[168:171], a[120:123], a[8:11], v[168:171]
ds_read_b128 a[116:119], v17 offset:61440
v_cvt_pk_bf16_f32 v195, v138, v139
v_mfma_f32_16x16x32_bf16 v[172:175], a[120:123], a[24:27], v[172:175]
v_exp_f32 v142, v142
v_exp_f32 v143, v143
v_mfma_f32_16x16x32_bf16 v[168:171], a[124:127], a[12:15], v[168:171]
ds_read_b128 a[120:123], v18 offset:61440
v_cvt_pk_bf16_f32 v198, v140, v141
v_mfma_f32_16x16x32_bf16 v[172:175], a[124:127], a[28:31], v[172:175]
v_exp_f32 v144, v144
v_exp_f32_e64 v145, v145
s_waitcnt lgkmcnt(3)
v_mfma_f32_16x16x32_bf16 v[176:179], a[96:99], a[0:3], v[56:59]
ds_read_b128 a[124:127], v19 offset:61440
v_cvt_pk_bf16_f32 v199, v142, v143
v_exp_f32_e64 v146, v146
v_mfma_f32_16x16x32_bf16 v[180:183], a[96:99], a[16:19], v[60:63]
v_exp_f32_e64 v147, v147
v_mfma_f32_16x16x32_bf16 v[176:179], a[100:103], a[4:7], v[176:179]
s_waitcnt vmcnt(28)
s_barrier
ds_read_b64_tr_b16 a[128:129], v20 offset:32768
v_cvt_pk_bf16_f32 v200, v144, v145
v_exp_f32_e64 v148, v148
v_mfma_f32_16x16x32_bf16 v[180:183], a[100:103], a[20:23], v[180:183]
ds_read_b64_tr_b16 a[130:131], v20 offset:36864
s_add_u32 m0, s37, 81920
s_add_u32 s57, s66, 0
buffer_load_dwordx4 v3, s[20:23], s57 offen offset:0 lds
v_mfma_f32_16x16x32_bf16 v[176:179], a[104:107], a[8:11], v[176:179]
ds_read_b64_tr_b16 a[132:133], v21 offset:32768
v_mfma_f32_16x16x32_bf16 v[180:183], a[104:107], a[24:27], v[180:183]
ds_read_b64_tr_b16 a[134:135], v21 offset:36864
buffer_load_dwordx4 v4, s[20:23], s57 offen offset:1024 lds
v_mfma_f32_16x16x32_bf16 v[176:179], a[108:111], a[12:15], v[176:179]
ds_read_b64_tr_b16 a[136:137], v22 offset:32768
v_mfma_f32_16x16x32_bf16 v[180:183], a[108:111], a[28:31], v[180:183]
ds_read_b64_tr_b16 a[138:139], v22 offset:36864
buffer_load_dwordx4 v5, s[20:23], s57 offen offset:2048 lds
s_waitcnt lgkmcnt(6)
v_mfma_f32_16x16x32_bf16 v[184:187], a[112:115], a[0:3], v[56:59]
ds_read_b64_tr_b16 a[140:141], v23 offset:32768
v_mfma_f32_16x16x32_bf16 v[188:191], a[112:115], a[16:19], v[60:63]
ds_read_b64_tr_b16 a[142:143], v23 offset:36864
buffer_load_dwordx4 v6, s[20:23], s57 offen offset:3072 lds
v_mfma_f32_16x16x32_bf16 v[184:187], a[116:119], a[4:7], v[184:187]
ds_read_b64_tr_b16 a[144:145], v24 offset:32768
v_mfma_f32_16x16x32_bf16 v[188:191], a[116:119], a[20:23], v[188:191]
ds_read_b64_tr_b16 a[146:147], v24 offset:36864
v_exp_f32_e64 v149, v149
v_mfma_f32_16x16x32_bf16 v[184:187], a[120:123], a[8:11], v[184:187]
ds_read_b64_tr_b16 a[148:149], v25 offset:32768
v_cvt_pk_bf16_f32 v201, v146, v147
v_mfma_f32_16x16x32_bf16 v[188:191], a[120:123], a[24:27], v[188:191]
ds_read_b64_tr_b16 a[150:151], v25 offset:36864
v_exp_f32_e64 v150, v150
v_mfma_f32_16x16x32_bf16 v[184:187], a[124:127], a[12:15], v[184:187]
ds_read_b64_tr_b16 a[152:153], v26 offset:32768
v_exp_f32_e64 v151, v151
v_cvt_pk_bf16_f32 v204, v148, v149
v_mfma_f32_16x16x32_bf16 v[188:191], a[124:127], a[28:31], v[188:191]
ds_read_b64_tr_b16 a[154:155], v26 offset:36864
s_nop 0
v_cvt_pk_bf16_f32 v205, v150, v151
s_waitcnt lgkmcnt(6)
v_mfma_f32_16x16x32_bf16 v[64:67], a[128:131], v[192:195], v[64:67]
ds_read_b64_tr_b16 a[156:157], v27 offset:32768
v_exp_f32_e64 v152, v152
v_mfma_f32_16x16x32_bf16 v[68:71], a[128:131], v[196:199], v[68:71]
ds_read_b64_tr_b16 a[158:159], v27 offset:36864
v_exp_f32_e64 v153, v153
v_mfma_f32_16x16x32_bf16 v[72:75], a[132:135], v[192:195], v[72:75]
ds_read_b64_tr_b16 a[128:129], v20 offset:40960
v_exp_f32_e64 v154, v154
v_mfma_f32_16x16x32_bf16 v[76:79], a[132:135], v[196:199], v[76:79]
ds_read_b64_tr_b16 a[130:131], v20 offset:45056
v_exp_f32_e64 v155, v155
v_mfma_f32_16x16x32_bf16 v[80:83], a[136:139], v[192:195], v[80:83]
ds_read_b64_tr_b16 a[132:133], v21 offset:40960
v_cvt_pk_bf16_f32 v202, v152, v153
v_mfma_f32_16x16x32_bf16 v[84:87], a[136:139], v[196:199], v[84:87]
ds_read_b64_tr_b16 a[134:135], v21 offset:45056
v_exp_f32_e64 v156, v156
v_mfma_f32_16x16x32_bf16 v[88:91], a[140:143], v[192:195], v[88:91]
ds_read_b64_tr_b16 a[136:137], v22 offset:40960
v_exp_f32_e64 v157, v157
v_mfma_f32_16x16x32_bf16 v[92:95], a[140:143], v[196:199], v[92:95]
ds_read_b64_tr_b16 a[138:139], v22 offset:45056
v_cvt_pk_bf16_f32 v203, v154, v155
v_mfma_f32_16x16x32_bf16 v[48:51], v[44:47], v[192:195], v[48:51]
s_waitcnt lgkmcnt(6)
v_mfma_f32_16x16x32_bf16 v[96:99], a[144:147], v[192:195], v[96:99]
ds_read_b64_tr_b16 a[140:141], v23 offset:40960
v_exp_f32 v158, v158
v_mfma_f32_16x16x32_bf16 v[100:103], a[144:147], v[196:199], v[100:103]
ds_read_b64_tr_b16 a[142:143], v23 offset:45056
v_exp_f32_e64 v159, v159
v_mfma_f32_16x16x32_bf16 v[104:107], a[148:151], v[192:195], v[104:107]
ds_read_b64_tr_b16 a[144:145], v24 offset:40960
v_cvt_pk_bf16_f32 v206, v156, v157
v_mfma_f32_16x16x32_bf16 v[108:111], a[148:151], v[196:199], v[108:111]
ds_read_b64_tr_b16 a[146:147], v24 offset:45056
s_nop 0
v_cvt_pk_bf16_f32 v207, v158, v159
v_mfma_f32_16x16x32_bf16 v[112:115], a[152:155], v[192:195], v[112:115]
ds_read_b64_tr_b16 a[148:149], v25 offset:40960
v_max3_f32 v34, v160, v161, v162
v_mfma_f32_16x16x32_bf16 v[116:119], a[152:155], v[196:199], v[116:119]
ds_read_b64_tr_b16 a[150:151], v25 offset:45056
v_max3_f32 v35, v164, v165, v166
v_mfma_f32_16x16x32_bf16 v[120:123], a[156:159], v[192:195], v[120:123]
ds_read_b64_tr_b16 a[152:153], v26 offset:40960
v_max3_f32 v34, v34, v163, v168
v_mfma_f32_16x16x32_bf16 v[124:127], a[156:159], v[196:199], v[124:127]
ds_read_b64_tr_b16 a[154:155], v26 offset:45056
v_max3_f32 v35, v35, v167, v172
v_mfma_f32_16x16x32_bf16 v[52:55], v[44:47], v[196:199], v[52:55]
s_waitcnt lgkmcnt(6)
v_mfma_f32_16x16x32_bf16 v[64:67], a[128:131], v[200:203], v[64:67]
ds_read_b64_tr_b16 a[156:157], v27 offset:40960
v_max3_f32 v34, v34, v169, v170
v_mfma_f32_16x16x32_bf16 v[68:71], a[128:131], v[204:207], v[68:71]
ds_read_b64_tr_b16 a[158:159], v27 offset:45056
v_max3_f32 v35, v35, v173, v174
v_mfma_f32_16x16x32_bf16 v[72:75], a[132:135], v[200:203], v[72:75]
s_barrier
v_max3_f32 v34, v34, v171, v176
v_max3_f32 v35, v35, v175, v180
v_mfma_f32_16x16x32_bf16 v[76:79], a[132:135], v[204:207], v[76:79]
s_add_u32 m0, s37, 49152
s_add_u32 s57, s66, 65536
buffer_load_dwordx4 v3, s[20:23], s57 offen offset:0 lds
v_mfma_f32_16x16x32_bf16 v[80:83], a[136:139], v[200:203], v[80:83]
v_mfma_f32_16x16x32_bf16 v[84:87], a[136:139], v[204:207], v[84:87]
buffer_load_dwordx4 v4, s[20:23], s57 offen offset:1024 lds
v_mfma_f32_16x16x32_bf16 v[88:91], a[140:143], v[200:203], v[88:91]
v_mfma_f32_16x16x32_bf16 v[92:95], a[140:143], v[204:207], v[92:95]
buffer_load_dwordx4 v5, s[20:23], s57 offen offset:2048 lds
v_mfma_f32_16x16x32_bf16 v[48:51], v[44:47], v[200:203], v[48:51]
s_waitcnt lgkmcnt(0)
v_mfma_f32_16x16x32_bf16 v[96:99], a[144:147], v[200:203], v[96:99]
v_mfma_f32_16x16x32_bf16 v[100:103], a[144:147], v[204:207], v[100:103]
buffer_load_dwordx4 v6, s[20:23], s57 offen offset:3072 lds
v_mfma_f32_16x16x32_bf16 v[104:107], a[148:151], v[200:203], v[104:107]
v_mfma_f32_16x16x32_bf16 v[108:111], a[148:151], v[204:207], v[108:111]
v_max3_f32 v34, v34, v177, v178
v_mfma_f32_16x16x32_bf16 v[112:115], a[152:155], v[200:203], v[112:115]
v_max3_f32 v35, v35, v181, v182
v_max3_f32 v34, v34, v179, v184
v_mfma_f32_16x16x32_bf16 v[116:119], a[152:155], v[204:207], v[116:119]
v_max3_f32 v35, v35, v183, v188
v_max3_f32 v34, v34, v185, v186
v_mfma_f32_16x16x32_bf16 v[120:123], a[156:159], v[200:203], v[120:123]
v_max3_f32 v35, v35, v189, v190
v_max_f32_e64 v34, v34, v187
v_mfma_f32_16x16x32_bf16 v[124:127], a[156:159], v[204:207], v[124:127]
v_max_f32 v35, v35, v191
v_max_f32 v36, v34, v35
v_mfma_f32_16x16x32_bf16 v[52:55], v[44:47], v[204:207], v[52:55]
v_cmp_lt_f32 vcc, s42, v36
s_cbranch_vccz L_f30
s_call_b64 s[94:95], L_rare
L_f30:
s_add_u32 s43, s43, 1
v_exp_f32 v160, v160
v_exp_f32 v161, v161
v_exp_f32 v162, v162
v_exp_f32 v163, v163
v_cvt_pk_bf16_f32 v192, v160, v161
v_exp_f32 v164, v164
v_exp_f32 v165, v165
v_cvt_pk_bf16_f32 v193, v162, v163
v_exp_f32 v166, v166
v_exp_f32 v167, v167
v_cvt_pk_bf16_f32 v196, v164, v165
v_exp_f32 v168, v168
v_exp_f32 v169, v169
v_cvt_pk_bf16_f32 v197, v166, v167
v_exp_f32 v170, v170
v_exp_f32 v171, v171
v_cvt_pk_bf16_f32 v194, v168, v169
v_exp_f32 v172, v172
v_exp_f32 v173, v173
v_cvt_pk_bf16_f32 v195, v170, v171
v_add_u32_e64 v15, 1, v15
s_waitcnt vmcnt(20)
s_mov_b64 exec, 1
buffer_store_dword v15, v14, s[24:27], s84 offen sc1
s_mov_b64 exec, -1
s_waitcnt vmcnt(29)
s_barrier
ds_read_b64_tr_b16 a[128:129], v20 offset:49152
ds_read_b64_tr_b16 a[130:131], v20 offset:53248
ds_read_b64_tr_b16 a[132:133], v21 offset:49152
ds_read_b64_tr_b16 a[134:135], v21 offset:53248
ds_read_b64_tr_b16 a[136:137], v22 offset:49152
ds_read_b64_tr_b16 a[138:139], v22 offset:53248
ds_read_b64_tr_b16 a[140:141], v23 offset:49152
ds_read_b64_tr_b16 a[142:143], v23 offset:53248
ds_read_b64_tr_b16 a[144:145], v24 offset:49152
ds_read_b64_tr_b16 a[146:147], v24 offset:53248
ds_read_b64_tr_b16 a[148:149], v25 offset:49152
ds_read_b64_tr_b16 a[150:151], v25 offset:53248
ds_read_b64_tr_b16 a[152:153], v26 offset:49152
ds_read_b64_tr_b16 a[154:155], v26 offset:53248
v_exp_f32 v174, v174
v_exp_f32_e64 v175, v175
v_cvt_pk_bf16_f32 v198, v172, v173
v_exp_f32 v176, v176
v_exp_f32 v177, v177
v_cvt_pk_bf16_f32 v199, v174, v175
s_nop 0
s_waitcnt lgkmcnt(6)
v_mfma_f32_16x16x32_bf16 v[64:67], a[128:131], v[192:195], v[64:67]
ds_read_b64_tr_b16 a[156:157], v27 offset:49152
s_add_u32 m0, s37, 98304
s_add_u32 s57, s67, 0
buffer_load_dwordx4 v3, s[20:23], s57 offen offset:0 lds
v_mfma_f32_16x16x32_bf16 v[68:71], a[128:131], v[196:199], v[68:71]
ds_read_b64_tr_b16 a[158:159], v27 offset:53248
v_exp_f32 v178, v178
v_mfma_f32_16x16x32_bf16 v[72:75], a[132:135], v[192:195], v[72:75]
ds_read_b64_tr_b16 a[128:129], v20 offset:57344
buffer_load_dwordx4 v4, s[20:23], s57 offen offset:1024 lds
v_mfma_f32_16x16x32_bf16 v[76:79], a[132:135], v[196:199], v[76:79]
ds_read_b64_tr_b16 a[130:131], v20 offset:61440
v_exp_f32_e64 v179, v179
v_cvt_pk_bf16_f32 v200, v176, v177
v_exp_f32_e64 v180, v180
v_mfma_f32_16x16x32_bf16 v[80:83], a[136:139], v[192:195], v[80:83]
ds_read_b64_tr_b16 a[132:133], v21 offset:57344
buffer_load_dwordx4 v5, s[20:23], s57 offen offset:2048 lds
v_mfma_f32_16x16x32_bf16 v[84:87], a[136:139], v[196:199], v[84:87]
ds_read_b64_tr_b16 a[134:135], v21 offset:61440
v_exp_f32_e64 v181, v181
v_cvt_pk_bf16_f32 v201, v178, v179
v_exp_f32_e64 v182, v182
v_mfma_f32_16x16x32_bf16 v[88:91], a[140:143], v[192:195], v[88:91]
ds_read_b64_tr_b16 a[136:137], v22 offset:57344
buffer_load_dwordx4 v6, s[20:23], s57 offen offset:3072 lds
v_mfma_f32_16x16x32_bf16 v[92:95], a[140:143], v[196:199], v[92:95]
ds_read_b64_tr_b16 a[138:139], v22 offset:61440
v_exp_f32_e64 v183, v183
v_cvt_pk_bf16_f32 v204, v180, v181
v_mfma_f32_16x16x32_bf16 v[48:51], v[44:47], v[192:195], v[48:51]
s_waitcnt lgkmcnt(6)
v_mfma_f32_16x16x32_bf16 v[96:99], a[144:147], v[192:195], v[96:99]
ds_read_b64_tr_b16 a[140:141], v23 offset:57344
v_exp_f32 v184, v184
v_exp_f32_e64 v185, v185
v_cvt_pk_bf16_f32 v205, v182, v183
v_mfma_f32_16x16x32_bf16 v[100:103], a[144:147], v[196:199], v[100:103]
ds_read_b64_tr_b16 a[142:143], v23 offset:61440
v_exp_f32 v186, v186
v_exp_f32 v187, v187
v_mfma_f32_16x16x32_bf16 v[104:107], a[148:151], v[192:195], v[104:107]
ds_read_b64_tr_b16 a[144:145], v24 offset:57344
v_cvt_pk_bf16_f32 v202, v184, v185
v_exp_f32 v188, v188
v_exp_f32 v189, v189
v_mfma_f32_16x16x32_bf16 v[108:111], a[148:151], v[196:199], v[108:111]
ds_read_b64_tr_b16 a[146:147], v24 offset:61440
v_cvt_pk_bf16_f32 v203, v186, v187
v_exp_f32_e64 v190, v190
v_mfma_f32_16x16x32_bf16 v[112:115], a[152:155], v[192:195], v[112:115]
ds_read_b64_tr_b16 a[148:149], v25 offset:57344
v_exp_f32_e64 v191, v191
v_cvt_pk_bf16_f32 v206, v188, v189
s_nop 0
v_cvt_pk_bf16_f32 v207, v190, v191
v_mfma_f32_16x16x32_bf16 v[116:119], a[152:155], v[196:199], v[116:119]
ds_read_b64_tr_b16 a[150:151], v25 offset:61440
v_mfma_f32_16x16x32_bf16 v[120:123], a[156:159], v[192:195], v[120:123]
ds_read_b64_tr_b16 a[152:153], v26 offset:57344
v_mfma_f32_16x16x32_bf16 v[124:127], a[156:159], v[196:199], v[124:127]
ds_read_b64_tr_b16 a[154:155], v26 offset:61440
v_mfma_f32_16x16x32_bf16 v[52:55], v[44:47], v[196:199], v[52:55]
s_waitcnt lgkmcnt(6)
v_mfma_f32_16x16x32_bf16 v[64:67], a[128:131], v[200:203], v[64:67]
ds_read_b64_tr_b16 a[156:157], v27 offset:57344
v_mfma_f32_16x16x32_bf16 v[68:71], a[128:131], v[204:207], v[68:71]
ds_read_b64_tr_b16 a[158:159], v27 offset:61440
v_mfma_f32_16x16x32_bf16 v[72:75], a[132:135], v[200:203], v[72:75]
v_mfma_f32_16x16x32_bf16 v[76:79], a[132:135], v[204:207], v[76:79]
v_mfma_f32_16x16x32_bf16 v[48:51], v[44:47], v[200:203], v[48:51]
v_mfma_f32_16x16x32_bf16 v[80:83], a[136:139], v[200:203], v[80:83]
v_mfma_f32_16x16x32_bf16 v[84:87], a[136:139], v[204:207], v[84:87]
v_mfma_f32_16x16x32_bf16 v[88:91], a[140:143], v[200:203], v[88:91]
v_mfma_f32_16x16x32_bf16 v[92:95], a[140:143], v[204:207], v[92:95]
v_mfma_f32_16x16x32_bf16 v[52:55], v[44:47], v[204:207], v[52:55]
s_waitcnt lgkmcnt(0)
v_mfma_f32_16x16x32_bf16 v[96:99], a[144:147], v[200:203], v[96:99]
v_mfma_f32_16x16x32_bf16 v[100:103], a[144:147], v[204:207], v[100:103]
v_mfma_f32_16x16x32_bf16 v[104:107], a[148:151], v[200:203], v[104:107]
v_mfma_f32_16x16x32_bf16 v[108:111], a[148:151], v[204:207], v[108:111]
v_mfma_f32_16x16x32_bf16 v[112:115], a[152:155], v[200:203], v[112:115]
v_mfma_f32_16x16x32_bf16 v[116:119], a[152:155], v[204:207], v[116:119]
v_mfma_f32_16x16x32_bf16 v[120:123], a[156:159], v[200:203], v[120:123]
v_mfma_f32_16x16x32_bf16 v[124:127], a[156:159], v[204:207], v[124:127]
v_add_u32 v15, 1, v15
v_add_u32_e64 v253, 1, v253
buffer_load_dword v29, v13, s[24:27], s85 offen sc1
v_add_u32 v192, -65536, v20
v_add_u32 v193, -65536, v21
v_add_u32 v194, -65536, v22
v_add_u32 v195, -65536, v23
v_add_u32 v196, -65536, v24
v_add_u32 v197, -65536, v25
v_add_u32 v198, -65536, v26
v_add_u32 v199, -65536, v27
v_add_u32 v30, 8192, v40
s_nop 4
v_rcp_f32 v8, v48
v_rcp_f32 v9, v48
v_rcp_f32 v10, v52
v_rcp_f32 v11, v52
s_nop 0
v_pk_mul_f32 v[64:65], v[64:65], v[8:9]
v_pk_mul_f32 v[66:67], v[66:67], v[8:9]
v_pk_mul_f32 v[72:73], v[72:73], v[8:9]
v_pk_mul_f32 v[74:75], v[74:75], v[8:9]
v_cvt_pk_bf16_f32 v128, v64, v65
v_cvt_pk_bf16_f32 v129, v66, v67
v_cvt_pk_bf16_f32 v130, v72, v73
v_cvt_pk_bf16_f32 v131, v74, v75
buffer_store_dwordx4 v[128:131], v40, s[24:27], s50 offen offset:0 sc1
v_pk_mul_f32 v[68:69], v[68:69], v[10:11]
v_pk_mul_f32 v[70:71], v[70:71], v[10:11]
v_pk_mul_f32 v[76:77], v[76:77], v[10:11]
v_pk_mul_f32 v[78:79], v[78:79], v[10:11]
v_cvt_pk_bf16_f32 v132, v68, v69
v_cvt_pk_bf16_f32 v133, v70, v71
v_cvt_pk_bf16_f32 v134, v76, v77
v_cvt_pk_bf16_f32 v135, v78, v79
buffer_store_dwordx4 v[132:135], v40, s[24:27], s50 offen offset:1024 sc1
s_add_u32 s50, s50, 8192
v_pk_mul_f32 v[80:81], v[80:81], v[8:9]
v_pk_mul_f32 v[82:83], v[82:83], v[8:9]
v_pk_mul_f32 v[88:89], v[88:89], v[8:9]
v_pk_mul_f32 v[90:91], v[90:91], v[8:9]
v_cvt_pk_bf16_f32 v136, v80, v81
v_cvt_pk_bf16_f32 v137, v82, v83
v_cvt_pk_bf16_f32 v138, v88, v89
v_cvt_pk_bf16_f32 v139, v90, v91
buffer_store_dwordx4 v[136:139], v40, s[24:27], s50 offen offset:0 sc1
v_pk_mul_f32 v[84:85], v[84:85], v[10:11]
v_pk_mul_f32 v[86:87], v[86:87], v[10:11]
v_pk_mul_f32 v[92:93], v[92:93], v[10:11]
v_pk_mul_f32 v[94:95], v[94:95], v[10:11]
v_cvt_pk_bf16_f32 v140, v84, v85
v_cvt_pk_bf16_f32 v141, v86, v87
v_cvt_pk_bf16_f32 v142, v92, v93
v_cvt_pk_bf16_f32 v143, v94, v95
buffer_store_dwordx4 v[140:143], v40, s[24:27], s50 offen offset:1024 sc1
s_add_u32 s50, s50, 8192
v_pk_mul_f32 v[96:97], v[96:97], v[8:9]
v_pk_mul_f32 v[98:99], v[98:99], v[8:9]
v_pk_mul_f32 v[104:105], v[104:105], v[8:9]
v_pk_mul_f32 v[106:107], v[106:107], v[8:9]
v_cvt_pk_bf16_f32 v144, v96, v97
v_cvt_pk_bf16_f32 v145, v98, v99
v_cvt_pk_bf16_f32 v146, v104, v105
v_cvt_pk_bf16_f32 v147, v106, v107
buffer_store_dwordx4 v[144:147], v40, s[24:27], s50 offen offset:0 sc1
v_pk_mul_f32 v[100:101], v[100:101], v[10:11]
v_pk_mul_f32 v[102:103], v[102:103], v[10:11]
v_pk_mul_f32 v[108:109], v[108:109], v[10:11]
v_pk_mul_f32 v[110:111], v[110:111], v[10:11]
v_cvt_pk_bf16_f32 v148, v100, v101
v_cvt_pk_bf16_f32 v149, v102, v103
v_cvt_pk_bf16_f32 v150, v108, v109
v_cvt_pk_bf16_f32 v151, v110, v111
buffer_store_dwordx4 v[148:151], v40, s[24:27], s50 offen offset:1024 sc1
s_add_u32 s50, s50, 8192
v_pk_mul_f32 v[112:113], v[112:113], v[8:9]
v_pk_mul_f32 v[114:115], v[114:115], v[8:9]
v_pk_mul_f32 v[120:121], v[120:121], v[8:9]
v_pk_mul_f32 v[122:123], v[122:123], v[8:9]
v_cvt_pk_bf16_f32 v152, v112, v113
v_cvt_pk_bf16_f32 v153, v114, v115
v_cvt_pk_bf16_f32 v154, v120, v121
v_cvt_pk_bf16_f32 v155, v122, v123
buffer_store_dwordx4 v[152:155], v40, s[24:27], s50 offen offset:0 sc1
v_pk_mul_f32 v[116:117], v[116:117], v[10:11]
v_pk_mul_f32 v[118:119], v[118:119], v[10:11]
v_pk_mul_f32 v[124:125], v[124:125], v[10:11]
v_pk_mul_f32 v[126:127], v[126:127], v[10:11]
v_cvt_pk_bf16_f32 v156, v116, v117
v_cvt_pk_bf16_f32 v157, v118, v119
v_cvt_pk_bf16_f32 v158, v124, v125
v_cvt_pk_bf16_f32 v159, v126, v127
buffer_store_dwordx4 v[156:159], v40, s[24:27], s50 offen offset:1024 sc1
s_add_u32 s50, s50, 8192
s_waitcnt vmcnt(8)
s_barrier
ds_read_b64_tr_b16 a[128:129], v240 offset:0
ds_read_b64_tr_b16 a[130:131], v240 offset:4096
ds_read_b64_tr_b16 a[132:133], v241 offset:0
ds_read_b64_tr_b16 a[134:135], v241 offset:4096
ds_read_b64_tr_b16 a[136:137], v242 offset:0
ds_read_b64_tr_b16 a[138:139], v242 offset:4096
ds_read_b64_tr_b16 a[140:141], v243 offset:0
ds_read_b64_tr_b16 a[142:143], v243 offset:4096
ds_read_b64_tr_b16 a[144:145], v244 offset:0
ds_read_b64_tr_b16 a[146:147], v244 offset:4096
ds_read_b64_tr_b16 a[148:149], v245 offset:0
ds_read_b64_tr_b16 a[150:151], v245 offset:4096
ds_read_b64_tr_b16 a[152:153], v246 offset:0
ds_read_b64_tr_b16 a[154:155], v246 offset:4096
s_waitcnt lgkmcnt(6)
v_mfma_f32_16x16x32_bf16 v[64:67], a[128:131], v[208:211], 0
ds_read_b64_tr_b16 a[156:157], v247 offset:0
v_mfma_f32_16x16x32_bf16 v[68:71], a[128:131], v[212:215], 0
ds_read_b64_tr_b16 a[158:159], v247 offset:4096
v_mfma_f32_16x16x32_bf16 v[72:75], a[132:135], v[208:211], 0
buffer_load_dword v29, v13, s[24:27], s85 offen sc1
s_add_u32 m0, s37, 114688
s_add_u32 s57, s67, 65536
buffer_load_dwordx4 v3, s[20:23], s57 offen offset:0 lds
ds_read_b64_tr_b16 a[128:129], v240 offset:8192
v_mfma_f32_16x16x32_bf16 v[76:79], a[132:135], v[212:215], 0
ds_read_b64_tr_b16 a[130:131], v240 offset:12288
v_mfma_f32_16x16x32_bf16 v[80:83], a[136:139], v[208:211], 0
ds_read_b64_tr_b16 a[132:133], v241 offset:8192
v_mfma_f32_16x16x32_bf16 v[84:87], a[136:139], v[212:215], 0
ds_read_b64_tr_b16 a[134:135], v241 offset:12288
v_mfma_f32_16x16x32_bf16 v[88:91], a[140:143], v[208:211], 0
buffer_load_dwordx4 v4, s[20:23], s57 offen offset:1024 lds
ds_read_b64_tr_b16 a[136:137], v242 offset:8192
v_mfma_f32_16x16x32_bf16 v[92:95], a[140:143], v[212:215], 0
ds_read_b64_tr_b16 a[138:139], v242 offset:12288
s_waitcnt lgkmcnt(6)
v_mfma_f32_16x16x32_bf16 v[96:99], a[144:147], v[208:211], 0
ds_read_b64_tr_b16 a[140:141], v243 offset:8192
v_mfma_f32_16x16x32_bf16 v[100:103], a[144:147], v[212:215], 0
ds_read_b64_tr_b16 a[142:143], v243 offset:12288
v_mfma_f32_16x16x32_bf16 v[104:107], a[148:151], v[208:211], 0
buffer_load_dwordx4 v5, s[20:23], s57 offen offset:2048 lds
ds_read_b64_tr_b16 a[144:145], v244 offset:8192
v_mfma_f32_16x16x32_bf16 v[108:111], a[148:151], v[212:215], 0
ds_read_b64_tr_b16 a[146:147], v244 offset:12288
v_mfma_f32_16x16x32_bf16 v[112:115], a[152:155], v[208:211], 0
ds_read_b64_tr_b16 a[148:149], v245 offset:8192
v_mfma_f32_16x16x32_bf16 v[116:119], a[152:155], v[212:215], 0
ds_read_b64_tr_b16 a[150:151], v245 offset:12288
v_mfma_f32_16x16x32_bf16 v[120:123], a[156:159], v[208:211], 0
buffer_load_dwordx4 v6, s[20:23], s57 offen offset:3072 lds
ds_read_b64_tr_b16 a[152:153], v246 offset:8192
v_mfma_f32_16x16x32_bf16 v[124:127], a[156:159], v[212:215], 0
ds_read_b64_tr_b16 a[154:155], v246 offset:12288
s_waitcnt lgkmcnt(6)
v_mfma_f32_16x16x32_bf16 v[64:67], a[128:131], v[216:219], v[64:67]
ds_read_b64_tr_b16 a[156:157], v247 offset:8192
v_mfma_f32_16x16x32_bf16 v[68:71], a[128:131], v[220:223], v[68:71]
ds_read_b64_tr_b16 a[158:159], v247 offset:12288
v_mfma_f32_16x16x32_bf16 v[72:75], a[132:135], v[216:219], v[72:75]
ds_read_b64_tr_b16 a[128:129], v240 offset:16384
v_mfma_f32_16x16x32_bf16 v[76:79], a[132:135], v[220:223], v[76:79]
ds_read_b64_tr_b16 a[130:131], v240 offset:20480
v_mfma_f32_16x16x32_bf16 v[80:83], a[136:139], v[216:219], v[80:83]
ds_read_b64_tr_b16 a[132:133], v241 offset:16384
v_mfma_f32_16x16x32_bf16 v[84:87], a[136:139], v[220:223], v[84:87]
ds_read_b64_tr_b16 a[134:135], v241 offset:20480
v_mfma_f32_16x16x32_bf16 v[88:91], a[140:143], v[216:219], v[88:91]
ds_read_b64_tr_b16 a[136:137], v242 offset:16384
v_mfma_f32_16x16x32_bf16 v[92:95], a[140:143], v[220:223], v[92:95]
ds_read_b64_tr_b16 a[138:139], v242 offset:20480
s_waitcnt lgkmcnt(6)
v_mfma_f32_16x16x32_bf16 v[96:99], a[144:147], v[216:219], v[96:99]
ds_read_b64_tr_b16 a[140:141], v243 offset:16384
v_mfma_f32_16x16x32_bf16 v[100:103], a[144:147], v[220:223], v[100:103]
ds_read_b64_tr_b16 a[142:143], v243 offset:20480
v_mfma_f32_16x16x32_bf16 v[104:107], a[148:151], v[216:219], v[104:107]
ds_read_b64_tr_b16 a[144:145], v244 offset:16384
v_mfma_f32_16x16x32_bf16 v[108:111], a[148:151], v[220:223], v[108:111]
ds_read_b64_tr_b16 a[146:147], v244 offset:20480
v_mfma_f32_16x16x32_bf16 v[112:115], a[152:155], v[216:219], v[112:115]
ds_read_b64_tr_b16 a[148:149], v245 offset:16384
v_mfma_f32_16x16x32_bf16 v[116:119], a[152:155], v[220:223], v[116:119]
ds_read_b64_tr_b16 a[150:151], v245 offset:20480
v_mfma_f32_16x16x32_bf16 v[120:123], a[156:159], v[216:219], v[120:123]
ds_read_b64_tr_b16 a[152:153], v246 offset:16384
v_mfma_f32_16x16x32_bf16 v[124:127], a[156:159], v[220:223], v[124:127]
ds_read_b64_tr_b16 a[154:155], v246 offset:20480
s_waitcnt lgkmcnt(6)
v_mfma_f32_16x16x32_bf16 v[64:67], a[128:131], v[224:227], v[64:67]
ds_read_b64_tr_b16 a[156:157], v247 offset:16384
v_mfma_f32_16x16x32_bf16 v[68:71], a[128:131], v[228:231], v[68:71]
ds_read_b64_tr_b16 a[158:159], v247 offset:20480
v_mfma_f32_16x16x32_bf16 v[72:75], a[132:135], v[224:227], v[72:75]
s_waitcnt vmcnt(4)
s_mov_b32 s87, 0x40000
L_c1:
v_cmp_eq_u32 vcc, v12, v29
s_cbranch_vccz L_c1_ok
s_sub_u32 s87, s87, 1
s_cbranch_scc1 L_c1_ok
buffer_load_dword v29, v13, s[24:27], s85 offen sc1
s_waitcnt vmcnt(0)
s_branch L_c1
L_c1_ok:
v_add_u32_e64 v12, 2, v12
s_waitcnt vmcnt(5)
s_mov_b64 exec, 1
buffer_store_dword v15, v14, s[24:27], s84 offen sc1
s_mov_b64 exec, -1
s_add_u32 s56, s69, 0
buffer_load_dwordx4 a[160:163], v40, s[24:27], s56 offen offset:0 sc1
ds_read_b64_tr_b16 a[128:129], v240 offset:24576
v_mfma_f32_16x16x32_bf16 v[76:79], a[132:135], v[228:231], v[76:79]
ds_read_b64_tr_b16 a[130:131], v240 offset:28672
v_mfma_f32_16x16x32_bf16 v[80:83], a[136:139], v[224:227], v[80:83]
ds_read_b64_tr_b16 a[132:133], v241 offset:24576
v_mfma_f32_16x16x32_bf16 v[84:87], a[136:139], v[228:231], v[84:87]
ds_read_b64_tr_b16 a[134:135], v241 offset:28672
v_mfma_f32_16x16x32_bf16 v[88:91], a[140:143], v[224:227], v[88:91]
buffer_load_dwordx4 a[164:167], v40, s[24:27], s56 offen offset:1024 sc1
ds_read_b64_tr_b16 a[136:137], v242 offset:24576
v_mfma_f32_16x16x32_bf16 v[92:95], a[140:143], v[228:231], v[92:95]
ds_read_b64_tr_b16 a[138:139], v242 offset:28672
s_waitcnt lgkmcnt(6)
v_mfma_f32_16x16x32_bf16 v[96:99], a[144:147], v[224:227], v[96:99]
ds_read_b64_tr_b16 a[140:141], v243 offset:24576
v_mfma_f32_16x16x32_bf16 v[100:103], a[144:147], v[228:231], v[100:103]
ds_read_b64_tr_b16 a[142:143], v243 offset:28672
v_mfma_f32_16x16x32_bf16 v[104:107], a[148:151], v[224:227], v[104:107]
buffer_load_dwordx4 a[168:171], v30, s[24:27], s56 offen offset:0 sc1
ds_read_b64_tr_b16 a[144:145], v244 offset:24576
v_mfma_f32_16x16x32_bf16 v[108:111], a[148:151], v[228:231], v[108:111]
ds_read_b64_tr_b16 a[146:147], v244 offset:28672
v_mfma_f32_16x16x32_bf16 v[112:115], a[152:155], v[224:227], v[112:115]
ds_read_b64_tr_b16 a[148:149], v245 offset:24576
v_mfma_f32_16x16x32_bf16 v[116:119], a[152:155], v[228:231], v[116:119]
ds_read_b64_tr_b16 a[150:151], v245 offset:28672
v_mfma_f32_16x16x32_bf16 v[120:123], a[156:159], v[224:227], v[120:123]
buffer_load_dwordx4 a[172:175], v30, s[24:27], s56 offen offset:1024 sc1
ds_read_b64_tr_b16 a[152:153], v246 offset:24576
v_mfma_f32_16x16x32_bf16 v[124:127], a[156:159], v[228:231], v[124:127]
ds_read_b64_tr_b16 a[154:155], v246 offset:28672
s_waitcnt lgkmcnt(6)
v_mfma_f32_16x16x32_bf16 v[64:67], a[128:131], v[232:235], v[64:67]
ds_read_b64_tr_b16 a[156:157], v247 offset:24576
v_mfma_f32_16x16x32_bf16 v[68:71], a[128:131], v[236:239], v[68:71]
ds_read_b64_tr_b16 a[158:159], v247 offset:28672
v_mfma_f32_16x16x32_bf16 v[72:75], a[132:135], v[232:235], v[72:75]
ds_read_b64_tr_b16 a[128:129], v192 offset:0
v_mfma_f32_16x16x32_bf16 v[76:79], a[132:135], v[236:239], v[76:79]
ds_read_b64_tr_b16 a[130:131], v192 offset:4096
v_mfma_f32_16x16x32_bf16 v[80:83], a[136:139], v[232:235], v[80:83]
ds_read_b64_tr_b16 a[132:133], v193 offset:0
v_mfma_f32_16x16x32_bf16 v[84:87], a[136:139], v[236:239], v[84:87]
ds_read_b64_tr_b16 a[134:135], v193 offset:4096
v_mfma_f32_16x16x32_bf16 v[88:91], a[140:143], v[232:235], v[88:91]
ds_read_b64_tr_b16 a[136:137], v194 offset:0
v_mfma_f32_16x16x32_bf16 v[92:95], a[140:143], v[236:239], v[92:95]
ds_read_b64_tr_b16 a[138:139], v194 offset:4096
s_waitcnt lgkmcnt(6)
v_mfma_f32_16x16x32_bf16 v[96:99], a[144:147], v[232:235], v[96:99]
ds_read_b64_tr_b16 a[140:141], v195 offset:0
v_mfma_f32_16x16x32_bf16 v[100:103], a[144:147], v[236:239], v[100:103]
ds_read_b64_tr_b16 a[142:143], v195 offset:4096
v_mfma_f32_16x16x32_bf16 v[104:107], a[148:151], v[232:235], v[104:107]
ds_read_b64_tr_b16 a[144:145], v196 offset:0
v_mfma_f32_16x16x32_bf16 v[108:111], a[148:151], v[236:239], v[108:111]
ds_read_b64_tr_b16 a[146:147], v196 offset:4096
v_mfma_f32_16x16x32_bf16 v[112:115], a[152:155], v[232:235], v[112:115]
ds_read_b64_tr_b16 a[148:149], v197 offset:0
v_mfma_f32_16x16x32_bf16 v[116:119], a[152:155], v[236:239], v[116:119]
ds_read_b64_tr_b16 a[150:151], v197 offset:4096
v_mfma_f32_16x16x32_bf16 v[120:123], a[156:159], v[232:235], v[120:123]
ds_read_b64_tr_b16 a[152:153], v198 offset:0
v_mfma_f32_16x16x32_bf16 v[124:127], a[156:159], v[236:239], v[124:127]
ds_read_b64_tr_b16 a[154:155], v198 offset:4096
s_waitcnt lgkmcnt(6)
v_mfma_f32_16x16x32_bf16 v[64:67], a[128:131], v[128:131], v[64:67]
ds_read_b64_tr_b16 a[156:157], v199 offset:0
v_mfma_f32_16x16x32_bf16 v[68:71], a[128:131], v[132:135], v[68:71]
ds_read_b64_tr_b16 a[158:159], v199 offset:4096
v_mfma_f32_16x16x32_bf16 v[72:75], a[132:135], v[128:131], v[72:75]
s_add_u32 s56, s69, 16384
buffer_load_dwordx4 a[176:179], v40, s[24:27], s56 offen offset:0 sc1
ds_read_b64_tr_b16 a[128:129], v192 offset:8192
v_mfma_f32_16x16x32_bf16 v[76:79], a[132:135], v[132:135], v[76:79]
ds_read_b64_tr_b16 a[130:131], v192 offset:12288
v_mfma_f32_16x16x32_bf16 v[80:83], a[136:139], v[128:131], v[80:83]
ds_read_b64_tr_b16 a[132:133], v193 offset:8192
v_mfma_f32_16x16x32_bf16 v[84:87], a[136:139], v[132:135], v[84:87]
ds_read_b64_tr_b16 a[134:135], v193 offset:12288
v_mfma_f32_16x16x32_bf16 v[88:91], a[140:143], v[128:131], v[88:91]
buffer_load_dwordx4 a[180:183], v40, s[24:27], s56 offen offset:1024 sc1
ds_read_b64_tr_b16 a[136:137], v194 offset:8192
v_mfma_f32_16x16x32_bf16 v[92:95], a[140:143], v[132:135], v[92:95]
ds_read_b64_tr_b16 a[138:139], v194 offset:12288
s_waitcnt lgkmcnt(6)
v_mfma_f32_16x16x32_bf16 v[96:99], a[144:147], v[128:131], v[96:99]
ds_read_b64_tr_b16 a[140:141], v195 offset:8192
v_mfma_f32_16x16x32_bf16 v[100:103], a[144:147], v[132:135], v[100:103]
ds_read_b64_tr_b16 a[142:143], v195 offset:12288
v_mfma_f32_16x16x32_bf16 v[104:107], a[148:151], v[128:131], v[104:107]
buffer_load_dwordx4 a[184:187], v30, s[24:27], s56 offen offset:0 sc1
ds_read_b64_tr_b16 a[144:145], v196 offset:8192
v_mfma_f32_16x16x32_bf16 v[108:111], a[148:151], v[132:135], v[108:111]
ds_read_b64_tr_b16 a[146:147], v196 offset:12288
v_mfma_f32_16x16x32_bf16 v[112:115], a[152:155], v[128:131], v[112:115]
ds_read_b64_tr_b16 a[148:149], v197 offset:8192
v_mfma_f32_16x16x32_bf16 v[116:119], a[152:155], v[132:135], v[116:119]
ds_read_b64_tr_b16 a[150:151], v197 offset:12288
v_mfma_f32_16x16x32_bf16 v[120:123], a[156:159], v[128:131], v[120:123]
buffer_load_dwordx4 a[188:191], v30, s[24:27], s56 offen offset:1024 sc1
ds_read_b64_tr_b16 a[152:153], v198 offset:8192
v_mfma_f32_16x16x32_bf16 v[124:127], a[156:159], v[132:135], v[124:127]
ds_read_b64_tr_b16 a[154:155], v198 offset:12288
s_waitcnt lgkmcnt(6)
v_mfma_f32_16x16x32_bf16 v[64:67], a[128:131], v[136:139], v[64:67]
ds_read_b64_tr_b16 a[156:157], v199 offset:8192
v_mfma_f32_16x16x32_bf16 v[68:71], a[128:131], v[140:143], v[68:71]
ds_read_b64_tr_b16 a[158:159], v199 offset:12288
v_mfma_f32_16x16x32_bf16 v[72:75], a[132:135], v[136:139], v[72:75]
ds_read_b64_tr_b16 a[128:129], v192 offset:16384
v_mfma_f32_16x16x32_bf16 v[76:79], a[132:135], v[140:143], v[76:79]
ds_read_b64_tr_b16 a[130:131], v192 offset:20480
v_mfma_f32_16x16x32_bf16 v[80:83], a[136:139], v[136:139], v[80:83]
ds_read_b64_tr_b16 a[132:133], v193 offset:16384
v_mfma_f32_16x16x32_bf16 v[84:87], a[136:139], v[140:143], v[84:87]
ds_read_b64_tr_b16 a[134:135], v193 offset:20480
v_mfma_f32_16x16x32_bf16 v[88:91], a[140:143], v[136:139], v[88:91]
ds_read_b64_tr_b16 a[136:137], v194 offset:16384
v_mfma_f32_16x16x32_bf16 v[92:95], a[140:143], v[140:143], v[92:95]
ds_read_b64_tr_b16 a[138:139], v194 offset:20480
s_waitcnt lgkmcnt(6)
v_mfma_f32_16x16x32_bf16 v[96:99], a[144:147], v[136:139], v[96:99]
ds_read_b64_tr_b16 a[140:141], v195 offset:16384
v_mfma_f32_16x16x32_bf16 v[100:103], a[144:147], v[140:143], v[100:103]
ds_read_b64_tr_b16 a[142:143], v195 offset:20480
v_mfma_f32_16x16x32_bf16 v[104:107], a[148:151], v[136:139], v[104:107]
ds_read_b64_tr_b16 a[144:145], v196 offset:16384
v_mfma_f32_16x16x32_bf16 v[108:111], a[148:151], v[140:143], v[108:111]
ds_read_b64_tr_b16 a[146:147], v196 offset:20480
v_mfma_f32_16x16x32_bf16 v[112:115], a[152:155], v[136:139], v[112:115]
ds_read_b64_tr_b16 a[148:149], v197 offset:16384
v_mfma_f32_16x16x32_bf16 v[116:119], a[152:155], v[140:143], v[116:119]
ds_read_b64_tr_b16 a[150:151], v197 offset:20480
v_mfma_f32_16x16x32_bf16 v[120:123], a[156:159], v[136:139], v[120:123]
ds_read_b64_tr_b16 a[152:153], v198 offset:16384
v_mfma_f32_16x16x32_bf16 v[124:127], a[156:159], v[140:143], v[124:127]
ds_read_b64_tr_b16 a[154:155], v198 offset:20480
s_waitcnt lgkmcnt(6)
v_mfma_f32_16x16x32_bf16 v[64:67], a[128:131], v[144:147], v[64:67]
ds_read_b64_tr_b16 a[156:157], v199 offset:16384
v_mfma_f32_16x16x32_bf16 v[68:71], a[128:131], v[148:151], v[68:71]
ds_read_b64_tr_b16 a[158:159], v199 offset:20480
v_mfma_f32_16x16x32_bf16 v[72:75], a[132:135], v[144:147], v[72:75]
s_add_u32 s56, s70, 0
buffer_load_dwordx4 a[192:195], v40, s[24:27], s56 offen offset:0 sc1
ds_read_b64_tr_b16 a[128:129], v192 offset:24576
v_mfma_f32_16x16x32_bf16 v[76:79], a[132:135], v[148:151], v[76:79]
ds_read_b64_tr_b16 a[130:131], v192 offset:28672
v_mfma_f32_16x16x32_bf16 v[80:83], a[136:139], v[144:147], v[80:83]
ds_read_b64_tr_b16 a[132:133], v193 offset:24576
v_mfma_f32_16x16x32_bf16 v[84:87], a[136:139], v[148:151], v[84:87]
ds_read_b64_tr_b16 a[134:135], v193 offset:28672
v_mfma_f32_16x16x32_bf16 v[88:91], a[140:143], v[144:147], v[88:91]
buffer_load_dwordx4 a[196:199], v40, s[24:27], s56 offen offset:1024 sc1
ds_read_b64_tr_b16 a[136:137], v194 offset:24576
v_mfma_f32_16x16x32_bf16 v[92:95], a[140:143], v[148:151], v[92:95]
ds_read_b64_tr_b16 a[138:139], v194 offset:28672
s_waitcnt lgkmcnt(6)
v_mfma_f32_16x16x32_bf16 v[96:99], a[144:147], v[144:147], v[96:99]
ds_read_b64_tr_b16 a[140:141], v195 offset:24576
v_mfma_f32_16x16x32_bf16 v[100:103], a[144:147], v[148:151], v[100:103]
ds_read_b64_tr_b16 a[142:143], v195 offset:28672
v_mfma_f32_16x16x32_bf16 v[104:107], a[148:151], v[144:147], v[104:107]
buffer_load_dwordx4 a[200:203], v30, s[24:27], s56 offen offset:0 sc1
ds_read_b64_tr_b16 a[144:145], v196 offset:24576
v_mfma_f32_16x16x32_bf16 v[108:111], a[148:151], v[148:151], v[108:111]
ds_read_b64_tr_b16 a[146:147], v196 offset:28672
v_mfma_f32_16x16x32_bf16 v[112:115], a[152:155], v[144:147], v[112:115]
ds_read_b64_tr_b16 a[148:149], v197 offset:24576
v_mfma_f32_16x16x32_bf16 v[116:119], a[152:155], v[148:151], v[116:119]
ds_read_b64_tr_b16 a[150:151], v197 offset:28672
v_mfma_f32_16x16x32_bf16 v[120:123], a[156:159], v[144:147], v[120:123]
buffer_load_dwordx4 a[204:207], v30, s[24:27], s56 offen offset:1024 sc1
ds_read_b64_tr_b16 a[152:153], v198 offset:24576
v_mfma_f32_16x16x32_bf16 v[124:127], a[156:159], v[148:151], v[124:127]
ds_read_b64_tr_b16 a[154:155], v198 offset:28672
s_waitcnt lgkmcnt(6)
v_mfma_f32_16x16x32_bf16 v[64:67], a[128:131], v[152:155], v[64:67]
ds_read_b64_tr_b16 a[156:157], v199 offset:24576
v_mfma_f32_16x16x32_bf16 v[68:71], a[128:131], v[156:159], v[68:71]
ds_read_b64_tr_b16 a[158:159], v199 offset:28672
v_mfma_f32_16x16x32_bf16 v[72:75], a[132:135], v[152:155], v[72:75]
s_barrier
s_add_u32 m0, s37, 131072
s_add_u32 s57, s65, 131072
buffer_load_dwordx4 v3, s[20:23], s57 offen offset:0 lds
ds_read_b64_tr_b16 a[128:129], v20 offset:0
v_mfma_f32_16x16x32_bf16 v[76:79], a[132:135], v[156:159], v[76:79]
ds_read_b64_tr_b16 a[130:131], v20 offset:4096
v_mfma_f32_16x16x32_bf16 v[80:83], a[136:139], v[152:155], v[80:83]
ds_read_b64_tr_b16 a[132:133], v21 offset:0
v_mfma_f32_16x16x32_bf16 v[84:87], a[136:139], v[156:159], v[84:87]
ds_read_b64_tr_b16 a[134:135], v21 offset:4096
v_mfma_f32_16x16x32_bf16 v[88:91], a[140:143], v[152:155], v[88:91]
buffer_load_dwordx4 v4, s[20:23], s57 offen offset:1024 lds
ds_read_b64_tr_b16 a[136:137], v22 offset:0
v_mfma_f32_16x16x32_bf16 v[92:95], a[140:143], v[156:159], v[92:95]
ds_read_b64_tr_b16 a[138:139], v22 offset:4096
s_waitcnt lgkmcnt(6)
v_mfma_f32_16x16x32_bf16 v[96:99], a[144:147], v[152:155], v[96:99]
ds_read_b64_tr_b16 a[140:141], v23 offset:0
v_mfma_f32_16x16x32_bf16 v[100:103], a[144:147], v[156:159], v[100:103]
ds_read_b64_tr_b16 a[142:143], v23 offset:4096
v_mfma_f32_16x16x32_bf16 v[104:107], a[148:151], v[152:155], v[104:107]
buffer_load_dwordx4 v5, s[20:23], s57 offen offset:2048 lds
ds_read_b64_tr_b16 a[144:145], v24 offset:0
v_mfma_f32_16x16x32_bf16 v[108:111], a[148:151], v[156:159], v[108:111]
ds_read_b64_tr_b16 a[146:147], v24 offset:4096
v_mfma_f32_16x16x32_bf16 v[112:115], a[152:155], v[152:155], v[112:115]
ds_read_b64_tr_b16 a[148:149], v25 offset:0
v_mfma_f32_16x16x32_bf16 v[116:119], a[152:155], v[156:159], v[116:119]
ds_read_b64_tr_b16 a[150:151], v25 offset:4096
v_mfma_f32_16x16x32_bf16 v[120:123], a[156:159], v[152:155], v[120:123]
s_waitcnt vmcnt(11)
buffer_load_dwordx4 v6, s[20:23], s57 offen offset:3072 lds
ds_read_b64_tr_b16 a[152:153], v26 offset:0
v_mfma_f32_16x16x32_bf16 v[124:127], a[156:159], v[156:159], v[124:127]
ds_read_b64_tr_b16 a[154:155], v26 offset:4096
s_waitcnt lgkmcnt(6)
v_mfma_f32_16x16x32_bf16 v[64:67], a[128:131], a[160:163], v[64:67]
ds_read_b64_tr_b16 a[156:157], v27 offset:0
v_mfma_f32_16x16x32_bf16 v[68:71], a[128:131], a[164:167], v[68:71]
ds_read_b64_tr_b16 a[158:159], v27 offset:4096
v_mfma_f32_16x16x32_bf16 v[72:75], a[132:135], a[160:163], v[72:75]
s_add_u32 s56, s70, 16384
buffer_load_dwordx4 a[208:211], v40, s[24:27], s56 offen offset:0 sc1
ds_read_b64_tr_b16 a[128:129], v20 offset:8192
v_mfma_f32_16x16x32_bf16 v[76:79], a[132:135], a[164:167], v[76:79]
ds_read_b64_tr_b16 a[130:131], v20 offset:12288
v_mfma_f32_16x16x32_bf16 v[80:83], a[136:139], a[160:163], v[80:83]
ds_read_b64_tr_b16 a[132:133], v21 offset:8192
v_mfma_f32_16x16x32_bf16 v[84:87], a[136:139], a[164:167], v[84:87]
ds_read_b64_tr_b16 a[134:135], v21 offset:12288
v_mfma_f32_16x16x32_bf16 v[88:91], a[140:143], a[160:163], v[88:91]
buffer_load_dwordx4 a[212:215], v40, s[24:27], s56 offen offset:1024 sc1
ds_read_b64_tr_b16 a[136:137], v22 offset:8192
v_mfma_f32_16x16x32_bf16 v[92:95], a[140:143], a[164:167], v[92:95]
ds_read_b64_tr_b16 a[138:139], v22 offset:12288
s_waitcnt lgkmcnt(6)
v_mfma_f32_16x16x32_bf16 v[96:99], a[144:147], a[160:163], v[96:99]
ds_read_b64_tr_b16 a[140:141], v23 offset:8192
v_mfma_f32_16x16x32_bf16 v[100:103], a[144:147], a[164:167], v[100:103]
ds_read_b64_tr_b16 a[142:143], v23 offset:12288
v_mfma_f32_16x16x32_bf16 v[104:107], a[148:151], a[160:163], v[104:107]
buffer_load_dwordx4 a[216:219], v30, s[24:27], s56 offen offset:0 sc1
ds_read_b64_tr_b16 a[144:145], v24 offset:8192
v_mfma_f32_16x16x32_bf16 v[108:111], a[148:151], a[164:167], v[108:111]
ds_read_b64_tr_b16 a[146:147], v24 offset:12288
v_mfma_f32_16x16x32_bf16 v[112:115], a[152:155], a[160:163], v[112:115]
ds_read_b64_tr_b16 a[148:149], v25 offset:8192
v_mfma_f32_16x16x32_bf16 v[116:119], a[152:155], a[164:167], v[116:119]
ds_read_b64_tr_b16 a[150:151], v25 offset:12288
v_mfma_f32_16x16x32_bf16 v[120:123], a[156:159], a[160:163], v[120:123]
buffer_load_dwordx4 a[220:223], v30, s[24:27], s56 offen offset:1024 sc1
ds_read_b64_tr_b16 a[152:153], v26 offset:8192
v_mfma_f32_16x16x32_bf16 v[124:127], a[156:159], a[164:167], v[124:127]
ds_read_b64_tr_b16 a[154:155], v26 offset:12288
s_waitcnt lgkmcnt(6)
v_mfma_f32_16x16x32_bf16 v[64:67], a[128:131], a[168:171], v[64:67]
ds_read_b64_tr_b16 a[156:157], v27 offset:8192
v_mfma_f32_16x16x32_bf16 v[68:71], a[128:131], a[172:175], v[68:71]
ds_read_b64_tr_b16 a[158:159], v27 offset:12288
v_mfma_f32_16x16x32_bf16 v[72:75], a[132:135], a[168:171], v[72:75]
s_add_u32 m0, s37, 147456
s_add_u32 s57, s65, 196608
buffer_load_dwordx4 v3, s[20:23], s57 offen offset:0 lds
ds_read_b64_tr_b16 a[128:129], v192 offset:32768
v_mfma_f32_16x16x32_bf16 v[76:79], a[132:135], a[172:175], v[76:79]
ds_read_b64_tr_b16 a[130:131], v192 offset:36864
v_mfma_f32_16x16x32_bf16 v[80:83], a[136:139], a[168:171], v[80:83]
ds_read_b64_tr_b16 a[132:133], v193 offset:32768
v_mfma_f32_16x16x32_bf16 v[84:87], a[136:139], a[172:175], v[84:87]
ds_read_b64_tr_b16 a[134:135], v193 offset:36864
v_mfma_f32_16x16x32_bf16 v[88:91], a[140:143], a[168:171], v[88:91]
buffer_load_dwordx4 v4, s[20:23], s57 offen offset:1024 lds
ds_read_b64_tr_b16 a[136:137], v194 offset:32768
v_mfma_f32_16x16x32_bf16 v[92:95], a[140:143], a[172:175], v[92:95]
ds_read_b64_tr_b16 a[138:139], v194 offset:36864
s_waitcnt lgkmcnt(6)
v_mfma_f32_16x16x32_bf16 v[96:99], a[144:147], a[168:171], v[96:99]
ds_read_b64_tr_b16 a[140:141], v195 offset:32768
v_mfma_f32_16x16x32_bf16 v[100:103], a[144:147], a[172:175], v[100:103]
ds_read_b64_tr_b16 a[142:143], v195 offset:36864
v_mfma_f32_16x16x32_bf16 v[104:107], a[148:151], a[168:171], v[104:107]
buffer_load_dwordx4 v5, s[20:23], s57 offen offset:2048 lds
ds_read_b64_tr_b16 a[144:145], v196 offset:32768
v_mfma_f32_16x16x32_bf16 v[108:111], a[148:151], a[172:175], v[108:111]
ds_read_b64_tr_b16 a[146:147], v196 offset:36864
v_mfma_f32_16x16x32_bf16 v[112:115], a[152:155], a[168:171], v[112:115]
ds_read_b64_tr_b16 a[148:149], v197 offset:32768
v_mfma_f32_16x16x32_bf16 v[116:119], a[152:155], a[172:175], v[116:119]
ds_read_b64_tr_b16 a[150:151], v197 offset:36864
v_mfma_f32_16x16x32_bf16 v[120:123], a[156:159], a[168:171], v[120:123]
s_waitcnt vmcnt(15)
buffer_load_dwordx4 v6, s[20:23], s57 offen offset:3072 lds
ds_read_b64_tr_b16 a[152:153], v198 offset:32768
v_mfma_f32_16x16x32_bf16 v[124:127], a[156:159], a[172:175], v[124:127]
ds_read_b64_tr_b16 a[154:155], v198 offset:36864
s_waitcnt lgkmcnt(6)
v_mfma_f32_16x16x32_bf16 v[64:67], a[128:131], a[176:179], v[64:67]
ds_read_b64_tr_b16 a[156:157], v199 offset:32768
v_mfma_f32_16x16x32_bf16 v[68:71], a[128:131], a[180:183], v[68:71]
ds_read_b64_tr_b16 a[158:159], v199 offset:36864
v_mfma_f32_16x16x32_bf16 v[72:75], a[132:135], a[176:179], v[72:75]
s_add_u32 s56, s71, 0
buffer_load_dwordx4 a[160:163], v40, s[24:27], s56 offen offset:0 sc1
ds_read_b64_tr_b16 a[128:129], v192 offset:40960
v_mfma_f32_16x16x32_bf16 v[76:79], a[132:135], a[180:183], v[76:79]
ds_read_b64_tr_b16 a[130:131], v192 offset:45056
v_mfma_f32_16x16x32_bf16 v[80:83], a[136:139], a[176:179], v[80:83]
ds_read_b64_tr_b16 a[132:133], v193 offset:40960
v_mfma_f32_16x16x32_bf16 v[84:87], a[136:139], a[180:183], v[84:87]
ds_read_b64_tr_b16 a[134:135], v193 offset:45056
v_mfma_f32_16x16x32_bf16 v[88:91], a[140:143], a[176:179], v[88:91]
buffer_load_dwordx4 a[164:167], v40, s[24:27], s56 offen offset:1024 sc1
ds_read_b64_tr_b16 a[136:137], v194 offset:40960
v_mfma_f32_16x16x32_bf16 v[92:95], a[140:143], a[180:183], v[92:95]
ds_read_b64_tr_b16 a[138:139], v194 offset:45056
s_waitcnt lgkmcnt(6)
v_mfma_f32_16x16x32_bf16 v[96:99], a[144:147], a[176:179], v[96:99]
ds_read_b64_tr_b16 a[140:141], v195 offset:40960
v_mfma_f32_16x16x32_bf16 v[100:103], a[144:147], a[180:183], v[100:103]
ds_read_b64_tr_b16 a[142:143], v195 offset:45056
v_mfma_f32_16x16x32_bf16 v[104:107], a[148:151], a[176:179], v[104:107]
buffer_load_dwordx4 a[168:171], v30, s[24:27], s56 offen offset:0 sc1
ds_read_b64_tr_b16 a[144:145], v196 offset:40960
v_mfma_f32_16x16x32_bf16 v[108:111], a[148:151], a[180:183], v[108:111]
ds_read_b64_tr_b16 a[146:147], v196 offset:45056
v_mfma_f32_16x16x32_bf16 v[112:115], a[152:155], a[176:179], v[112:115]
ds_read_b64_tr_b16 a[148:149], v197 offset:40960
v_mfma_f32_16x16x32_bf16 v[116:119], a[152:155], a[180:183], v[116:119]
ds_read_b64_tr_b16 a[150:151], v197 offset:45056
v_mfma_f32_16x16x32_bf16 v[120:123], a[156:159], a[176:179], v[120:123]
buffer_load_dwordx4 a[172:175], v30, s[24:27], s56 offen offset:1024 sc1
ds_read_b64_tr_b16 a[152:153], v198 offset:40960
v_mfma_f32_16x16x32_bf16 v[124:127], a[156:159], a[180:183], v[124:127]
ds_read_b64_tr_b16 a[154:155], v198 offset:45056
s_waitcnt lgkmcnt(6)
v_mfma_f32_16x16x32_bf16 v[64:67], a[128:131], a[184:187], v[64:67]
buffer_load_dword v29, v13, s[24:27], s85 offen sc1
ds_read_b64_tr_b16 a[156:157], v199 offset:40960
v_mfma_f32_16x16x32_bf16 v[68:71], a[128:131], a[188:191], v[68:71]
ds_read_b64_tr_b16 a[158:159], v199 offset:45056
v_mfma_f32_16x16x32_bf16 v[72:75], a[132:135], a[184:187], v[72:75]
s_add_u32 m0, s37, 0
s_add_u32 s57, s66, 131072
buffer_load_dwordx4 v3, s[20:23], s57 offen offset:0 lds
ds_read_b64_tr_b16 a[128:129], v20 offset:16384
v_mfma_f32_16x16x32_bf16 v[76:79], a[132:135], a[188:191], v[76:79]
ds_read_b64_tr_b16 a[130:131], v20 offset:20480
v_mfma_f32_16x16x32_bf16 v[80:83], a[136:139], a[184:187], v[80:83]
ds_read_b64_tr_b16 a[132:133], v21 offset:16384
v_mfma_f32_16x16x32_bf16 v[84:87], a[136:139], a[188:191], v[84:87]
ds_read_b64_tr_b16 a[134:135], v21 offset:20480
v_mfma_f32_16x16x32_bf16 v[88:91], a[140:143], a[184:187], v[88:91]
buffer_load_dwordx4 v4, s[20:23], s57 offen offset:1024 lds
ds_read_b64_tr_b16 a[136:137], v22 offset:16384
v_mfma_f32_16x16x32_bf16 v[92:95], a[140:143], a[188:191], v[92:95]
ds_read_b64_tr_b16 a[138:139], v22 offset:20480
s_waitcnt lgkmcnt(6)
v_mfma_f32_16x16x32_bf16 v[96:99], a[144:147], a[184:187], v[96:99]
ds_read_b64_tr_b16 a[140:141], v23 offset:16384
v_mfma_f32_16x16x32_bf16 v[100:103], a[144:147], a[188:191], v[100:103]
ds_read_b64_tr_b16 a[142:143], v23 offset:20480
v_mfma_f32_16x16x32_bf16 v[104:107], a[148:151], a[184:187], v[104:107]
buffer_load_dwordx4 v5, s[20:23], s57 offen offset:2048 lds
ds_read_b64_tr_b16 a[144:145], v24 offset:16384
v_mfma_f32_16x16x32_bf16 v[108:111], a[148:151], a[188:191], v[108:111]
ds_read_b64_tr_b16 a[146:147], v24 offset:20480
v_mfma_f32_16x16x32_bf16 v[112:115], a[152:155], a[184:187], v[112:115]
ds_read_b64_tr_b16 a[148:149], v25 offset:16384
v_mfma_f32_16x16x32_bf16 v[116:119], a[152:155], a[188:191], v[116:119]
ds_read_b64_tr_b16 a[150:151], v25 offset:20480
v_mfma_f32_16x16x32_bf16 v[120:123], a[156:159], a[184:187], v[120:123]
s_waitcnt vmcnt(20)
buffer_load_dwordx4 v6, s[20:23], s57 offen offset:3072 lds
ds_read_b64_tr_b16 a[152:153], v26 offset:16384
v_mfma_f32_16x16x32_bf16 v[124:127], a[156:159], a[188:191], v[124:127]
ds_read_b64_tr_b16 a[154:155], v26 offset:20480
s_waitcnt lgkmcnt(6)
v_mfma_f32_16x16x32_bf16 v[64:67], a[128:131], a[192:195], v[64:67]
ds_read_b64_tr_b16 a[156:157], v27 offset:16384
v_mfma_f32_16x16x32_bf16 v[68:71], a[128:131], a[196:199], v[68:71]
ds_read_b64_tr_b16 a[158:159], v27 offset:20480
v_mfma_f32_16x16x32_bf16 v[72:75], a[132:135], a[192:195], v[72:75]
s_add_u32 s56, s71, 16384
buffer_load_dwordx4 a[176:179], v40, s[24:27], s56 offen offset:0 sc1
ds_read_b64_tr_b16 a[128:129], v20 offset:24576
v_mfma_f32_16x16x32_bf16 v[76:79], a[132:135], a[196:199], v[76:79]
ds_read_b64_tr_b16 a[130:131], v20 offset:28672
v_mfma_f32_16x16x32_bf16 v[80:83], a[136:139], a[192:195], v[80:83]
ds_read_b64_tr_b16 a[132:133], v21 offset:24576
v_mfma_f32_16x16x32_bf16 v[84:87], a[136:139], a[196:199], v[84:87]
ds_read_b64_tr_b16 a[134:135], v21 offset:28672
v_mfma_f32_16x16x32_bf16 v[88:91], a[140:143], a[192:195], v[88:91]
buffer_load_dwordx4 a[180:183], v40, s[24:27], s56 offen offset:1024 sc1
ds_read_b64_tr_b16 a[136:137], v22 offset:24576
v_mfma_f32_16x16x32_bf16 v[92:95], a[140:143], a[196:199], v[92:95]
ds_read_b64_tr_b16 a[138:139], v22 offset:28672
s_waitcnt lgkmcnt(6)
v_mfma_f32_16x16x32_bf16 v[96:99], a[144:147], a[192:195], v[96:99]
ds_read_b64_tr_b16 a[140:141], v23 offset:24576
v_mfma_f32_16x16x32_bf16 v[100:103], a[144:147], a[196:199], v[100:103]
ds_read_b64_tr_b16 a[142:143], v23 offset:28672
v_mfma_f32_16x16x32_bf16 v[104:107], a[148:151], a[192:195], v[104:107]
buffer_load_dwordx4 a[184:187], v30, s[24:27], s56 offen offset:0 sc1
ds_read_b64_tr_b16 a[144:145], v24 offset:24576
v_mfma_f32_16x16x32_bf16 v[108:111], a[148:151], a[196:199], v[108:111]
ds_read_b64_tr_b16 a[146:147], v24 offset:28672
v_mfma_f32_16x16x32_bf16 v[112:115], a[152:155], a[192:195], v[112:115]
ds_read_b64_tr_b16 a[148:149], v25 offset:24576
v_mfma_f32_16x16x32_bf16 v[116:119], a[152:155], a[196:199], v[116:119]
ds_read_b64_tr_b16 a[150:151], v25 offset:28672
v_mfma_f32_16x16x32_bf16 v[120:123], a[156:159], a[192:195], v[120:123]
buffer_load_dwordx4 a[188:191], v30, s[24:27], s56 offen offset:1024 sc1
ds_read_b64_tr_b16 a[152:153], v26 offset:24576
v_mfma_f32_16x16x32_bf16 v[124:127], a[156:159], a[196:199], v[124:127]
ds_read_b64_tr_b16 a[154:155], v26 offset:28672
s_waitcnt lgkmcnt(6)
v_mfma_f32_16x16x32_bf16 v[64:67], a[128:131], a[200:203], v[64:67]
ds_read_b64_tr_b16 a[156:157], v27 offset:24576
v_mfma_f32_16x16x32_bf16 v[68:71], a[128:131], a[204:207], v[68:71]
ds_read_b64_tr_b16 a[158:159], v27 offset:28672
v_mfma_f32_16x16x32_bf16 v[72:75], a[132:135], a[200:203], v[72:75]
s_barrier
s_add_u32 m0, s37, 16384
s_add_u32 s57, s66, 196608
buffer_load_dwordx4 v3, s[20:23], s57 offen offset:0 lds
ds_read_b64_tr_b16 a[128:129], v192 offset:49152
v_mfma_f32_16x16x32_bf16 v[76:79], a[132:135], a[204:207], v[76:79]
ds_read_b64_tr_b16 a[130:131], v192 offset:53248
v_mfma_f32_16x16x32_bf16 v[80:83], a[136:139], a[200:203], v[80:83]
ds_read_b64_tr_b16 a[132:133], v193 offset:49152
v_mfma_f32_16x16x32_bf16 v[84:87], a[136:139], a[204:207], v[84:87]
ds_read_b64_tr_b16 a[134:135], v193 offset:53248
v_mfma_f32_16x16x32_bf16 v[88:91], a[140:143], a[200:203], v[88:91]
buffer_load_dwordx4 v4, s[20:23], s57 offen offset:1024 lds
ds_read_b64_tr_b16 a[136:137], v194 offset:49152
v_mfma_f32_16x16x32_bf16 v[92:95], a[140:143], a[204:207], v[92:95]
ds_read_b64_tr_b16 a[138:139], v194 offset:53248
s_waitcnt lgkmcnt(6)
v_mfma_f32_16x16x32_bf16 v[96:99], a[144:147], a[200:203], v[96:99]
ds_read_b64_tr_b16 a[140:141], v195 offset:49152
v_mfma_f32_16x16x32_bf16 v[100:103], a[144:147], a[204:207], v[100:103]
ds_read_b64_tr_b16 a[142:143], v195 offset:53248
v_mfma_f32_16x16x32_bf16 v[104:107], a[148:151], a[200:203], v[104:107]
buffer_load_dwordx4 v5, s[20:23], s57 offen offset:2048 lds
ds_read_b64_tr_b16 a[144:145], v196 offset:49152
v_mfma_f32_16x16x32_bf16 v[108:111], a[148:151], a[204:207], v[108:111]
ds_read_b64_tr_b16 a[146:147], v196 offset:53248
v_mfma_f32_16x16x32_bf16 v[112:115], a[152:155], a[200:203], v[112:115]
ds_read_b64_tr_b16 a[148:149], v197 offset:49152
v_mfma_f32_16x16x32_bf16 v[116:119], a[152:155], a[204:207], v[116:119]
ds_read_b64_tr_b16 a[150:151], v197 offset:53248
v_mfma_f32_16x16x32_bf16 v[120:123], a[156:159], a[200:203], v[120:123]
s_waitcnt vmcnt(20)
buffer_load_dwordx4 v6, s[20:23], s57 offen offset:3072 lds
ds_read_b64_tr_b16 a[152:153], v198 offset:49152
v_mfma_f32_16x16x32_bf16 v[124:127], a[156:159], a[204:207], v[124:127]
ds_read_b64_tr_b16 a[154:155], v198 offset:53248
s_waitcnt lgkmcnt(6)
v_mfma_f32_16x16x32_bf16 v[64:67], a[128:131], a[208:211], v[64:67]
ds_read_b64_tr_b16 a[156:157], v199 offset:49152
v_mfma_f32_16x16x32_bf16 v[68:71], a[128:131], a[212:215], v[68:71]
ds_read_b64_tr_b16 a[158:159], v199 offset:53248
v_mfma_f32_16x16x32_bf16 v[72:75], a[132:135], a[208:211], v[72:75]
s_waitcnt vmcnt(12)
s_mov_b32 s87, 0x40000
L_c2:
v_cmp_ne_u32 vcc, v12, v29
s_cbranch_vccz L_c2_ok
s_sub_u32 s87, s87, 1
s_cbranch_scc1 L_c2_ok
buffer_load_dword v29, v13, s[24:27], s85 offen sc1
s_waitcnt vmcnt(0)
s_branch L_c2
L_c2_ok:
s_add_u32 s56, s69, 32768
buffer_load_dwordx4 a[192:195], v40, s[24:27], s56 offen offset:0 sc1
ds_read_b64_tr_b16 a[128:129], v192 offset:57344
v_mfma_f32_16x16x32_bf16 v[76:79], a[132:135], a[212:215], v[76:79]
ds_read_b64_tr_b16 a[130:131], v192 offset:61440
v_mfma_f32_16x16x32_bf16 v[80:83], a[136:139], a[208:211], v[80:83]
ds_read_b64_tr_b16 a[132:133], v193 offset:57344
v_mfma_f32_16x16x32_bf16 v[84:87], a[136:139], a[212:215], v[84:87]
ds_read_b64_tr_b16 a[134:135], v193 offset:61440
v_mfma_f32_16x16x32_bf16 v[88:91], a[140:143], a[208:211], v[88:91]
buffer_load_dwordx4 a[196:199], v40, s[24:27], s56 offen offset:1024 sc1
ds_read_b64_tr_b16 a[136:137], v194 offset:57344
v_mfma_f32_16x16x32_bf16 v[92:95], a[140:143], a[212:215], v[92:95]
ds_read_b64_tr_b16 a[138:139], v194 offset:61440
s_waitcnt lgkmcnt(6)
v_mfma_f32_16x16x32_bf16 v[96:99], a[144:147], a[208:211], v[96:99]
ds_read_b64_tr_b16 a[140:141], v195 offset:57344
v_mfma_f32_16x16x32_bf16 v[100:103], a[144:147], a[212:215], v[100:103]
ds_read_b64_tr_b16 a[142:143], v195 offset:61440
v_mfma_f32_16x16x32_bf16 v[104:107], a[148:151], a[208:211], v[104:107]
buffer_load_dwordx4 a[200:203], v30, s[24:27], s56 offen offset:0 sc1
ds_read_b64_tr_b16 a[144:145], v196 offset:57344
v_mfma_f32_16x16x32_bf16 v[108:111], a[148:151], a[212:215], v[108:111]
ds_read_b64_tr_b16 a[146:147], v196 offset:61440
v_mfma_f32_16x16x32_bf16 v[112:115], a[152:155], a[208:211], v[112:115]
ds_read_b64_tr_b16 a[148:149], v197 offset:57344
v_mfma_f32_16x16x32_bf16 v[116:119], a[152:155], a[212:215], v[116:119]
ds_read_b64_tr_b16 a[150:151], v197 offset:61440
v_mfma_f32_16x16x32_bf16 v[120:123], a[156:159], a[208:211], v[120:123]
buffer_load_dwordx4 a[204:207], v30, s[24:27], s56 offen offset:1024 sc1
ds_read_b64_tr_b16 a[152:153], v198 offset:57344
v_mfma_f32_16x16x32_bf16 v[124:127], a[156:159], a[212:215], v[124:127]
ds_read_b64_tr_b16 a[154:155], v198 offset:61440
s_waitcnt lgkmcnt(6)
v_mfma_f32_16x16x32_bf16 v[64:67], a[128:131], a[216:219], v[64:67]
ds_read_b64_tr_b16 a[156:157], v199 offset:57344
v_mfma_f32_16x16x32_bf16 v[68:71], a[128:131], a[220:223], v[68:71]
ds_read_b64_tr_b16 a[158:159], v199 offset:61440
v_mfma_f32_16x16x32_bf16 v[72:75], a[132:135], a[216:219], v[72:75]
s_add_u32 m0, s37, 65536
s_add_u32 s57, s67, 131072
buffer_load_dwordx4 v3, s[20:23], s57 offen offset:0 lds
ds_read_b64_tr_b16 a[128:129], v20 offset:32768
v_mfma_f32_16x16x32_bf16 v[76:79], a[132:135], a[220:223], v[76:79]
ds_read_b64_tr_b16 a[130:131], v20 offset:36864
v_mfma_f32_16x16x32_bf16 v[80:83], a[136:139], a[216:219], v[80:83]
ds_read_b64_tr_b16 a[132:133], v21 offset:32768
v_mfma_f32_16x16x32_bf16 v[84:87], a[136:139], a[220:223], v[84:87]
ds_read_b64_tr_b16 a[134:135], v21 offset:36864
v_mfma_f32_16x16x32_bf16 v[88:91], a[140:143], a[216:219], v[88:91]
buffer_load_dwordx4 v4, s[20:23], s57 offen offset:1024 lds
ds_read_b64_tr_b16 a[136:137], v22 offset:32768
v_mfma_f32_16x16x32_bf16 v[92:95], a[140:143], a[220:223], v[92:95]
ds_read_b64_tr_b16 a[138:139], v22 offset:36864
s_waitcnt lgkmcnt(6)
v_mfma_f32_16x16x32_bf16 v[96:99], a[144:147], a[216:219], v[96:99]
ds_read_b64_tr_b16 a[140:141], v23 offset:32768
v_mfma_f32_16x16x32_bf16 v[100:103], a[144:147], a[220:223], v[100:103]
ds_read_b64_tr_b16 a[142:143], v23 offset:36864
v_mfma_f32_16x16x32_bf16 v[104:107], a[148:151], a[216:219], v[104:107]
buffer_load_dwordx4 v5, s[20:23], s57 offen offset:2048 lds
ds_read_b64_tr_b16 a[144:145], v24 offset:32768
v_mfma_f32_16x16x32_bf16 v[108:111], a[148:151], a[220:223], v[108:111]
ds_read_b64_tr_b16 a[146:147], v24 offset:36864
v_mfma_f32_16x16x32_bf16 v[112:115], a[152:155], a[216:219], v[112:115]
ds_read_b64_tr_b16 a[148:149], v25 offset:32768
v_mfma_f32_16x16x32_bf16 v[116:119], a[152:155], a[220:223], v[116:119]
ds_read_b64_tr_b16 a[150:151], v25 offset:36864
v_mfma_f32_16x16x32_bf16 v[120:123], a[156:159], a[216:219], v[120:123]
s_waitcnt vmcnt(20)
buffer_load_dwordx4 v6, s[20:23], s57 offen offset:3072 lds
ds_read_b64_tr_b16 a[152:153], v26 offset:32768
v_mfma_f32_16x16x32_bf16 v[124:127], a[156:159], a[220:223], v[124:127]
ds_read_b64_tr_b16 a[154:155], v26 offset:36864
s_waitcnt lgkmcnt(6)
v_mfma_f32_16x16x32_bf16 v[64:67], a[128:131], a[160:163], v[64:67]
ds_read_b64_tr_b16 a[156:157], v27 offset:32768
v_mfma_f32_16x16x32_bf16 v[68:71], a[128:131], a[164:167], v[68:71]
ds_read_b64_tr_b16 a[158:159], v27 offset:36864
v_mfma_f32_16x16x32_bf16 v[72:75], a[132:135], a[160:163], v[72:75]
s_add_u32 s56, s69, 49152
buffer_load_dwordx4 a[208:211], v40, s[24:27], s56 offen offset:0 sc1
ds_read_b64_tr_b16 a[128:129], v20 offset:40960
v_mfma_f32_16x16x32_bf16 v[76:79], a[132:135], a[164:167], v[76:79]
ds_read_b64_tr_b16 a[130:131], v20 offset:45056
v_mfma_f32_16x16x32_bf16 v[80:83], a[136:139], a[160:163], v[80:83]
ds_read_b64_tr_b16 a[132:133], v21 offset:40960
v_mfma_f32_16x16x32_bf16 v[84:87], a[136:139], a[164:167], v[84:87]
ds_read_b64_tr_b16 a[134:135], v21 offset:45056
v_mfma_f32_16x16x32_bf16 v[88:91], a[140:143], a[160:163], v[88:91]
buffer_load_dwordx4 a[212:215], v40, s[24:27], s56 offen offset:1024 sc1
ds_read_b64_tr_b16 a[136:137], v22 offset:40960
v_mfma_f32_16x16x32_bf16 v[92:95], a[140:143], a[164:167], v[92:95]
ds_read_b64_tr_b16 a[138:139], v22 offset:45056
s_waitcnt lgkmcnt(6)
v_mfma_f32_16x16x32_bf16 v[96:99], a[144:147], a[160:163], v[96:99]
ds_read_b64_tr_b16 a[140:141], v23 offset:40960
v_mfma_f32_16x16x32_bf16 v[100:103], a[144:147], a[164:167], v[100:103]
ds_read_b64_tr_b16 a[142:143], v23 offset:45056
v_mfma_f32_16x16x32_bf16 v[104:107], a[148:151], a[160:163], v[104:107]
buffer_load_dwordx4 a[216:219], v30, s[24:27], s56 offen offset:0 sc1
ds_read_b64_tr_b16 a[144:145], v24 offset:40960
v_mfma_f32_16x16x32_bf16 v[108:111], a[148:151], a[164:167], v[108:111]
ds_read_b64_tr_b16 a[146:147], v24 offset:45056
v_mfma_f32_16x16x32_bf16 v[112:115], a[152:155], a[160:163], v[112:115]
ds_read_b64_tr_b16 a[148:149], v25 offset:40960
v_mfma_f32_16x16x32_bf16 v[116:119], a[152:155], a[164:167], v[116:119]
ds_read_b64_tr_b16 a[150:151], v25 offset:45056
v_mfma_f32_16x16x32_bf16 v[120:123], a[156:159], a[160:163], v[120:123]
buffer_load_dwordx4 a[220:223], v30, s[24:27], s56 offen offset:1024 sc1
ds_read_b64_tr_b16 a[152:153], v26 offset:40960
v_mfma_f32_16x16x32_bf16 v[124:127], a[156:159], a[164:167], v[124:127]
ds_read_b64_tr_b16 a[154:155], v26 offset:45056
s_waitcnt lgkmcnt(6)
v_mfma_f32_16x16x32_bf16 v[64:67], a[128:131], a[168:171], v[64:67]
ds_read_b64_tr_b16 a[156:157], v27 offset:40960
v_mfma_f32_16x16x32_bf16 v[68:71], a[128:131], a[172:175], v[68:71]
ds_read_b64_tr_b16 a[158:159], v27 offset:45056
v_mfma_f32_16x16x32_bf16 v[72:75], a[132:135], a[168:171], v[72:75]
s_waitcnt vmcnt(20)
s_barrier
s_add_u32 m0, s37, 32768
s_add_u32 s57, s67, 196608
buffer_load_dwordx4 v3, s[20:23], s57 offen offset:0 lds
ds_read_b64_tr_b16 a[128:129], v20 offset:49152
v_mfma_f32_16x16x32_bf16 v[76:79], a[132:135], a[172:175], v[76:79]
ds_read_b64_tr_b16 a[130:131], v20 offset:53248
v_mfma_f32_16x16x32_bf16 v[80:83], a[136:139], a[168:171], v[80:83]
ds_read_b64_tr_b16 a[132:133], v21 offset:49152
v_mfma_f32_16x16x32_bf16 v[84:87], a[136:139], a[172:175], v[84:87]
ds_read_b64_tr_b16 a[134:135], v21 offset:53248
v_mfma_f32_16x16x32_bf16 v[88:91], a[140:143], a[168:171], v[88:91]
buffer_load_dwordx4 v4, s[20:23], s57 offen offset:1024 lds
ds_read_b64_tr_b16 a[136:137], v22 offset:49152
v_mfma_f32_16x16x32_bf16 v[92:95], a[140:143], a[172:175], v[92:95]
ds_read_b64_tr_b16 a[138:139], v22 offset:53248
s_waitcnt lgkmcnt(6)
v_mfma_f32_16x16x32_bf16 v[96:99], a[144:147], a[168:171], v[96:99]
ds_read_b64_tr_b16 a[140:141], v23 offset:49152
v_mfma_f32_16x16x32_bf16 v[100:103], a[144:147], a[172:175], v[100:103]
ds_read_b64_tr_b16 a[142:143], v23 offset:53248
v_mfma_f32_16x16x32_bf16 v[104:107], a[148:151], a[168:171], v[104:107]
buffer_load_dwordx4 v5, s[20:23], s57 offen offset:2048 lds
ds_read_b64_tr_b16 a[144:145], v24 offset:49152
v_mfma_f32_16x16x32_bf16 v[108:111], a[148:151], a[172:175], v[108:111]
ds_read_b64_tr_b16 a[146:147], v24 offset:53248
v_mfma_f32_16x16x32_bf16 v[112:115], a[152:155], a[168:171], v[112:115]
ds_read_b64_tr_b16 a[148:149], v25 offset:49152
v_mfma_f32_16x16x32_bf16 v[116:119], a[152:155], a[172:175], v[116:119]
ds_read_b64_tr_b16 a[150:151], v25 offset:53248
v_mfma_f32_16x16x32_bf16 v[120:123], a[156:159], a[168:171], v[120:123]
s_waitcnt vmcnt(19)
buffer_load_dwordx4 v6, s[20:23], s57 offen offset:3072 lds
ds_read_b64_tr_b16 a[152:153], v26 offset:49152
v_mfma_f32_16x16x32_bf16 v[124:127], a[156:159], a[172:175], v[124:127]
ds_read_b64_tr_b16 a[154:155], v26 offset:53248
s_waitcnt lgkmcnt(6)
v_mfma_f32_16x16x32_bf16 v[64:67], a[128:131], a[176:179], v[64:67]
ds_read_b64_tr_b16 a[156:157], v27 offset:49152
v_mfma_f32_16x16x32_bf16 v[68:71], a[128:131], a[180:183], v[68:71]
ds_read_b64_tr_b16 a[158:159], v27 offset:53248
v_mfma_f32_16x16x32_bf16 v[72:75], a[132:135], a[176:179], v[72:75]
s_add_u32 s56, s70, 32768
buffer_load_dwordx4 a[160:163], v40, s[24:27], s56 offen offset:0 sc1
ds_read_b64_tr_b16 a[128:129], v20 offset:57344
v_mfma_f32_16x16x32_bf16 v[76:79], a[132:135], a[180:183], v[76:79]
ds_read_b64_tr_b16 a[130:131], v20 offset:61440
v_mfma_f32_16x16x32_bf16 v[80:83], a[136:139], a[176:179], v[80:83]
ds_read_b64_tr_b16 a[132:133], v21 offset:57344
v_mfma_f32_16x16x32_bf16 v[84:87], a[136:139], a[180:183], v[84:87]
ds_read_b64_tr_b16 a[134:135], v21 offset:61440
v_mfma_f32_16x16x32_bf16 v[88:91], a[140:143], a[176:179], v[88:91]
buffer_load_dwordx4 a[164:167], v40, s[24:27], s56 offen offset:1024 sc1
ds_read_b64_tr_b16 a[136:137], v22 offset:57344
v_mfma_f32_16x16x32_bf16 v[92:95], a[140:143], a[180:183], v[92:95]
ds_read_b64_tr_b16 a[138:139], v22 offset:61440
s_waitcnt lgkmcnt(6)
v_mfma_f32_16x16x32_bf16 v[96:99], a[144:147], a[176:179], v[96:99]
ds_read_b64_tr_b16 a[140:141], v23 offset:57344
v_mfma_f32_16x16x32_bf16 v[100:103], a[144:147], a[180:183], v[100:103]
ds_read_b64_tr_b16 a[142:143], v23 offset:61440
v_mfma_f32_16x16x32_bf16 v[104:107], a[148:151], a[176:179], v[104:107]
buffer_load_dwordx4 a[168:171], v30, s[24:27], s56 offen offset:0 sc1
ds_read_b64_tr_b16 a[144:145], v24 offset:57344
v_mfma_f32_16x16x32_bf16 v[108:111], a[148:151], a[180:183], v[108:111]
ds_read_b64_tr_b16 a[146:147], v24 offset:61440
v_mfma_f32_16x16x32_bf16 v[112:115], a[152:155], a[176:179], v[112:115]
ds_read_b64_tr_b16 a[148:149], v25 offset:57344
v_mfma_f32_16x16x32_bf16 v[116:119], a[152:155], a[180:183], v[116:119]
ds_read_b64_tr_b16 a[150:151], v25 offset:61440
v_mfma_f32_16x16x32_bf16 v[120:123], a[156:159], a[176:179], v[120:123]
buffer_load_dwordx4 a[172:175], v30, s[24:27], s56 offen offset:1024 sc1
ds_read_b64_tr_b16 a[152:153], v26 offset:57344
v_mfma_f32_16x16x32_bf16 v[124:127], a[156:159], a[180:183], v[124:127]
ds_read_b64_tr_b16 a[154:155], v26 offset:61440
s_waitcnt lgkmcnt(6)
v_mfma_f32_16x16x32_bf16 v[64:67], a[128:131], a[184:187], v[64:67]
ds_read_b64_tr_b16 a[156:157], v27 offset:57344
v_mfma_f32_16x16x32_bf16 v[68:71], a[128:131], a[188:191], v[68:71]
ds_read_b64_tr_b16 a[158:159], v27 offset:61440
v_mfma_f32_16x16x32_bf16 v[72:75], a[132:135], a[184:187], v[72:75]
ds_read_b64_tr_b16 a[128:129], v240 offset:0
v_mfma_f32_16x16x32_bf16 v[76:79], a[132:135], a[188:191], v[76:79]
ds_read_b64_tr_b16 a[130:131], v240 offset:4096
v_mfma_f32_16x16x32_bf16 v[80:83], a[136:139], a[184:187], v[80:83]
ds_read_b64_tr_b16 a[132:133], v241 offset:0
v_mfma_f32_16x16x32_bf16 v[84:87], a[136:139], a[188:191], v[84:87]
ds_read_b64_tr_b16 a[134:135], v241 offset:4096
v_mfma_f32_16x16x32_bf16 v[88:91], a[140:143], a[184:187], v[88:91]
ds_read_b64_tr_b16 a[136:137], v242 offset:0
v_mfma_f32_16x16x32_bf16 v[92:95], a[140:143], a[188:191], v[92:95]
ds_read_b64_tr_b16 a[138:139], v242 offset:4096
s_waitcnt lgkmcnt(6)
v_mfma_f32_16x16x32_bf16 v[96:99], a[144:147], a[184:187], v[96:99]
ds_read_b64_tr_b16 a[140:141], v243 offset:0
v_mfma_f32_16x16x32_bf16 v[100:103], a[144:147], a[188:191], v[100:103]
ds_read_b64_tr_b16 a[142:143], v243 offset:4096
v_mfma_f32_16x16x32_bf16 v[104:107], a[148:151], a[184:187], v[104:107]
ds_read_b64_tr_b16 a[144:145], v244 offset:0
v_mfma_f32_16x16x32_bf16 v[108:111], a[148:151], a[188:191], v[108:111]
ds_read_b64_tr_b16 a[146:147], v244 offset:4096
v_mfma_f32_16x16x32_bf16 v[112:115], a[152:155], a[184:187], v[112:115]
ds_read_b64_tr_b16 a[148:149], v245 offset:0
v_mfma_f32_16x16x32_bf16 v[116:119], a[152:155], a[188:191], v[116:119]
ds_read_b64_tr_b16 a[150:151], v245 offset:4096
v_mfma_f32_16x16x32_bf16 v[120:123], a[156:159], a[184:187], v[120:123]
s_waitcnt vmcnt(16)
ds_read_b64_tr_b16 a[152:153], v246 offset:0
v_mfma_f32_16x16x32_bf16 v[124:127], a[156:159], a[188:191], v[124:127]
ds_read_b64_tr_b16 a[154:155], v246 offset:4096
s_waitcnt lgkmcnt(6)
v_mfma_f32_16x16x32_bf16 v[64:67], a[128:131], a[192:195], v[64:67]
ds_read_b64_tr_b16 a[156:157], v247 offset:0
v_mfma_f32_16x16x32_bf16 v[68:71], a[128:131], a[196:199], v[68:71]
ds_read_b64_tr_b16 a[158:159], v247 offset:4096
v_mfma_f32_16x16x32_bf16 v[72:75], a[132:135], a[192:195], v[72:75]
s_add_u32 s56, s70, 49152
buffer_load_dwordx4 a[176:179], v40, s[24:27], s56 offen offset:0 sc1
ds_read_b64_tr_b16 a[128:129], v240 offset:8192
v_mfma_f32_16x16x32_bf16 v[76:79], a[132:135], a[196:199], v[76:79]
ds_read_b64_tr_b16 a[130:131], v240 offset:12288
v_mfma_f32_16x16x32_bf16 v[80:83], a[136:139], a[192:195], v[80:83]
ds_read_b64_tr_b16 a[132:133], v241 offset:8192
v_mfma_f32_16x16x32_bf16 v[84:87], a[136:139], a[196:199], v[84:87]
ds_read_b64_tr_b16 a[134:135], v241 offset:12288
v_mfma_f32_16x16x32_bf16 v[88:91], a[140:143], a[192:195], v[88:91]
buffer_load_dwordx4 a[180:183], v40, s[24:27], s56 offen offset:1024 sc1
ds_read_b64_tr_b16 a[136:137], v242 offset:8192
v_mfma_f32_16x16x32_bf16 v[92:95], a[140:143], a[196:199], v[92:95]
ds_read_b64_tr_b16 a[138:139], v242 offset:12288
s_waitcnt lgkmcnt(6)
v_mfma_f32_16x16x32_bf16 v[96:99], a[144:147], a[192:195], v[96:99]
ds_read_b64_tr_b16 a[140:141], v243 offset:8192
v_mfma_f32_16x16x32_bf16 v[100:103], a[144:147], a[196:199], v[100:103]
ds_read_b64_tr_b16 a[142:143], v243 offset:12288
v_mfma_f32_16x16x32_bf16 v[104:107], a[148:151], a[192:195], v[104:107]
buffer_load_dwordx4 a[184:187], v30, s[24:27], s56 offen offset:0 sc1
ds_read_b64_tr_b16 a[144:145], v244 offset:8192
v_mfma_f32_16x16x32_bf16 v[108:111], a[148:151], a[196:199], v[108:111]
ds_read_b64_tr_b16 a[146:147], v244 offset:12288
v_mfma_f32_16x16x32_bf16 v[112:115], a[152:155], a[192:195], v[112:115]
ds_read_b64_tr_b16 a[148:149], v245 offset:8192
v_mfma_f32_16x16x32_bf16 v[116:119], a[152:155], a[196:199], v[116:119]
ds_read_b64_tr_b16 a[150:151], v245 offset:12288
v_mfma_f32_16x16x32_bf16 v[120:123], a[156:159], a[192:195], v[120:123]
buffer_load_dwordx4 a[188:191], v30, s[24:27], s56 offen offset:1024 sc1
ds_read_b64_tr_b16 a[152:153], v246 offset:8192
v_mfma_f32_16x16x32_bf16 v[124:127], a[156:159], a[196:199], v[124:127]
ds_read_b64_tr_b16 a[154:155], v246 offset:12288
s_waitcnt lgkmcnt(6)
v_mfma_f32_16x16x32_bf16 v[64:67], a[128:131], a[200:203], v[64:67]
ds_read_b64_tr_b16 a[156:157], v247 offset:8192
v_mfma_f32_16x16x32_bf16 v[68:71], a[128:131], a[204:207], v[68:71]
ds_read_b64_tr_b16 a[158:159], v247 offset:12288
v_mfma_f32_16x16x32_bf16 v[72:75], a[132:135], a[200:203], v[72:75]
ds_read_b64_tr_b16 a[128:129], v240 offset:16384
v_mfma_f32_16x16x32_bf16 v[76:79], a[132:135], a[204:207], v[76:79]
ds_read_b64_tr_b16 a[130:131], v240 offset:20480
v_mfma_f32_16x16x32_bf16 v[80:83], a[136:139], a[200:203], v[80:83]
ds_read_b64_tr_b16 a[132:133], v241 offset:16384
v_mfma_f32_16x16x32_bf16 v[84:87], a[136:139], a[204:207], v[84:87]
ds_read_b64_tr_b16 a[134:135], v241 offset:20480
v_mfma_f32_16x16x32_bf16 v[88:91], a[140:143], a[200:203], v[88:91]
ds_read_b64_tr_b16 a[136:137], v242 offset:16384
v_mfma_f32_16x16x32_bf16 v[92:95], a[140:143], a[204:207], v[92:95]
ds_read_b64_tr_b16 a[138:139], v242 offset:20480
s_waitcnt lgkmcnt(6)
v_mfma_f32_16x16x32_bf16 v[96:99], a[144:147], a[200:203], v[96:99]
ds_read_b64_tr_b16 a[140:141], v243 offset:16384
v_mfma_f32_16x16x32_bf16 v[100:103], a[144:147], a[204:207], v[100:103]
ds_read_b64_tr_b16 a[142:143], v243 offset:20480
v_mfma_f32_16x16x32_bf16 v[104:107], a[148:151], a[200:203], v[104:107]
ds_read_b64_tr_b16 a[144:145], v244 offset:16384
v_mfma_f32_16x16x32_bf16 v[108:111], a[148:151], a[204:207], v[108:111]
ds_read_b64_tr_b16 a[146:147], v244 offset:20480
v_mfma_f32_16x16x32_bf16 v[112:115], a[152:155], a[200:203], v[112:115]
ds_read_b64_tr_b16 a[148:149], v245 offset:16384
v_mfma_f32_16x16x32_bf16 v[116:119], a[152:155], a[204:207], v[116:119]
ds_read_b64_tr_b16 a[150:151], v245 offset:20480
v_mfma_f32_16x16x32_bf16 v[120:123], a[156:159], a[200:203], v[120:123]
s_waitcnt vmcnt(12)
ds_read_b64_tr_b16 a[152:153], v246 offset:16384
v_mfma_f32_16x16x32_bf16 v[124:127], a[156:159], a[204:207], v[124:127]
ds_read_b64_tr_b16 a[154:155], v246 offset:20480
s_waitcnt lgkmcnt(6)
v_mfma_f32_16x16x32_bf16 v[64:67], a[128:131], a[208:211], v[64:67]
ds_read_b64_tr_b16 a[156:157], v247 offset:16384
v_mfma_f32_16x16x32_bf16 v[68:71], a[128:131], a[212:215], v[68:71]
ds_read_b64_tr_b16 a[158:159], v247 offset:20480
v_mfma_f32_16x16x32_bf16 v[72:75], a[132:135], a[208:211], v[72:75]
s_add_u32 s56, s71, 32768
buffer_load_dwordx4 a[192:195], v40, s[24:27], s56 offen offset:0 sc1
ds_read_b64_tr_b16 a[128:129], v240 offset:24576
v_mfma_f32_16x16x32_bf16 v[76:79], a[132:135], a[212:215], v[76:79]
ds_read_b64_tr_b16 a[130:131], v240 offset:28672
v_mfma_f32_16x16x32_bf16 v[80:83], a[136:139], a[208:211], v[80:83]
ds_read_b64_tr_b16 a[132:133], v241 offset:24576
v_mfma_f32_16x16x32_bf16 v[84:87], a[136:139], a[212:215], v[84:87]
ds_read_b64_tr_b16 a[134:135], v241 offset:28672
v_mfma_f32_16x16x32_bf16 v[88:91], a[140:143], a[208:211], v[88:91]
buffer_load_dwordx4 a[196:199], v40, s[24:27], s56 offen offset:1024 sc1
ds_read_b64_tr_b16 a[136:137], v242 offset:24576
v_mfma_f32_16x16x32_bf16 v[92:95], a[140:143], a[212:215], v[92:95]
ds_read_b64_tr_b16 a[138:139], v242 offset:28672
s_waitcnt lgkmcnt(6)
v_mfma_f32_16x16x32_bf16 v[96:99], a[144:147], a[208:211], v[96:99]
ds_read_b64_tr_b16 a[140:141], v243 offset:24576
v_mfma_f32_16x16x32_bf16 v[100:103], a[144:147], a[212:215], v[100:103]
ds_read_b64_tr_b16 a[142:143], v243 offset:28672
v_mfma_f32_16x16x32_bf16 v[104:107], a[148:151], a[208:211], v[104:107]
buffer_load_dwordx4 a[200:203], v30, s[24:27], s56 offen offset:0 sc1
ds_read_b64_tr_b16 a[144:145], v244 offset:24576
v_mfma_f32_16x16x32_bf16 v[108:111], a[148:151], a[212:215], v[108:111]
ds_read_b64_tr_b16 a[146:147], v244 offset:28672
v_mfma_f32_16x16x32_bf16 v[112:115], a[152:155], a[208:211], v[112:115]
ds_read_b64_tr_b16 a[148:149], v245 offset:24576
v_mfma_f32_16x16x32_bf16 v[116:119], a[152:155], a[212:215], v[116:119]
ds_read_b64_tr_b16 a[150:151], v245 offset:28672
v_mfma_f32_16x16x32_bf16 v[120:123], a[156:159], a[208:211], v[120:123]
buffer_load_dwordx4 a[204:207], v30, s[24:27], s56 offen offset:1024 sc1
ds_read_b64_tr_b16 a[152:153], v246 offset:24576
v_mfma_f32_16x16x32_bf16 v[124:127], a[156:159], a[212:215], v[124:127]
ds_read_b64_tr_b16 a[154:155], v246 offset:28672
s_waitcnt lgkmcnt(6)
v_mfma_f32_16x16x32_bf16 v[64:67], a[128:131], a[216:219], v[64:67]
ds_read_b64_tr_b16 a[156:157], v247 offset:24576
v_mfma_f32_16x16x32_bf16 v[68:71], a[128:131], a[220:223], v[68:71]
ds_read_b64_tr_b16 a[158:159], v247 offset:28672
v_mfma_f32_16x16x32_bf16 v[72:75], a[132:135], a[216:219], v[72:75]
ds_read_b64_tr_b16 a[128:129], v192 offset:0
v_mfma_f32_16x16x32_bf16 v[76:79], a[132:135], a[220:223], v[76:79]
ds_read_b64_tr_b16 a[130:131], v192 offset:4096
v_mfma_f32_16x16x32_bf16 v[80:83], a[136:139], a[216:219], v[80:83]
ds_read_b64_tr_b16 a[132:133], v193 offset:0
v_mfma_f32_16x16x32_bf16 v[84:87], a[136:139], a[220:223], v[84:87]
ds_read_b64_tr_b16 a[134:135], v193 offset:4096
v_mfma_f32_16x16x32_bf16 v[88:91], a[140:143], a[216:219], v[88:91]
ds_read_b64_tr_b16 a[136:137], v194 offset:0
v_mfma_f32_16x16x32_bf16 v[92:95], a[140:143], a[220:223], v[92:95]
ds_read_b64_tr_b16 a[138:139], v194 offset:4096
s_waitcnt lgkmcnt(6)
v_mfma_f32_16x16x32_bf16 v[96:99], a[144:147], a[216:219], v[96:99]
ds_read_b64_tr_b16 a[140:141], v195 offset:0
v_mfma_f32_16x16x32_bf16 v[100:103], a[144:147], a[220:223], v[100:103]
ds_read_b64_tr_b16 a[142:143], v195 offset:4096
v_mfma_f32_16x16x32_bf16 v[104:107], a[148:151], a[216:219], v[104:107]
ds_read_b64_tr_b16 a[144:145], v196 offset:0
v_mfma_f32_16x16x32_bf16 v[108:111], a[148:151], a[220:223], v[108:111]
ds_read_b64_tr_b16 a[146:147], v196 offset:4096
v_mfma_f32_16x16x32_bf16 v[112:115], a[152:155], a[216:219], v[112:115]
ds_read_b64_tr_b16 a[148:149], v197 offset:0
v_mfma_f32_16x16x32_bf16 v[116:119], a[152:155], a[220:223], v[116:119]
ds_read_b64_tr_b16 a[150:151], v197 offset:4096
v_mfma_f32_16x16x32_bf16 v[120:123], a[156:159], a[216:219], v[120:123]
s_waitcnt vmcnt(8)
ds_read_b64_tr_b16 a[152:153], v198 offset:0
v_mfma_f32_16x16x32_bf16 v[124:127], a[156:159], a[220:223], v[124:127]
ds_read_b64_tr_b16 a[154:155], v198 offset:4096
s_waitcnt lgkmcnt(6)
v_mfma_f32_16x16x32_bf16 v[64:67], a[128:131], a[160:163], v[64:67]
ds_read_b64_tr_b16 a[156:157], v199 offset:0
v_mfma_f32_16x16x32_bf16 v[68:71], a[128:131], a[164:167], v[68:71]
ds_read_b64_tr_b16 a[158:159], v199 offset:4096
v_mfma_f32_16x16x32_bf16 v[72:75], a[132:135], a[160:163], v[72:75]
s_add_u32 s56, s71, 49152
buffer_load_dwordx4 a[208:211], v40, s[24:27], s56 offen offset:0 sc1
ds_read_b64_tr_b16 a[128:129], v192 offset:8192
v_mfma_f32_16x16x32_bf16 v[76:79], a[132:135], a[164:167], v[76:79]
ds_read_b64_tr_b16 a[130:131], v192 offset:12288
v_mfma_f32_16x16x32_bf16 v[80:83], a[136:139], a[160:163], v[80:83]
ds_read_b64_tr_b16 a[132:133], v193 offset:8192
v_mfma_f32_16x16x32_bf16 v[84:87], a[136:139], a[164:167], v[84:87]
ds_read_b64_tr_b16 a[134:135], v193 offset:12288
v_mfma_f32_16x16x32_bf16 v[88:91], a[140:143], a[160:163], v[88:91]
buffer_load_dwordx4 a[212:215], v40, s[24:27], s56 offen offset:1024 sc1
ds_read_b64_tr_b16 a[136:137], v194 offset:8192
v_mfma_f32_16x16x32_bf16 v[92:95], a[140:143], a[164:167], v[92:95]
ds_read_b64_tr_b16 a[138:139], v194 offset:12288
s_waitcnt lgkmcnt(6)
v_mfma_f32_16x16x32_bf16 v[96:99], a[144:147], a[160:163], v[96:99]
ds_read_b64_tr_b16 a[140:141], v195 offset:8192
v_mfma_f32_16x16x32_bf16 v[100:103], a[144:147], a[164:167], v[100:103]
ds_read_b64_tr_b16 a[142:143], v195 offset:12288
v_mfma_f32_16x16x32_bf16 v[104:107], a[148:151], a[160:163], v[104:107]
buffer_load_dwordx4 a[216:219], v30, s[24:27], s56 offen offset:0 sc1
ds_read_b64_tr_b16 a[144:145], v196 offset:8192
v_mfma_f32_16x16x32_bf16 v[108:111], a[148:151], a[164:167], v[108:111]
ds_read_b64_tr_b16 a[146:147], v196 offset:12288
v_mfma_f32_16x16x32_bf16 v[112:115], a[152:155], a[160:163], v[112:115]
ds_read_b64_tr_b16 a[148:149], v197 offset:8192
v_mfma_f32_16x16x32_bf16 v[116:119], a[152:155], a[164:167], v[116:119]
ds_read_b64_tr_b16 a[150:151], v197 offset:12288
v_mfma_f32_16x16x32_bf16 v[120:123], a[156:159], a[160:163], v[120:123]
buffer_load_dwordx4 a[220:223], v30, s[24:27], s56 offen offset:1024 sc1
ds_read_b64_tr_b16 a[152:153], v198 offset:8192
v_mfma_f32_16x16x32_bf16 v[124:127], a[156:159], a[164:167], v[124:127]
ds_read_b64_tr_b16 a[154:155], v198 offset:12288
s_waitcnt lgkmcnt(6)
v_mfma_f32_16x16x32_bf16 v[64:67], a[128:131], a[168:171], v[64:67]
ds_read_b64_tr_b16 a[156:157], v199 offset:8192
v_mfma_f32_16x16x32_bf16 v[68:71], a[128:131], a[172:175], v[68:71]
ds_read_b64_tr_b16 a[158:159], v199 offset:12288
v_mfma_f32_16x16x32_bf16 v[72:75], a[132:135], a[168:171], v[72:75]
s_waitcnt vmcnt(16)
s_barrier
ds_read_b64_tr_b16 a[128:129], v192 offset:16384
v_mfma_f32_16x16x32_bf16 v[76:79], a[132:135], a[172:175], v[76:79]
ds_read_b64_tr_b16 a[130:131], v192 offset:20480
v_mfma_f32_16x16x32_bf16 v[80:83], a[136:139], a[168:171], v[80:83]
ds_read_b64_tr_b16 a[132:133], v193 offset:16384
v_mfma_f32_16x16x32_bf16 v[84:87], a[136:139], a[172:175], v[84:87]
ds_read_b64_tr_b16 a[134:135], v193 offset:20480
v_mfma_f32_16x16x32_bf16 v[88:91], a[140:143], a[168:171], v[88:91]
ds_read_b64_tr_b16 a[136:137], v194 offset:16384
v_mfma_f32_16x16x32_bf16 v[92:95], a[140:143], a[172:175], v[92:95]
ds_read_b64_tr_b16 a[138:139], v194 offset:20480
s_waitcnt lgkmcnt(6)
v_mfma_f32_16x16x32_bf16 v[96:99], a[144:147], a[168:171], v[96:99]
ds_read_b64_tr_b16 a[140:141], v195 offset:16384
v_mfma_f32_16x16x32_bf16 v[100:103], a[144:147], a[172:175], v[100:103]
ds_read_b64_tr_b16 a[142:143], v195 offset:20480
v_mfma_f32_16x16x32_bf16 v[104:107], a[148:151], a[168:171], v[104:107]
ds_read_b64_tr_b16 a[144:145], v196 offset:16384
v_mfma_f32_16x16x32_bf16 v[108:111], a[148:151], a[172:175], v[108:111]
ds_read_b64_tr_b16 a[146:147], v196 offset:20480
v_mfma_f32_16x16x32_bf16 v[112:115], a[152:155], a[168:171], v[112:115]
ds_read_b64_tr_b16 a[148:149], v197 offset:16384
v_mfma_f32_16x16x32_bf16 v[116:119], a[152:155], a[172:175], v[116:119]
ds_read_b64_tr_b16 a[150:151], v197 offset:20480
v_mfma_f32_16x16x32_bf16 v[120:123], a[156:159], a[168:171], v[120:123]
s_waitcnt vmcnt(8)
ds_read_b64_tr_b16 a[152:153], v198 offset:16384
v_mfma_f32_16x16x32_bf16 v[124:127], a[156:159], a[172:175], v[124:127]
ds_read_b64_tr_b16 a[154:155], v198 offset:20480
s_waitcnt lgkmcnt(6)
v_mfma_f32_16x16x32_bf16 v[64:67], a[128:131], a[176:179], v[64:67]
ds_read_b64_tr_b16 a[156:157], v199 offset:16384
v_mfma_f32_16x16x32_bf16 v[68:71], a[128:131], a[180:183], v[68:71]
ds_read_b64_tr_b16 a[158:159], v199 offset:20480
v_mfma_f32_16x16x32_bf16 v[72:75], a[132:135], a[176:179], v[72:75]
ds_read_b64_tr_b16 a[128:129], v192 offset:24576
v_mfma_f32_16x16x32_bf16 v[76:79], a[132:135], a[180:183], v[76:79]
ds_read_b64_tr_b16 a[130:131], v192 offset:28672
v_mfma_f32_16x16x32_bf16 v[80:83], a[136:139], a[176:179], v[80:83]
ds_read_b64_tr_b16 a[132:133], v193 offset:24576
v_mfma_f32_16x16x32_bf16 v[84:87], a[136:139], a[180:183], v[84:87]
ds_read_b64_tr_b16 a[134:135], v193 offset:28672
v_mfma_f32_16x16x32_bf16 v[88:91], a[140:143], a[176:179], v[88:91]
ds_read_b64_tr_b16 a[136:137], v194 offset:24576
v_mfma_f32_16x16x32_bf16 v[92:95], a[140:143], a[180:183], v[92:95]
ds_read_b64_tr_b16 a[138:139], v194 offset:28672
s_waitcnt lgkmcnt(6)
v_mfma_f32_16x16x32_bf16 v[96:99], a[144:147], a[176:179], v[96:99]
ds_read_b64_tr_b16 a[140:141], v195 offset:24576
v_mfma_f32_16x16x32_bf16 v[100:103], a[144:147], a[180:183], v[100:103]
ds_read_b64_tr_b16 a[142:143], v195 offset:28672
v_mfma_f32_16x16x32_bf16 v[104:107], a[148:151], a[176:179], v[104:107]
ds_read_b64_tr_b16 a[144:145], v196 offset:24576
v_mfma_f32_16x16x32_bf16 v[108:111], a[148:151], a[180:183], v[108:111]
ds_read_b64_tr_b16 a[146:147], v196 offset:28672
v_mfma_f32_16x16x32_bf16 v[112:115], a[152:155], a[176:179], v[112:115]
ds_read_b64_tr_b16 a[148:149], v197 offset:24576
v_mfma_f32_16x16x32_bf16 v[116:119], a[152:155], a[180:183], v[116:119]
ds_read_b64_tr_b16 a[150:151], v197 offset:28672
v_mfma_f32_16x16x32_bf16 v[120:123], a[156:159], a[176:179], v[120:123]
ds_read_b64_tr_b16 a[152:153], v198 offset:24576
v_mfma_f32_16x16x32_bf16 v[124:127], a[156:159], a[180:183], v[124:127]
ds_read_b64_tr_b16 a[154:155], v198 offset:28672
s_waitcnt lgkmcnt(6)
v_mfma_f32_16x16x32_bf16 v[64:67], a[128:131], a[184:187], v[64:67]
ds_read_b64_tr_b16 a[156:157], v199 offset:24576
v_mfma_f32_16x16x32_bf16 v[68:71], a[128:131], a[188:191], v[68:71]
ds_read_b64_tr_b16 a[158:159], v199 offset:28672
v_mfma_f32_16x16x32_bf16 v[72:75], a[132:135], a[184:187], v[72:75]
ds_read_b64_tr_b16 a[128:129], v20 offset:0
v_mfma_f32_16x16x32_bf16 v[76:79], a[132:135], a[188:191], v[76:79]
ds_read_b64_tr_b16 a[130:131], v20 offset:4096
v_mfma_f32_16x16x32_bf16 v[80:83], a[136:139], a[184:187], v[80:83]
ds_read_b64_tr_b16 a[132:133], v21 offset:0
v_mfma_f32_16x16x32_bf16 v[84:87], a[136:139], a[188:191], v[84:87]
ds_read_b64_tr_b16 a[134:135], v21 offset:4096
v_mfma_f32_16x16x32_bf16 v[88:91], a[140:143], a[184:187], v[88:91]
ds_read_b64_tr_b16 a[136:137], v22 offset:0
v_mfma_f32_16x16x32_bf16 v[92:95], a[140:143], a[188:191], v[92:95]
ds_read_b64_tr_b16 a[138:139], v22 offset:4096
s_waitcnt lgkmcnt(6)
v_mfma_f32_16x16x32_bf16 v[96:99], a[144:147], a[184:187], v[96:99]
ds_read_b64_tr_b16 a[140:141], v23 offset:0
v_mfma_f32_16x16x32_bf16 v[100:103], a[144:147], a[188:191], v[100:103]
ds_read_b64_tr_b16 a[142:143], v23 offset:4096
v_mfma_f32_16x16x32_bf16 v[104:107], a[148:151], a[184:187], v[104:107]
ds_read_b64_tr_b16 a[144:145], v24 offset:0
v_mfma_f32_16x16x32_bf16 v[108:111], a[148:151], a[188:191], v[108:111]
ds_read_b64_tr_b16 a[146:147], v24 offset:4096
v_mfma_f32_16x16x32_bf16 v[112:115], a[152:155], a[184:187], v[112:115]
ds_read_b64_tr_b16 a[148:149], v25 offset:0
v_mfma_f32_16x16x32_bf16 v[116:119], a[152:155], a[188:191], v[116:119]
ds_read_b64_tr_b16 a[150:151], v25 offset:4096
v_mfma_f32_16x16x32_bf16 v[120:123], a[156:159], a[184:187], v[120:123]
s_waitcnt vmcnt(4)
ds_read_b64_tr_b16 a[152:153], v26 offset:0
v_mfma_f32_16x16x32_bf16 v[124:127], a[156:159], a[188:191], v[124:127]
ds_read_b64_tr_b16 a[154:155], v26 offset:4096
s_waitcnt lgkmcnt(6)
v_mfma_f32_16x16x32_bf16 v[64:67], a[128:131], a[192:195], v[64:67]
ds_read_b64_tr_b16 a[156:157], v27 offset:0
v_mfma_f32_16x16x32_bf16 v[68:71], a[128:131], a[196:199], v[68:71]
ds_read_b64_tr_b16 a[158:159], v27 offset:4096
v_mfma_f32_16x16x32_bf16 v[72:75], a[132:135], a[192:195], v[72:75]
ds_read_b64_tr_b16 a[128:129], v20 offset:8192
v_mfma_f32_16x16x32_bf16 v[76:79], a[132:135], a[196:199], v[76:79]
ds_read_b64_tr_b16 a[130:131], v20 offset:12288
v_mfma_f32_16x16x32_bf16 v[80:83], a[136:139], a[192:195], v[80:83]
ds_read_b64_tr_b16 a[132:133], v21 offset:8192
v_mfma_f32_16x16x32_bf16 v[84:87], a[136:139], a[196:199], v[84:87]
ds_read_b64_tr_b16 a[134:135], v21 offset:12288
v_mfma_f32_16x16x32_bf16 v[88:91], a[140:143], a[192:195], v[88:91]
ds_read_b64_tr_b16 a[136:137], v22 offset:8192
v_mfma_f32_16x16x32_bf16 v[92:95], a[140:143], a[196:199], v[92:95]
ds_read_b64_tr_b16 a[138:139], v22 offset:12288
s_waitcnt lgkmcnt(6)
v_mfma_f32_16x16x32_bf16 v[96:99], a[144:147], a[192:195], v[96:99]
ds_read_b64_tr_b16 a[140:141], v23 offset:8192
v_mfma_f32_16x16x32_bf16 v[100:103], a[144:147], a[196:199], v[100:103]
ds_read_b64_tr_b16 a[142:143], v23 offset:12288
v_mfma_f32_16x16x32_bf16 v[104:107], a[148:151], a[192:195], v[104:107]
ds_read_b64_tr_b16 a[144:145], v24 offset:8192
v_mfma_f32_16x16x32_bf16 v[108:111], a[148:151], a[196:199], v[108:111]
ds_read_b64_tr_b16 a[146:147], v24 offset:12288
v_mfma_f32_16x16x32_bf16 v[112:115], a[152:155], a[192:195], v[112:115]
ds_read_b64_tr_b16 a[148:149], v25 offset:8192
v_mfma_f32_16x16x32_bf16 v[116:119], a[152:155], a[196:199], v[116:119]
ds_read_b64_tr_b16 a[150:151], v25 offset:12288
v_mfma_f32_16x16x32_bf16 v[120:123], a[156:159], a[192:195], v[120:123]
ds_read_b64_tr_b16 a[152:153], v26 offset:8192
v_mfma_f32_16x16x32_bf16 v[124:127], a[156:159], a[196:199], v[124:127]
ds_read_b64_tr_b16 a[154:155], v26 offset:12288
s_waitcnt lgkmcnt(6)
v_mfma_f32_16x16x32_bf16 v[64:67], a[128:131], a[200:203], v[64:67]
ds_read_b64_tr_b16 a[156:157], v27 offset:8192
v_mfma_f32_16x16x32_bf16 v[68:71], a[128:131], a[204:207], v[68:71]
ds_read_b64_tr_b16 a[158:159], v27 offset:12288
v_mfma_f32_16x16x32_bf16 v[72:75], a[132:135], a[200:203], v[72:75]
ds_read_b64_tr_b16 a[128:129], v192 offset:32768
v_mfma_f32_16x16x32_bf16 v[76:79], a[132:135], a[204:207], v[76:79]
ds_read_b64_tr_b16 a[130:131], v192 offset:36864
v_mfma_f32_16x16x32_bf16 v[80:83], a[136:139], a[200:203], v[80:83]
ds_read_b64_tr_b16 a[132:133], v193 offset:32768
v_mfma_f32_16x16x32_bf16 v[84:87], a[136:139], a[204:207], v[84:87]
ds_read_b64_tr_b16 a[134:135], v193 offset:36864
v_mfma_f32_16x16x32_bf16 v[88:91], a[140:143], a[200:203], v[88:91]
ds_read_b64_tr_b16 a[136:137], v194 offset:32768
v_mfma_f32_16x16x32_bf16 v[92:95], a[140:143], a[204:207], v[92:95]
ds_read_b64_tr_b16 a[138:139], v194 offset:36864
s_waitcnt lgkmcnt(6)
v_mfma_f32_16x16x32_bf16 v[96:99], a[144:147], a[200:203], v[96:99]
ds_read_b64_tr_b16 a[140:141], v195 offset:32768
v_mfma_f32_16x16x32_bf16 v[100:103], a[144:147], a[204:207], v[100:103]
ds_read_b64_tr_b16 a[142:143], v195 offset:36864
v_mfma_f32_16x16x32_bf16 v[104:107], a[148:151], a[200:203], v[104:107]
ds_read_b64_tr_b16 a[144:145], v196 offset:32768
v_mfma_f32_16x16x32_bf16 v[108:111], a[148:151], a[204:207], v[108:111]
ds_read_b64_tr_b16 a[146:147], v196 offset:36864
v_mfma_f32_16x16x32_bf16 v[112:115], a[152:155], a[200:203], v[112:115]
ds_read_b64_tr_b16 a[148:149], v197 offset:32768
v_mfma_f32_16x16x32_bf16 v[116:119], a[152:155], a[204:207], v[116:119]
ds_read_b64_tr_b16 a[150:151], v197 offset:36864
v_mfma_f32_16x16x32_bf16 v[120:123], a[156:159], a[200:203], v[120:123]
s_waitcnt vmcnt(0)
ds_read_b64_tr_b16 a[152:153], v198 offset:32768
v_mfma_f32_16x16x32_bf16 v[124:127], a[156:159], a[204:207], v[124:127]
ds_read_b64_tr_b16 a[154:155], v198 offset:36864
s_waitcnt lgkmcnt(6)
v_mfma_f32_16x16x32_bf16 v[64:67], a[128:131], a[208:211], v[64:67]
ds_read_b64_tr_b16 a[156:157], v199 offset:32768
v_mfma_f32_16x16x32_bf16 v[68:71], a[128:131], a[212:215], v[68:71]
ds_read_b64_tr_b16 a[158:159], v199 offset:36864
v_mfma_f32_16x16x32_bf16 v[72:75], a[132:135], a[208:211], v[72:75]
ds_read_b64_tr_b16 a[128:129], v192 offset:40960
v_mfma_f32_16x16x32_bf16 v[76:79], a[132:135], a[212:215], v[76:79]
ds_read_b64_tr_b16 a[130:131], v192 offset:45056
v_mfma_f32_16x16x32_bf16 v[80:83], a[136:139], a[208:211], v[80:83]
ds_read_b64_tr_b16 a[132:133], v193 offset:40960
v_mfma_f32_16x16x32_bf16 v[84:87], a[136:139], a[212:215], v[84:87]
ds_read_b64_tr_b16 a[134:135], v193 offset:45056
v_mfma_f32_16x16x32_bf16 v[88:91], a[140:143], a[208:211], v[88:91]
ds_read_b64_tr_b16 a[136:137], v194 offset:40960
v_mfma_f32_16x16x32_bf16 v[92:95], a[140:143], a[212:215], v[92:95]
ds_read_b64_tr_b16 a[138:139], v194 offset:45056
s_waitcnt lgkmcnt(6)
v_mfma_f32_16x16x32_bf16 v[96:99], a[144:147], a[208:211], v[96:99]
ds_read_b64_tr_b16 a[140:141], v195 offset:40960
v_mfma_f32_16x16x32_bf16 v[100:103], a[144:147], a[212:215], v[100:103]
ds_read_b64_tr_b16 a[142:143], v195 offset:45056
v_mfma_f32_16x16x32_bf16 v[104:107], a[148:151], a[208:211], v[104:107]
ds_read_b64_tr_b16 a[144:145], v196 offset:40960
v_mfma_f32_16x16x32_bf16 v[108:111], a[148:151], a[212:215], v[108:111]
ds_read_b64_tr_b16 a[146:147], v196 offset:45056
v_mfma_f32_16x16x32_bf16 v[112:115], a[152:155], a[208:211], v[112:115]
ds_read_b64_tr_b16 a[148:149], v197 offset:40960
v_mfma_f32_16x16x32_bf16 v[116:119], a[152:155], a[212:215], v[116:119]
ds_read_b64_tr_b16 a[150:151], v197 offset:45056
v_mfma_f32_16x16x32_bf16 v[120:123], a[156:159], a[208:211], v[120:123]
ds_read_b64_tr_b16 a[152:153], v198 offset:40960
v_mfma_f32_16x16x32_bf16 v[124:127], a[156:159], a[212:215], v[124:127]
ds_read_b64_tr_b16 a[154:155], v198 offset:45056
s_waitcnt lgkmcnt(6)
v_mfma_f32_16x16x32_bf16 v[64:67], a[128:131], a[216:219], v[64:67]
ds_read_b64_tr_b16 a[156:157], v199 offset:40960
v_mfma_f32_16x16x32_bf16 v[68:71], a[128:131], a[220:223], v[68:71]
ds_read_b64_tr_b16 a[158:159], v199 offset:45056
v_mfma_f32_16x16x32_bf16 v[72:75], a[132:135], a[216:219], v[72:75]
v_mfma_f32_16x16x32_bf16 v[76:79], a[132:135], a[220:223], v[76:79]
v_mfma_f32_16x16x32_bf16 v[80:83], a[136:139], a[216:219], v[80:83]
v_mfma_f32_16x16x32_bf16 v[84:87], a[136:139], a[220:223], v[84:87]
v_mfma_f32_16x16x32_bf16 v[88:91], a[140:143], a[216:219], v[88:91]
v_mfma_f32_16x16x32_bf16 v[92:95], a[140:143], a[220:223], v[92:95]
s_waitcnt lgkmcnt(0)
v_mfma_f32_16x16x32_bf16 v[96:99], a[144:147], a[216:219], v[96:99]
v_mfma_f32_16x16x32_bf16 v[100:103], a[144:147], a[220:223], v[100:103]
v_mfma_f32_16x16x32_bf16 v[104:107], a[148:151], a[216:219], v[104:107]
v_mfma_f32_16x16x32_bf16 v[108:111], a[148:151], a[220:223], v[108:111]
v_mfma_f32_16x16x32_bf16 v[112:115], a[152:155], a[216:219], v[112:115]
v_mfma_f32_16x16x32_bf16 v[116:119], a[152:155], a[220:223], v[116:119]
v_mfma_f32_16x16x32_bf16 v[120:123], a[156:159], a[216:219], v[120:123]
v_mfma_f32_16x16x32_bf16 v[124:127], a[156:159], a[220:223], v[124:127]
s_nop 3
v_add_u32 v4, s37, v40
v_and_b32 v5, 15, v2
v_lshrrev_b32 v6, 4, v2
v_lshlrev_b32 v5, 10, v5
v_lshl_add_u32 v5, v6, 4, v5
v_lshrrev_b32 v7, 2, v13
s_nop 1
s_cmp_eq_u32 s36, s61
s_cbranch_scc1 L_own
v_cvt_pk_bf16_f32 v128, v64, v65
v_cvt_pk_bf16_f32 v129, v66, v67
v_cvt_pk_bf16_f32 v130, v72, v73
v_cvt_pk_bf16_f32 v131, v74, v75
buffer_store_dwordx4 v[128:131], v40, s[24:27], s62 offen offset:0 sc1
v_cvt_pk_bf16_f32 v132, v68, v69
v_cvt_pk_bf16_f32 v133, v70, v71
v_cvt_pk_bf16_f32 v134, v76, v77
v_cvt_pk_bf16_f32 v135, v78, v79
buffer_store_dwordx4 v[132:135], v40, s[24:27], s62 offen offset:1024 sc1
v_cvt_pk_bf16_f32 v136, v80, v81
v_cvt_pk_bf16_f32 v137, v82, v83
v_cvt_pk_bf16_f32 v138, v88, v89
v_cvt_pk_bf16_f32 v139, v90, v91
buffer_store_dwordx4 v[136:139], v40, s[24:27], s62 offen offset:2048 sc1
v_cvt_pk_bf16_f32 v140, v84, v85
v_cvt_pk_bf16_f32 v141, v86, v87
v_cvt_pk_bf16_f32 v142, v92, v93
v_cvt_pk_bf16_f32 v143, v94, v95
buffer_store_dwordx4 v[140:143], v40, s[24:27], s62 offen offset:3072 sc1
s_add_u32 s62, s62, 4096
v_cvt_pk_bf16_f32 v144, v96, v97
v_cvt_pk_bf16_f32 v145, v98, v99
v_cvt_pk_bf16_f32 v146, v104, v105
v_cvt_pk_bf16_f32 v147, v106, v107
buffer_store_dwordx4 v[144:147], v40, s[24:27], s62 offen offset:0 sc1
v_cvt_pk_bf16_f32 v148, v100, v101
v_cvt_pk_bf16_f32 v149, v102, v103
v_cvt_pk_bf16_f32 v150, v108, v109
v_cvt_pk_bf16_f32 v151, v110, v111
buffer_store_dwordx4 v[148:151], v40, s[24:27], s62 offen offset:1024 sc1
v_cvt_pk_bf16_f32 v152, v112, v113
v_cvt_pk_bf16_f32 v153, v114, v115
v_cvt_pk_bf16_f32 v154, v120, v121
v_cvt_pk_bf16_f32 v155, v122, v123
buffer_store_dwordx4 v[152:155], v40, s[24:27], s62 offen offset:2048 sc1
v_cvt_pk_bf16_f32 v156, v116, v117
v_cvt_pk_bf16_f32 v157, v118, v119
v_cvt_pk_bf16_f32 v158, v124, v125
v_cvt_pk_bf16_f32 v159, v126, v127
buffer_store_dwordx4 v[156:159], v40, s[24:27], s62 offen offset:3072 sc1
s_barrier
s_waitcnt vmcnt(0)
s_mov_b64 exec, 1
buffer_store_dword v253, v14, s[24:27], s3 offen sc1
s_mov_b64 exec, -1
s_branch L_join
L_own:
s_barrier
ds_write_b128 v40, v[64:67] offset:0
ds_write_b128 v40, v[68:71] offset:1024
ds_write_b128 v40, v[72:75] offset:2048
ds_write_b128 v40, v[76:79] offset:3072
ds_write_b128 v40, v[80:83] offset:4096
ds_write_b128 v40, v[84:87] offset:5120
ds_write_b128 v40, v[88:91] offset:6144
ds_write_b128 v40, v[92:95] offset:7168
s_waitcnt lgkmcnt(0)
ds_write_b128 v40, v[96:99] offset:8192
ds_write_b128 v40, v[100:103] offset:9216
ds_write_b128 v40, v[104:107] offset:10240
ds_write_b128 v40, v[108:111] offset:11264
ds_write_b128 v40, v[112:115] offset:12288
ds_write_b128 v40, v[116:119] offset:13312
ds_write_b128 v40, v[120:123] offset:14336
ds_write_b128 v40, v[124:127] offset:15360
s_waitcnt lgkmcnt(0)
L_join:
s_barrier
ds_read_b128 v[64:67], v4 offset:0
ds_read_b128 v[68:71], v4 offset:1024
ds_read_b128 v[72:75], v4 offset:2048
ds_read_b128 v[76:79], v4 offset:3072
v_cmp_ne_u32 s[96:97], s61, v7
buffer_load_dword v29, v13, s[24:27], s45 offen sc1
s_waitcnt vmcnt(0)
s_mov_b32 s87, 0x40000
L_c3:
v_cmp_eq_u32 vcc, v252, v29
s_and_b64 vcc, vcc, s[96:97]
s_cbranch_vccz L_c3_ok
s_sub_u32 s87, s87, 1
s_cbranch_scc1 L_c3_ok
buffer_load_dword v29, v13, s[24:27], s45 offen sc1
s_waitcnt vmcnt(0)
s_branch L_c3
L_c3_ok:
s_add_u32 s51, s61, 1
s_and_b32 s51, s51, 3
s_lshl_b32 s51, s51, 13
s_add_u32 s51, s51, s63
buffer_load_dwordx4 v[80:83], v40, s[24:27], s51 offen offset:0 sc1
buffer_load_dwordx4 v[84:87], v40, s[24:27], s51 offen offset:1024 sc1
s_add_u32 s51, s61, 2
s_and_b32 s51, s51, 3
s_lshl_b32 s51, s51, 13
s_add_u32 s51, s51, s63
buffer_load_dwordx4 v[88:91], v40, s[24:27], s51 offen offset:0 sc1
buffer_load_dwordx4 v[92:95], v40, s[24:27], s51 offen offset:1024 sc1
s_add_u32 s51, s61, 3
s_and_b32 s51, s51, 3
s_lshl_b32 s51, s51, 13
s_add_u32 s51, s51, s63
buffer_load_dwordx4 v[96:99], v40, s[24:27], s51 offen offset:0 sc1
buffer_load_dwordx4 v[100:103], v40, s[24:27], s51 offen offset:1024 sc1
v_mov_b32 v112, 0x3f80
v_mov_b32 v113, 0x3f800000
s_waitcnt lgkmcnt(0)
s_waitcnt vmcnt(4)
v_dot2_f32_bf16 v64, v80, v112, v64
v_dot2_f32_bf16 v65, v80, v113, v65
v_dot2_f32_bf16 v66, v81, v112, v66
v_dot2_f32_bf16 v67, v81, v113, v67
v_dot2_f32_bf16 v72, v82, v112, v72
v_dot2_f32_bf16 v73, v82, v113, v73
v_dot2_f32_bf16 v74, v83, v112, v74
v_dot2_f32_bf16 v75, v83, v113, v75
v_dot2_f32_bf16 v68, v84, v112, v68
v_dot2_f32_bf16 v69, v84, v113, v69
v_dot2_f32_bf16 v70, v85, v112, v70
v_dot2_f32_bf16 v71, v85, v113, v71
v_dot2_f32_bf16 v76, v86, v112, v76
v_dot2_f32_bf16 v77, v86, v113, v77
v_dot2_f32_bf16 v78, v87, v112, v78
v_dot2_f32_bf16 v79, v87, v113, v79
s_waitcnt vmcnt(2)
v_dot2_f32_bf16 v64, v88, v112, v64
v_dot2_f32_bf16 v65, v88, v113, v65
v_dot2_f32_bf16 v66, v89, v112, v66
v_dot2_f32_bf16 v67, v89, v113, v67
v_dot2_f32_bf16 v72, v90, v112, v72
v_dot2_f32_bf16 v73, v90, v113, v73
v_dot2_f32_bf16 v74, v91, v112, v74
v_dot2_f32_bf16 v75, v91, v113, v75
v_dot2_f32_bf16 v68, v92, v112, v68
v_dot2_f32_bf16 v69, v92, v113, v69
v_dot2_f32_bf16 v70, v93, v112, v70
v_dot2_f32_bf16 v71, v93, v113, v71
v_dot2_f32_bf16 v76, v94, v112, v76
v_dot2_f32_bf16 v77, v94, v113, v77
v_dot2_f32_bf16 v78, v95, v112, v78
v_dot2_f32_bf16 v79, v95, v113, v79
s_waitcnt vmcnt(0)
v_dot2_f32_bf16 v64, v96, v112, v64
v_dot2_f32_bf16 v65, v96, v113, v65
v_dot2_f32_bf16 v66, v97, v112, v66
v_dot2_f32_bf16 v67, v97, v113, v67
v_dot2_f32_bf16 v72, v98, v112, v72
v_dot2_f32_bf16 v73, v98, v113, v73
v_dot2_f32_bf16 v74, v99, v112, v74
v_dot2_f32_bf16 v75, v99, v113, v75
v_dot2_f32_bf16 v68, v100, v112, v68
v_dot2_f32_bf16 v69, v100, v113, v69
v_dot2_f32_bf16 v70, v101, v112, v70
v_dot2_f32_bf16 v71, v101, v113, v71
v_dot2_f32_bf16 v76, v102, v112, v76
v_dot2_f32_bf16 v77, v102, v113, v77
v_dot2_f32_bf16 v78, v103, v112, v78
v_dot2_f32_bf16 v79, v103, v113, v79
s_nop 2
v_cvt_pk_bf16_f32 v104, v64, v65
v_cvt_pk_bf16_f32 v105, v66, v67
v_cvt_pk_bf16_f32 v106, v72, v73
v_cvt_pk_bf16_f32 v107, v74, v75
v_cvt_pk_bf16_f32 v108, v68, v69
v_cvt_pk_bf16_f32 v109, v70, v71
v_cvt_pk_bf16_f32 v110, v76, v77
v_cvt_pk_bf16_f32 v111, v78, v79
s_nop 0
v_permlane32_swap_b32 v104, v106
v_permlane32_swap_b32 v105, v107
v_permlane32_swap_b32 v108, v110
v_permlane32_swap_b32 v109, v111
v_permlane16_swap_b32 v104, v106
v_permlane16_swap_b32 v105, v107
v_permlane16_swap_b32 v108, v110
v_permlane16_swap_b32 v109, v111
s_add_u32 s51, s47, 16384
buffer_store_dwordx4 v[104:107], v5, s[28:31], s47 offen
buffer_store_dwordx4 v[108:111], v5, s[28:31], s51 offen
L_end:
s_endpgm
L_codeend:
.section .rodata,"a"
.p2align 6
.amdhsa_kernel standalone__mha_block_cached__near_ridge_kernel
  .amdhsa_next_free_vgpr 512
  .amdhsa_next_free_sgpr 102
  .amdhsa_accum_offset 256
  .amdhsa_group_segment_fixed_size 0
  .amdhsa_kernarg_size 64
  .amdhsa_user_sgpr_count 2
  .amdhsa_user_sgpr_kernarg_segment_ptr 1
  .amdhsa_system_sgpr_workgroup_id_x 1
.end_amdhsa_kernel
```
